```python
import torch

def _softmax(x, axis=-1):
    return torch.softmax(x, dim=axis)
def _gelu(x):
    return torch.nn.functional.gelu(x, approximate="tanh")
def _silu(x):
    return torch.nn.functional.silu(x)
def _sigmoid(x):
    return torch.sigmoid(x)
def _layernorm(x, axis=-1, eps=1e-5):
    m = x.mean(dim=axis, keepdim=True)
    v = x.var(dim=axis, keepdim=True, unbiased=False)
    return (x - m) / torch.sqrt(v + eps)
def _scatter_add(tgt, idx, src, axis=0):
    return tgt.clone().index_add_(axis, idx, src)
def _segment_sum(src, seg, n):
    out = torch.zeros((n,) + src.shape[1:], dtype=src.dtype)
    return out.index_add_(0, seg, src)
def _pad(x, pw):
    flat = tuple(v for pair in reversed(pw) for v in pair)
    return torch.nn.functional.pad(x, flat)

kernel_name = 'standalone__gqa_block_cached__near_ridge'

def setup_inputs():

    _w = (lambda a: (lambda t: t.to(torch.bfloat16) if t.is_floating_point() else t)(torch.as_tensor(a)))
    B, Sq, D = 8, 224, 512
    Hq, Hkv, Sk, Dh = 32, 32, 1024, 128
    assert Hq % Hkv == 0, (Hq, Hkv)
    return {
        "x": _w((lambda *s: torch.randn(*s, dtype=torch.bfloat16) * 0.8)(B, Sq, D)),
        "k_cache": _w((lambda *s: torch.randn(*s, dtype=torch.bfloat16) * 0.8)(B, Hkv, Sk, Dh)),
        "v_cache": _w((lambda *s: torch.randn(*s, dtype=torch.bfloat16) * 0.05)(B, Hkv, Sk, Dh)),
        "wq": _w((lambda *s: torch.randn(*s, dtype=torch.bfloat16) * 0.8)(D, Hq * Dh) * (D ** -0.5)),
        "wo": _w((lambda *s: torch.randn(*s, dtype=torch.bfloat16) * 0.05)(Hq * Dh, D) * ((Hq * Dh) ** -0.5)),
    }

def reference(x, k_cache, v_cache, wq, wo):
    B, Sq, D = x.shape
    Hq, Dh = 32, 128
    Hkv = k_cache.shape[1]
    rep = Hq // Hkv
    q = (lambda x, *d: x.permute(*d))((x @ wq).reshape(B, Sq, Hq, Dh), 0, 2, 1, 3)
    k = (lambda x, n, axis: torch.repeat_interleave(x, n, dim=axis))(k_cache, rep, axis=1)
    v = (lambda x, n, axis: torch.repeat_interleave(x, n, dim=axis))(v_cache, rep, axis=1)
    scores = torch.einsum("bhqd,bhkd->bhqk", q, k) * (Dh ** -0.5)
    p = _softmax(scores, axis=-1)
    o = torch.einsum("bhqk,bhkd->bhqd", p, v)
    return (lambda x, *d: x.permute(*d))(o, 0, 2, 1, 3).reshape(B, Sq, Hq * Dh) @ wo
```

```asm
; @launch grid=(256,1,1) block=(256,1,1) lds=163840
.amdgcn_target "amdgcn-amd-amdhsa--gfx950"
.text
.globl standalone__gqa_block_cached__near_ridge_kernel
.p2align 8
.type standalone__gqa_block_cached__near_ridge_kernel,@function
standalone__gqa_block_cached__near_ridge_kernel:
  s_cmp_ge_u32 s2, 256
  s_cbranch_scc1 L_end
  s_load_dwordx8 s[44:51], s[0:1], 0
  s_load_dwordx8 s[52:59], s[0:1], 32
  v_lshrrev_b32 v1, 6, v0
  v_and_b32 v255, 63, v0
  v_readfirstlane_b32 s30, v1
  s_nop 3
  v_and_b32 v20, 15, v255
  s_lshr_b32 s38, s2, 3
  s_lshl_b32 s38, s38, 4
  s_cmp_lg_u32 s30, 3
  s_cbranch_scc1 L_nopf
  s_getpc_b64 s[100:101]
L_pc0:
  s_sub_u32 s100, s100, L_pc0-standalone__gqa_block_cached__near_ridge_kernel
  s_subb_u32 s101, s101, 0
  v_add_u32 v20, s38, v20
  v_lshlrev_b32 v20, 7, v20
  v_min_u32 v20, L_end-standalone__gqa_block_cached__near_ridge_kernel, v20
  global_load_dword v21, v20, s[100:101]
L_nopf:
  s_and_b32 s34, s2, 7
  s_lshr_b32 s33, s2, 3
  s_and_b32 s33, s33, 3
  s_lshr_b32 s31, s2, 5
  s_lshl_b32 s32, s34, 2
  s_add_u32 s32, s32, s33
  s_lshl_b32 s35, s33, 1
  s_add_u32 s35, s35, s31
  s_and_b32 s35, s35, 7
  v_lshrrev_b32 v2, 4, v255
  v_and_b32 v3, 15, v255
  v_and_b32 v4, 31, v255
  v_lshrrev_b32 v5, 5, v255
  v_lshrrev_b32 v6, 2, v3
  v_and_b32 v7, 3, v3
  v_lshlrev_b32 v8, 2, v2
  v_xor_b32 v8, v8, v3
  v_lshlrev_b32 v8, 4, v8
  v_lshl_add_u32 v156, v2, 13, v8
  v_add_u32 v157, 31744, v156
  v_add_u32 v158, 63488, v156
  v_add_u32 v159, 95232, v156
  v_and_b32 v9, 7, v255
  v_xor_b32 v9, v9, v2
  v_lshlrev_b32 v9, 4, v9
  v_lshrrev_b32 v10, 3, v255
  v_lshl_add_u32 v152, v10, 10, v9
  v_xor_b32 v153, 64, v152
  v_add_u32 v153, 7168, v153
  v_add_u32 v154, 14336, v152
  v_add_u32 v155, 14336, v153
  s_lshl_b32 s76, s30, 16
  s_lshl_b32 s77, s30, 13
  s_lshl_b32 s78, s30, 17
  s_lshl_b32 s79, s30, 12
  s_add_u32 s79, s79, 28672
  s_cmp_eq_u32 s30, 0
  s_cselect_b32 s81, 7, 19
  s_cselect_b64 s[42:43], -1, 0
  s_cselect_b32 s80, 6, 12
  s_cselect_b32 s82, 0, 16384
  s_lshl_b32 s80, s80, 15
  s_add_u32 s82, s82, 24576
  v_cndmask_b32 v136, v156, v152, s[42:43]
  v_cndmask_b32 v137, v157, v153, s[42:43]
  v_cndmask_b32 v138, v158, v154, s[42:43]
  v_cndmask_b32 v139, v159, v155, s[42:43]
  s_mov_b32 s63, 0x20000
  s_waitcnt lgkmcnt(0)
  s_mul_i32 s38, s31, 229376
  s_add_u32 s4, s44, s38
  s_addc_u32 s5, s45, 0
  s_mov_b32 s6, 229376
  s_mov_b32 s7, 0x20000
  s_lshl_b32 s38, s32, 8
  s_add_u32 s8, s50, s38
  s_addc_u32 s9, s51, 0
  s_sub_u32 s10, 0x400000, s38
  s_mov_b32 s11, 0x20000
  s_cmp_eq_u32 s30, 3
  s_cbranch_scc1 L_LW
  s_cmp_eq_u32 s30, 0
  s_cselect_b32 s60, s4, s8
  s_cselect_b32 s61, s5, s9
  s_cselect_b32 s62, s6, s10
  s_mov_b32 s36, s35
  s_lshl_b32 s39, s36, 7
  s_add_u32 m0, s77, 0
  s_add_u32 s38, s76, s39
  buffer_load_dwordx4 v152, s[4:7], s38 offen offset:0 lds
  buffer_load_dwordx4 v153, s[4:7], s38 offen offset:1024 lds
  buffer_load_dwordx4 v154, s[4:7], s38 offen offset:2048 lds
  buffer_load_dwordx4 v155, s[4:7], s38 offen offset:3072 lds
  s_add_u32 m0, s77, 4096
  s_add_u32 s38, s38, 32768
  buffer_load_dwordx4 v152, s[4:7], s38 offen offset:0 lds
  buffer_load_dwordx4 v153, s[4:7], s38 offen offset:1024 lds
  buffer_load_dwordx4 v154, s[4:7], s38 offen offset:2048 lds
  buffer_load_dwordx4 v155, s[4:7], s38 offen offset:3072 lds
  s_lshl_b32 s39, s36, 19
  s_add_u32 m0, s79, 0
  s_add_u32 s38, s78, s39
  buffer_load_dwordx4 v156, s[8:11], s38 offen offset:0 lds
  buffer_load_dwordx4 v157, s[8:11], s38 offen offset:1024 lds
  buffer_load_dwordx4 v158, s[8:11], s38 offen offset:2048 lds
  buffer_load_dwordx4 v159, s[8:11], s38 offen offset:3072 lds
  s_cmp_eq_u32 s30, 2
  s_cbranch_scc1 L_qskip1
  s_lshl_b32 s39, s36, s81
  s_add_u32 m0, s82, 0
  s_add_u32 s38, s80, s39
  buffer_load_dwordx4 v136, s[60:63], s38 offen offset:0 lds
  buffer_load_dwordx4 v137, s[60:63], s38 offen offset:1024 lds
  buffer_load_dwordx4 v138, s[60:63], s38 offen offset:2048 lds
  buffer_load_dwordx4 v139, s[60:63], s38 offen offset:3072 lds
L_qskip1:
  s_add_u32 s36, s36, 2
  s_and_b32 s36, s36, 7
  s_lshl_b32 s38, s31, 5
  s_add_u32 s38, s38, s32
  s_lshl_b32 s38, s38, 18
  s_add_u32 s12, s46, s38
  s_addc_u32 s13, s47, 0
  s_mov_b32 s14, 0x40000
  s_mov_b32 s15, 0x20000
  s_add_u32 s16, s48, s38
  s_addc_u32 s17, s49, 0
  s_mov_b32 s18, 0x40000
  s_mov_b32 s19, 0x20000
  s_lshl_b32 s38, s34, 19
  s_lshl_b32 s39, s33, 8
  s_add_u32 s38, s38, s39
  s_add_u32 s20, s52, s38
  s_addc_u32 s21, s53, 0
  s_sub_u32 s22, 0x400000, s38
  s_mov_b32 s23, 0x20000
  s_mov_b64 s[24:25], s[54:55]
  s_mov_b64 s[26:27], s[56:57]
  s_mov_b64 s[28:29], s[58:59]
  v_xor_b32 v9, v3, v2
  v_lshlrev_b32 v9, 4, v9
  v_lshl_add_u32 v228, v2, 8, v9
  v_xor_b32 v229, 64, v228
  v_xor_b32 v230, 128, v228
  v_xor_b32 v231, 192, v228
  v_lshlrev_b32 v9, 1, v2
  v_xor_b32 v9, v9, v3
  v_lshlrev_b32 v9, 4, v9
  v_lshl_add_u32 v232, v2, 8, v9
  v_xor_b32 v233, 128, v232
  v_lshl_add_u32 v234, v2, 10, v9
  v_xor_b32 v235, 128, v234
  v_add_u32 v236, 6144, v234
  v_add_u32 v235, 3072, v235
  v_add_u32 v237, 6144, v235
  v_xor_b32 v9, v3, v2
  v_lshlrev_b32 v9, 4, v9
  v_lshl_add_u32 v9, v3, 8, v9
  v_add_u32 v240, 98304, v9
  v_xor_b32 v241, 64, v240
  v_xor_b32 v242, 128, v240
  v_xor_b32 v243, 192, v240
  v_lshl_add_u32 v10, v2, 2, v6
  v_and_b32 v11, 7, v10
  v_lshlrev_b32 v11, 1, v11
  v_lshrrev_b32 v12, 1, v7
  v_or_b32 v11, v11, v12
  v_lshlrev_b32 v11, 4, v11
  v_and_b32 v12, 1, v7
  v_lshl_add_u32 v11, v12, 3, v11
  v_lshl_add_u32 v11, v10, 8, v11
  v_add_u32 v244, 98304, v11
  v_xor_b32 v245, 32, v244
  v_xor_b32 v246, 64, v244
  v_xor_b32 v247, 96, v244
  v_xor_b32 v248, 128, v244
  v_xor_b32 v249, 160, v244
  v_xor_b32 v250, 192, v244
  v_xor_b32 v251, 224, v244
  v_lshl_add_u32 v10, v2, 3, v6
  v_lshlrev_b32 v11, 2, v6
  v_or_b32 v11, v11, v7
  v_lshlrev_b32 v11, 4, v11
  v_lshl_add_u32 v11, v10, 8, v11
  v_add_u32 v128, 28672, v11
  v_xor_b32 v129, 64, v128
  v_xor_b32 v130, 128, v128
  v_xor_b32 v131, 192, v128
  v_lshrrev_b32 v11, 1, v3
  v_xor_b32 v11, v11, v2
  v_lshlrev_b32 v11, 4, v11
  v_lshl_add_u32 v11, v3, 7, v11
  s_lshl_b32 s38, s30, 13
  s_add_u32 s38, s38, 0
  v_add_u32 v132, s38, v11
  v_xor_b32 v133, 64, v132
  v_add_u32 v134, 90112, v132
  v_add_u32 v135, 90112, v133
  v_add_u32 v160, 90112, v128
  v_add_u32 v161, 90112, v129
  v_add_u32 v162, 90112, v130
  v_add_u32 v163, 90112, v131
  v_mov_b32 v192, 0
  v_mov_b32 v193, 0
  v_mov_b32 v194, 0
  v_mov_b32 v195, 0
  v_mov_b32 v238, 0
  v_mov_b32 v239, 0
  v_mov_b32 v222, 0
  v_mov_b32 v223, 0
  s_lshl_b32 s39, s36, 7
  s_add_u32 m0, s77, 45056
  s_add_u32 s38, s76, s39
  buffer_load_dwordx4 v152, s[4:7], s38 offen offset:0 lds
  buffer_load_dwordx4 v153, s[4:7], s38 offen offset:1024 lds
  buffer_load_dwordx4 v154, s[4:7], s38 offen offset:2048 lds
  buffer_load_dwordx4 v155, s[4:7], s38 offen offset:3072 lds
  s_add_u32 m0, s77, 49152
  s_add_u32 s38, s38, 32768
  buffer_load_dwordx4 v152, s[4:7], s38 offen offset:0 lds
  buffer_load_dwordx4 v153, s[4:7], s38 offen offset:1024 lds
  buffer_load_dwordx4 v154, s[4:7], s38 offen offset:2048 lds
  buffer_load_dwordx4 v155, s[4:7], s38 offen offset:3072 lds
  s_lshl_b32 s39, s36, 19
  s_add_u32 m0, s79, 45056
  s_add_u32 s38, s78, s39
  buffer_load_dwordx4 v156, s[8:11], s38 offen offset:0 lds
  buffer_load_dwordx4 v157, s[8:11], s38 offen offset:1024 lds
  buffer_load_dwordx4 v158, s[8:11], s38 offen offset:2048 lds
  buffer_load_dwordx4 v159, s[8:11], s38 offen offset:3072 lds
  s_cmp_eq_u32 s30, 2
  s_cbranch_scc1 L_qskip2
  s_lshl_b32 s39, s36, s81
  s_add_u32 m0, s82, 45056
  s_add_u32 s38, s80, s39
  buffer_load_dwordx4 v136, s[60:63], s38 offen offset:0 lds
  buffer_load_dwordx4 v137, s[60:63], s38 offen offset:1024 lds
  buffer_load_dwordx4 v138, s[60:63], s38 offen offset:2048 lds
  buffer_load_dwordx4 v139, s[60:63], s38 offen offset:3072 lds
L_qskip2:
  s_add_u32 s36, s36, 2
  s_and_b32 s36, s36, 7
  s_add_u32 s38, s33, s30
  s_and_b32 s38, s38, 3
  s_lshl_b32 s90, s38, 17
  s_lshl_b32 s91, s30, 15
  s_mov_b32 s87, 0
  s_mov_b32 s88, 32768
  s_mov_b32 s89, 24576
  s_waitcnt vmcnt(12)
  s_barrier
  ds_read_b128 a[128:131], v132 offset:0
  ds_read_b128 a[136:139], v132 offset:2048
  ds_read_b128 a[144:147], v132 offset:4096
  ds_read_b128 a[152:155], v132 offset:6144
  ds_read_b64_tr_b16 a[0:1], v128 offset:0
  ds_read_b64_tr_b16 a[2:3], v128 offset:1024
  ds_read_b64_tr_b16 a[4:5], v128 offset:8
  ds_read_b64_tr_b16 a[6:7], v128 offset:1032
  ds_read_b64_tr_b16 a[8:9], v129 offset:0
  ds_read_b64_tr_b16 a[10:11], v129 offset:1024
  ds_read_b64_tr_b16 a[12:13], v129 offset:8
  ds_read_b64_tr_b16 a[14:15], v129 offset:1032
  ds_read_b64_tr_b16 a[16:17], v130 offset:0
  ds_read_b64_tr_b16 a[18:19], v130 offset:1024
  ds_read_b64_tr_b16 a[20:21], v130 offset:8
  ds_read_b64_tr_b16 a[22:23], v130 offset:1032
  ds_read_b64_tr_b16 a[24:25], v131 offset:0
  ds_read_b64_tr_b16 a[26:27], v131 offset:1024
  ds_read_b64_tr_b16 a[28:29], v131 offset:8
  ds_read_b64_tr_b16 a[30:31], v131 offset:1032
  ds_read_b128 a[132:135], v133 offset:0
  ds_read_b128 a[140:143], v133 offset:2048
  ds_read_b128 a[148:151], v133 offset:4096
  ds_read_b128 a[156:159], v133 offset:6144
  ds_read_b64_tr_b16 a[32:33], v128 offset:8192
  ds_read_b64_tr_b16 a[34:35], v128 offset:9216
  ds_read_b64_tr_b16 a[36:37], v128 offset:8200
  ds_read_b64_tr_b16 a[38:39], v128 offset:9224
  ds_read_b64_tr_b16 a[40:41], v129 offset:8192
  ds_read_b64_tr_b16 a[42:43], v129 offset:9216
  ds_read_b64_tr_b16 a[44:45], v129 offset:8200
  ds_read_b64_tr_b16 a[46:47], v129 offset:9224
  ds_read_b64_tr_b16 a[48:49], v130 offset:8192
  ds_read_b64_tr_b16 a[50:51], v130 offset:9216
  ds_read_b64_tr_b16 a[52:53], v130 offset:8200
  ds_read_b64_tr_b16 a[54:55], v130 offset:9224
  ds_read_b64_tr_b16 a[56:57], v131 offset:8192
  ds_read_b64_tr_b16 a[58:59], v131 offset:9216
  ds_read_b64_tr_b16 a[60:61], v131 offset:8200
  ds_read_b64_tr_b16 a[62:63], v131 offset:9224
  s_waitcnt lgkmcnt(0)
  v_mfma_f32_16x16x32_bf16 v[0:3], a[0:3], a[128:131], 0
  s_waitcnt vmcnt(0)
  s_barrier
  v_mfma_f32_16x16x32_bf16 v[32:35], a[0:3], a[136:139], 0
  v_mfma_f32_16x16x32_bf16 v[64:67], a[0:3], a[144:147], 0
  ds_read_b128 a[160:163], v132 offset:45056
  v_mfma_f32_16x16x32_bf16 v[96:99], a[0:3], a[152:155], 0
  ds_read_b128 a[168:171], v132 offset:47104
  v_mfma_f32_16x16x32_bf16 v[4:7], a[4:7], a[128:131], 0
  ds_read_b128 a[176:179], v132 offset:49152
  v_mfma_f32_16x16x32_bf16 v[36:39], a[4:7], a[136:139], 0
  v_mfma_f32_16x16x32_bf16 v[68:71], a[4:7], a[144:147], 0
  ds_read_b128 a[184:187], v132 offset:51200
  v_mfma_f32_16x16x32_bf16 v[100:103], a[4:7], a[152:155], 0
  ds_read_b64_tr_b16 a[64:65], v128 offset:45056
  v_mfma_f32_16x16x32_bf16 v[8:11], a[8:11], a[128:131], 0
  v_mfma_f32_16x16x32_bf16 v[40:43], a[8:11], a[136:139], 0
  ds_read_b64_tr_b16 a[66:67], v128 offset:46080
  v_mfma_f32_16x16x32_bf16 v[72:75], a[8:11], a[144:147], 0
  ds_read_b64_tr_b16 a[68:69], v128 offset:45064
  v_mfma_f32_16x16x32_bf16 v[104:107], a[8:11], a[152:155], 0
  ds_read_b64_tr_b16 a[70:71], v128 offset:46088
  v_mfma_f32_16x16x32_bf16 v[12:15], a[12:15], a[128:131], 0
  v_mfma_f32_16x16x32_bf16 v[44:47], a[12:15], a[136:139], 0
  ds_read_b64_tr_b16 a[72:73], v129 offset:45056
  v_mfma_f32_16x16x32_bf16 v[76:79], a[12:15], a[144:147], 0
  ds_read_b64_tr_b16 a[74:75], v129 offset:46080
  v_mfma_f32_16x16x32_bf16 v[108:111], a[12:15], a[152:155], 0
  v_mfma_f32_16x16x32_bf16 v[16:19], a[16:19], a[128:131], 0
  ds_read_b64_tr_b16 a[76:77], v129 offset:45064
  v_mfma_f32_16x16x32_bf16 v[48:51], a[16:19], a[136:139], 0
  ds_read_b64_tr_b16 a[78:79], v129 offset:46088
  v_mfma_f32_16x16x32_bf16 v[80:83], a[16:19], a[144:147], 0
  ds_read_b64_tr_b16 a[80:81], v130 offset:45056
  v_mfma_f32_16x16x32_bf16 v[112:115], a[16:19], a[152:155], 0
  v_mfma_f32_16x16x32_bf16 v[20:23], a[20:23], a[128:131], 0
  ds_read_b64_tr_b16 a[82:83], v130 offset:46080
  v_mfma_f32_16x16x32_bf16 v[52:55], a[20:23], a[136:139], 0
  ds_read_b64_tr_b16 a[84:85], v130 offset:45064
  v_mfma_f32_16x16x32_bf16 v[84:87], a[20:23], a[144:147], 0
  v_mfma_f32_16x16x32_bf16 v[116:119], a[20:23], a[152:155], 0
  ds_read_b64_tr_b16 a[86:87], v130 offset:46088
  v_mfma_f32_16x16x32_bf16 v[24:27], a[24:27], a[128:131], 0
  ds_read_b64_tr_b16 a[88:89], v131 offset:45056
  v_mfma_f32_16x16x32_bf16 v[56:59], a[24:27], a[136:139], 0
  ds_read_b64_tr_b16 a[90:91], v131 offset:46080
  v_mfma_f32_16x16x32_bf16 v[88:91], a[24:27], a[144:147], 0
  v_mfma_f32_16x16x32_bf16 v[120:123], a[24:27], a[152:155], 0
  ds_read_b64_tr_b16 a[92:93], v131 offset:45064
  v_mfma_f32_16x16x32_bf16 v[28:31], a[28:31], a[128:131], 0
  ds_read_b64_tr_b16 a[94:95], v131 offset:46088
  v_mfma_f32_16x16x32_bf16 v[60:63], a[28:31], a[136:139], 0
  v_mfma_f32_16x16x32_bf16 v[92:95], a[28:31], a[144:147], 0
  ds_read_b128 a[164:167], v133 offset:45056
  v_mfma_f32_16x16x32_bf16 v[124:127], a[28:31], a[152:155], 0
  ds_read_b128 a[172:175], v133 offset:47104
  v_mfma_f32_16x16x32_bf16 v[0:3], a[32:35], a[132:135], v[0:3]
  ds_read_b128 a[180:183], v133 offset:49152
  v_mfma_f32_16x16x32_bf16 v[32:35], a[32:35], a[140:143], v[32:35]
  v_mfma_f32_16x16x32_bf16 v[64:67], a[32:35], a[148:151], v[64:67]
  ds_read_b128 a[188:191], v133 offset:51200
  v_mfma_f32_16x16x32_bf16 v[96:99], a[32:35], a[156:159], v[96:99]
  ds_read_b64_tr_b16 a[96:97], v128 offset:53248
  v_mfma_f32_16x16x32_bf16 v[4:7], a[36:39], a[132:135], v[4:7]
  v_mfma_f32_16x16x32_bf16 v[36:39], a[36:39], a[140:143], v[36:39]
  ds_read_b64_tr_b16 a[98:99], v128 offset:54272
  v_mfma_f32_16x16x32_bf16 v[68:71], a[36:39], a[148:151], v[68:71]
  ds_read_b64_tr_b16 a[100:101], v128 offset:53256
  v_mfma_f32_16x16x32_bf16 v[100:103], a[36:39], a[156:159], v[100:103]
  ds_read_b64_tr_b16 a[102:103], v128 offset:54280
  v_mfma_f32_16x16x32_bf16 v[8:11], a[40:43], a[132:135], v[8:11]
  v_mfma_f32_16x16x32_bf16 v[40:43], a[40:43], a[140:143], v[40:43]
  ds_read_b64_tr_b16 a[104:105], v129 offset:53248
  v_mfma_f32_16x16x32_bf16 v[72:75], a[40:43], a[148:151], v[72:75]
  ds_read_b64_tr_b16 a[106:107], v129 offset:54272
  v_mfma_f32_16x16x32_bf16 v[104:107], a[40:43], a[156:159], v[104:107]
  v_mfma_f32_16x16x32_bf16 v[12:15], a[44:47], a[132:135], v[12:15]
  ds_read_b64_tr_b16 a[108:109], v129 offset:53256
  v_mfma_f32_16x16x32_bf16 v[44:47], a[44:47], a[140:143], v[44:47]
  ds_read_b64_tr_b16 a[110:111], v129 offset:54280
  v_mfma_f32_16x16x32_bf16 v[76:79], a[44:47], a[148:151], v[76:79]
  ds_read_b64_tr_b16 a[112:113], v130 offset:53248
  v_mfma_f32_16x16x32_bf16 v[108:111], a[44:47], a[156:159], v[108:111]
  v_mfma_f32_16x16x32_bf16 v[16:19], a[48:51], a[132:135], v[16:19]
  ds_read_b64_tr_b16 a[114:115], v130 offset:54272
  v_mfma_f32_16x16x32_bf16 v[48:51], a[48:51], a[140:143], v[48:51]
  ds_read_b64_tr_b16 a[116:117], v130 offset:53256
  v_mfma_f32_16x16x32_bf16 v[80:83], a[48:51], a[148:151], v[80:83]
  v_mfma_f32_16x16x32_bf16 v[112:115], a[48:51], a[156:159], v[112:115]
  ds_read_b64_tr_b16 a[118:119], v130 offset:54280
  v_mfma_f32_16x16x32_bf16 v[20:23], a[52:55], a[132:135], v[20:23]
  ds_read_b64_tr_b16 a[120:121], v131 offset:53248
  v_mfma_f32_16x16x32_bf16 v[52:55], a[52:55], a[140:143], v[52:55]
  ds_read_b64_tr_b16 a[122:123], v131 offset:54272
  v_mfma_f32_16x16x32_bf16 v[84:87], a[52:55], a[148:151], v[84:87]
  v_mfma_f32_16x16x32_bf16 v[116:119], a[52:55], a[156:159], v[116:119]
  ds_read_b64_tr_b16 a[124:125], v131 offset:53256
  v_mfma_f32_16x16x32_bf16 v[24:27], a[56:59], a[132:135], v[24:27]
  ds_read_b64_tr_b16 a[126:127], v131 offset:54280
  v_mfma_f32_16x16x32_bf16 v[56:59], a[56:59], a[140:143], v[56:59]
  v_mfma_f32_16x16x32_bf16 v[88:91], a[56:59], a[148:151], v[88:91]
  v_mfma_f32_16x16x32_bf16 v[120:123], a[56:59], a[156:159], v[120:123]
  v_mfma_f32_16x16x32_bf16 v[28:31], a[60:63], a[132:135], v[28:31]
  v_mfma_f32_16x16x32_bf16 v[60:63], a[60:63], a[140:143], v[60:63]
  v_mfma_f32_16x16x32_bf16 v[92:95], a[60:63], a[148:151], v[92:95]
  v_mfma_f32_16x16x32_bf16 v[124:127], a[60:63], a[156:159], v[124:127]
  s_waitcnt lgkmcnt(0)
  v_mfma_f32_16x16x32_bf16 v[0:3], a[64:67], a[160:163], v[0:3]
  s_barrier
  v_mfma_f32_16x16x32_bf16 v[32:35], a[64:67], a[168:171], v[32:35]
  v_mfma_f32_16x16x32_bf16 v[64:67], a[64:67], a[176:179], v[64:67]
  ds_read_b128 a[128:131], v134 offset:0
  v_mfma_f32_16x16x32_bf16 v[96:99], a[64:67], a[184:187], v[96:99]
  ds_read_b128 a[136:139], v134 offset:2048
  v_mfma_f32_16x16x32_bf16 v[4:7], a[68:71], a[160:163], v[4:7]
  ds_read_b128 a[144:147], v134 offset:4096
  v_mfma_f32_16x16x32_bf16 v[36:39], a[68:71], a[168:171], v[36:39]
  v_mfma_f32_16x16x32_bf16 v[68:71], a[68:71], a[176:179], v[68:71]
  ds_read_b128 a[152:155], v134 offset:6144
  v_mfma_f32_16x16x32_bf16 v[100:103], a[68:71], a[184:187], v[100:103]
  ds_read_b64_tr_b16 a[0:1], v160 offset:0
  v_mfma_f32_16x16x32_bf16 v[8:11], a[72:75], a[160:163], v[8:11]
  v_mfma_f32_16x16x32_bf16 v[40:43], a[72:75], a[168:171], v[40:43]
  ds_read_b64_tr_b16 a[2:3], v160 offset:1024
  v_mfma_f32_16x16x32_bf16 v[72:75], a[72:75], a[176:179], v[72:75]
  ds_read_b64_tr_b16 a[4:5], v160 offset:8
  v_mfma_f32_16x16x32_bf16 v[104:107], a[72:75], a[184:187], v[104:107]
  ds_read_b64_tr_b16 a[6:7], v160 offset:1032
  v_mfma_f32_16x16x32_bf16 v[12:15], a[76:79], a[160:163], v[12:15]
  v_mfma_f32_16x16x32_bf16 v[44:47], a[76:79], a[168:171], v[44:47]
  ds_read_b64_tr_b16 a[8:9], v161 offset:0
  v_mfma_f32_16x16x32_bf16 v[76:79], a[76:79], a[176:179], v[76:79]
  ds_read_b64_tr_b16 a[10:11], v161 offset:1024
  v_mfma_f32_16x16x32_bf16 v[108:111], a[76:79], a[184:187], v[108:111]
  v_mfma_f32_16x16x32_bf16 v[16:19], a[80:83], a[160:163], v[16:19]
  ds_read_b64_tr_b16 a[12:13], v161 offset:8
  v_mfma_f32_16x16x32_bf16 v[48:51], a[80:83], a[168:171], v[48:51]
  ds_read_b64_tr_b16 a[14:15], v161 offset:1032
  v_mfma_f32_16x16x32_bf16 v[80:83], a[80:83], a[176:179], v[80:83]
  ds_read_b64_tr_b16 a[16:17], v162 offset:0
  v_mfma_f32_16x16x32_bf16 v[112:115], a[80:83], a[184:187], v[112:115]
  v_mfma_f32_16x16x32_bf16 v[20:23], a[84:87], a[160:163], v[20:23]
  ds_read_b64_tr_b16 a[18:19], v162 offset:1024
  v_mfma_f32_16x16x32_bf16 v[52:55], a[84:87], a[168:171], v[52:55]
  ds_read_b64_tr_b16 a[20:21], v162 offset:8
  v_mfma_f32_16x16x32_bf16 v[84:87], a[84:87], a[176:179], v[84:87]
  v_mfma_f32_16x16x32_bf16 v[116:119], a[84:87], a[184:187], v[116:119]
  ds_read_b64_tr_b16 a[22:23], v162 offset:1032
  v_mfma_f32_16x16x32_bf16 v[24:27], a[88:91], a[160:163], v[24:27]
  ds_read_b64_tr_b16 a[24:25], v163 offset:0
  v_mfma_f32_16x16x32_bf16 v[56:59], a[88:91], a[168:171], v[56:59]
  ds_read_b64_tr_b16 a[26:27], v163 offset:1024
  v_mfma_f32_16x16x32_bf16 v[88:91], a[88:91], a[176:179], v[88:91]
  v_mfma_f32_16x16x32_bf16 v[120:123], a[88:91], a[184:187], v[120:123]
  ds_read_b64_tr_b16 a[28:29], v163 offset:8
  v_mfma_f32_16x16x32_bf16 v[28:31], a[92:95], a[160:163], v[28:31]
  ds_read_b64_tr_b16 a[30:31], v163 offset:1032
  v_mfma_f32_16x16x32_bf16 v[60:63], a[92:95], a[168:171], v[60:63]
  v_mfma_f32_16x16x32_bf16 v[92:95], a[92:95], a[176:179], v[92:95]
  ds_read_b128 a[132:135], v135 offset:0
  v_mfma_f32_16x16x32_bf16 v[124:127], a[92:95], a[184:187], v[124:127]
  ds_read_b128 a[140:143], v135 offset:2048
  v_mfma_f32_16x16x32_bf16 v[0:3], a[96:99], a[164:167], v[0:3]
  ds_read_b128 a[148:151], v135 offset:4096
  v_mfma_f32_16x16x32_bf16 v[32:35], a[96:99], a[172:175], v[32:35]
  v_mfma_f32_16x16x32_bf16 v[64:67], a[96:99], a[180:183], v[64:67]
  ds_read_b128 a[156:159], v135 offset:6144
  v_mfma_f32_16x16x32_bf16 v[96:99], a[96:99], a[188:191], v[96:99]
  ds_read_b64_tr_b16 a[32:33], v160 offset:8192
  v_mfma_f32_16x16x32_bf16 v[4:7], a[100:103], a[164:167], v[4:7]
  v_mfma_f32_16x16x32_bf16 v[36:39], a[100:103], a[172:175], v[36:39]
  ds_read_b64_tr_b16 a[34:35], v160 offset:9216
  v_mfma_f32_16x16x32_bf16 v[68:71], a[100:103], a[180:183], v[68:71]
  ds_read_b64_tr_b16 a[36:37], v160 offset:8200
  v_mfma_f32_16x16x32_bf16 v[100:103], a[100:103], a[188:191], v[100:103]
  ds_read_b64_tr_b16 a[38:39], v160 offset:9224
  v_mfma_f32_16x16x32_bf16 v[8:11], a[104:107], a[164:167], v[8:11]
  v_mfma_f32_16x16x32_bf16 v[40:43], a[104:107], a[172:175], v[40:43]
  ds_read_b64_tr_b16 a[40:41], v161 offset:8192
  v_mfma_f32_16x16x32_bf16 v[72:75], a[104:107], a[180:183], v[72:75]
  ds_read_b64_tr_b16 a[42:43], v161 offset:9216
  v_mfma_f32_16x16x32_bf16 v[104:107], a[104:107], a[188:191], v[104:107]
  v_mfma_f32_16x16x32_bf16 v[12:15], a[108:111], a[164:167], v[12:15]
  ds_read_b64_tr_b16 a[44:45], v161 offset:8200
  v_mfma_f32_16x16x32_bf16 v[44:47], a[108:111], a[172:175], v[44:47]
  ds_read_b64_tr_b16 a[46:47], v161 offset:9224
  v_mfma_f32_16x16x32_bf16 v[76:79], a[108:111], a[180:183], v[76:79]
  ds_read_b64_tr_b16 a[48:49], v162 offset:8192
  v_mfma_f32_16x16x32_bf16 v[108:111], a[108:111], a[188:191], v[108:111]
  v_mfma_f32_16x16x32_bf16 v[16:19], a[112:115], a[164:167], v[16:19]
  ds_read_b64_tr_b16 a[50:51], v162 offset:9216
  v_mfma_f32_16x16x32_bf16 v[48:51], a[112:115], a[172:175], v[48:51]
  ds_read_b64_tr_b16 a[52:53], v162 offset:8200
  v_mfma_f32_16x16x32_bf16 v[80:83], a[112:115], a[180:183], v[80:83]
  v_mfma_f32_16x16x32_bf16 v[112:115], a[112:115], a[188:191], v[112:115]
  ds_read_b64_tr_b16 a[54:55], v162 offset:9224
  v_mfma_f32_16x16x32_bf16 v[20:23], a[116:119], a[164:167], v[20:23]
  ds_read_b64_tr_b16 a[56:57], v163 offset:8192
  v_mfma_f32_16x16x32_bf16 v[52:55], a[116:119], a[172:175], v[52:55]
  ds_read_b64_tr_b16 a[58:59], v163 offset:9216
  v_mfma_f32_16x16x32_bf16 v[84:87], a[116:119], a[180:183], v[84:87]
  v_mfma_f32_16x16x32_bf16 v[116:119], a[116:119], a[188:191], v[116:119]
  ds_read_b64_tr_b16 a[60:61], v163 offset:8200
  v_mfma_f32_16x16x32_bf16 v[24:27], a[120:123], a[164:167], v[24:27]
  ds_read_b64_tr_b16 a[62:63], v163 offset:9224
  v_mfma_f32_16x16x32_bf16 v[56:59], a[120:123], a[172:175], v[56:59]
  v_mfma_f32_16x16x32_bf16 v[88:91], a[120:123], a[180:183], v[88:91]
  v_mfma_f32_16x16x32_bf16 v[120:123], a[120:123], a[188:191], v[120:123]
  v_mfma_f32_16x16x32_bf16 v[28:31], a[124:127], a[164:167], v[28:31]
  v_mfma_f32_16x16x32_bf16 v[60:63], a[124:127], a[172:175], v[60:63]
  v_mfma_f32_16x16x32_bf16 v[92:95], a[124:127], a[180:183], v[92:95]
  v_mfma_f32_16x16x32_bf16 v[124:127], a[124:127], a[188:191], v[124:127]
  s_waitcnt lgkmcnt(0)
  v_mfma_f32_16x16x32_bf16 v[0:3], a[0:3], a[128:131], v[0:3]
  s_barrier
  v_mfma_f32_16x16x32_bf16 v[32:35], a[0:3], a[136:139], v[32:35]
  v_mfma_f32_16x16x32_bf16 v[64:67], a[0:3], a[144:147], v[64:67]
  ds_read_b128 a[160:163], v132 offset:0
  v_mfma_f32_16x16x32_bf16 v[96:99], a[0:3], a[152:155], v[96:99]
  ds_read_b128 a[168:171], v132 offset:2048
  v_mfma_f32_16x16x32_bf16 v[4:7], a[4:7], a[128:131], v[4:7]
  ds_read_b128 a[176:179], v132 offset:4096
  v_mfma_f32_16x16x32_bf16 v[36:39], a[4:7], a[136:139], v[36:39]
  v_mfma_f32_16x16x32_bf16 v[68:71], a[4:7], a[144:147], v[68:71]
  ds_read_b128 a[184:187], v132 offset:6144
  v_mfma_f32_16x16x32_bf16 v[100:103], a[4:7], a[152:155], v[100:103]
  ds_read_b64_tr_b16 a[64:65], v128 offset:0
  v_mfma_f32_16x16x32_bf16 v[8:11], a[8:11], a[128:131], v[8:11]
  v_mfma_f32_16x16x32_bf16 v[40:43], a[8:11], a[136:139], v[40:43]
  ds_read_b64_tr_b16 a[66:67], v128 offset:1024
  v_mfma_f32_16x16x32_bf16 v[72:75], a[8:11], a[144:147], v[72:75]
  ds_read_b64_tr_b16 a[68:69], v128 offset:8
  v_mfma_f32_16x16x32_bf16 v[104:107], a[8:11], a[152:155], v[104:107]
  ds_read_b64_tr_b16 a[70:71], v128 offset:1032
  v_mfma_f32_16x16x32_bf16 v[12:15], a[12:15], a[128:131], v[12:15]
  v_mfma_f32_16x16x32_bf16 v[44:47], a[12:15], a[136:139], v[44:47]
  ds_read_b64_tr_b16 a[72:73], v129 offset:0
  v_mfma_f32_16x16x32_bf16 v[76:79], a[12:15], a[144:147], v[76:79]
  ds_read_b64_tr_b16 a[74:75], v129 offset:1024
  v_mfma_f32_16x16x32_bf16 v[108:111], a[12:15], a[152:155], v[108:111]
  v_mfma_f32_16x16x32_bf16 v[16:19], a[16:19], a[128:131], v[16:19]
  ds_read_b64_tr_b16 a[76:77], v129 offset:8
  v_mfma_f32_16x16x32_bf16 v[48:51], a[16:19], a[136:139], v[48:51]
  ds_read_b64_tr_b16 a[78:79], v129 offset:1032
  v_mfma_f32_16x16x32_bf16 v[80:83], a[16:19], a[144:147], v[80:83]
  ds_read_b64_tr_b16 a[80:81], v130 offset:0
  v_mfma_f32_16x16x32_bf16 v[112:115], a[16:19], a[152:155], v[112:115]
  v_mfma_f32_16x16x32_bf16 v[20:23], a[20:23], a[128:131], v[20:23]
  ds_read_b64_tr_b16 a[82:83], v130 offset:1024
  v_mfma_f32_16x16x32_bf16 v[52:55], a[20:23], a[136:139], v[52:55]
  ds_read_b64_tr_b16 a[84:85], v130 offset:8
  v_mfma_f32_16x16x32_bf16 v[84:87], a[20:23], a[144:147], v[84:87]
  v_mfma_f32_16x16x32_bf16 v[116:119], a[20:23], a[152:155], v[116:119]
  ds_read_b64_tr_b16 a[86:87], v130 offset:1032
  v_mfma_f32_16x16x32_bf16 v[24:27], a[24:27], a[128:131], v[24:27]
  ds_read_b64_tr_b16 a[88:89], v131 offset:0
  v_mfma_f32_16x16x32_bf16 v[56:59], a[24:27], a[136:139], v[56:59]
  ds_read_b64_tr_b16 a[90:91], v131 offset:1024
  v_mfma_f32_16x16x32_bf16 v[88:91], a[24:27], a[144:147], v[88:91]
  v_mfma_f32_16x16x32_bf16 v[120:123], a[24:27], a[152:155], v[120:123]
  ds_read_b64_tr_b16 a[92:93], v131 offset:8
  v_mfma_f32_16x16x32_bf16 v[28:31], a[28:31], a[128:131], v[28:31]
  ds_read_b64_tr_b16 a[94:95], v131 offset:1032
  v_mfma_f32_16x16x32_bf16 v[60:63], a[28:31], a[136:139], v[60:63]
  v_mfma_f32_16x16x32_bf16 v[92:95], a[28:31], a[144:147], v[92:95]
  ds_read_b128 a[164:167], v133 offset:0
  v_mfma_f32_16x16x32_bf16 v[124:127], a[28:31], a[152:155], v[124:127]
  ds_read_b128 a[172:175], v133 offset:2048
  v_mfma_f32_16x16x32_bf16 v[0:3], a[32:35], a[132:135], v[0:3]
  ds_read_b128 a[180:183], v133 offset:4096
  v_mfma_f32_16x16x32_bf16 v[32:35], a[32:35], a[140:143], v[32:35]
  v_mfma_f32_16x16x32_bf16 v[64:67], a[32:35], a[148:151], v[64:67]
  ds_read_b128 a[188:191], v133 offset:6144
  v_mfma_f32_16x16x32_bf16 v[96:99], a[32:35], a[156:159], v[96:99]
  ds_read_b64_tr_b16 a[96:97], v128 offset:8192
  v_mfma_f32_16x16x32_bf16 v[4:7], a[36:39], a[132:135], v[4:7]
  v_mfma_f32_16x16x32_bf16 v[36:39], a[36:39], a[140:143], v[36:39]
  ds_read_b64_tr_b16 a[98:99], v128 offset:9216
  v_mfma_f32_16x16x32_bf16 v[68:71], a[36:39], a[148:151], v[68:71]
  ds_read_b64_tr_b16 a[100:101], v128 offset:8200
  v_mfma_f32_16x16x32_bf16 v[100:103], a[36:39], a[156:159], v[100:103]
  ds_read_b64_tr_b16 a[102:103], v128 offset:9224
  v_mfma_f32_16x16x32_bf16 v[8:11], a[40:43], a[132:135], v[8:11]
  v_mfma_f32_16x16x32_bf16 v[40:43], a[40:43], a[140:143], v[40:43]
  ds_read_b64_tr_b16 a[104:105], v129 offset:8192
  v_mfma_f32_16x16x32_bf16 v[72:75], a[40:43], a[148:151], v[72:75]
  ds_read_b64_tr_b16 a[106:107], v129 offset:9216
  v_mfma_f32_16x16x32_bf16 v[104:107], a[40:43], a[156:159], v[104:107]
  v_mfma_f32_16x16x32_bf16 v[12:15], a[44:47], a[132:135], v[12:15]
  ds_read_b64_tr_b16 a[108:109], v129 offset:8200
  v_mfma_f32_16x16x32_bf16 v[44:47], a[44:47], a[140:143], v[44:47]
  ds_read_b64_tr_b16 a[110:111], v129 offset:9224
  v_mfma_f32_16x16x32_bf16 v[76:79], a[44:47], a[148:151], v[76:79]
  ds_read_b64_tr_b16 a[112:113], v130 offset:8192
  v_mfma_f32_16x16x32_bf16 v[108:111], a[44:47], a[156:159], v[108:111]
  v_mfma_f32_16x16x32_bf16 v[16:19], a[48:51], a[132:135], v[16:19]
  ds_read_b64_tr_b16 a[114:115], v130 offset:9216
  v_mfma_f32_16x16x32_bf16 v[48:51], a[48:51], a[140:143], v[48:51]
  ds_read_b64_tr_b16 a[116:117], v130 offset:8200
  v_mfma_f32_16x16x32_bf16 v[80:83], a[48:51], a[148:151], v[80:83]
  v_mfma_f32_16x16x32_bf16 v[112:115], a[48:51], a[156:159], v[112:115]
  ds_read_b64_tr_b16 a[118:119], v130 offset:9224
  v_mfma_f32_16x16x32_bf16 v[20:23], a[52:55], a[132:135], v[20:23]
  ds_read_b64_tr_b16 a[120:121], v131 offset:8192
  v_mfma_f32_16x16x32_bf16 v[52:55], a[52:55], a[140:143], v[52:55]
  ds_read_b64_tr_b16 a[122:123], v131 offset:9216
  v_mfma_f32_16x16x32_bf16 v[84:87], a[52:55], a[148:151], v[84:87]
  v_mfma_f32_16x16x32_bf16 v[116:119], a[52:55], a[156:159], v[116:119]
  ds_read_b64_tr_b16 a[124:125], v131 offset:8200
  v_mfma_f32_16x16x32_bf16 v[24:27], a[56:59], a[132:135], v[24:27]
  ds_read_b64_tr_b16 a[126:127], v131 offset:9224
  v_mfma_f32_16x16x32_bf16 v[56:59], a[56:59], a[140:143], v[56:59]
  v_mfma_f32_16x16x32_bf16 v[88:91], a[56:59], a[148:151], v[88:91]
  v_mfma_f32_16x16x32_bf16 v[120:123], a[56:59], a[156:159], v[120:123]
  v_mfma_f32_16x16x32_bf16 v[28:31], a[60:63], a[132:135], v[28:31]
  v_mfma_f32_16x16x32_bf16 v[60:63], a[60:63], a[140:143], v[60:63]
  v_mfma_f32_16x16x32_bf16 v[92:95], a[60:63], a[148:151], v[92:95]
  v_mfma_f32_16x16x32_bf16 v[124:127], a[60:63], a[156:159], v[124:127]
  s_waitcnt lgkmcnt(0)
  v_mfma_f32_16x16x32_bf16 v[0:3], a[64:67], a[160:163], v[0:3]
  s_barrier
  v_mfma_f32_16x16x32_bf16 v[32:35], a[64:67], a[168:171], v[32:35]
  v_mfma_f32_16x16x32_bf16 v[64:67], a[64:67], a[176:179], v[64:67]
  ds_read_b128 a[128:131], v132 offset:45056
  v_mfma_f32_16x16x32_bf16 v[96:99], a[64:67], a[184:187], v[96:99]
  ds_read_b128 a[136:139], v132 offset:47104
  v_mfma_f32_16x16x32_bf16 v[4:7], a[68:71], a[160:163], v[4:7]
  ds_read_b128 a[144:147], v132 offset:49152
  v_mfma_f32_16x16x32_bf16 v[36:39], a[68:71], a[168:171], v[36:39]
  v_mfma_f32_16x16x32_bf16 v[68:71], a[68:71], a[176:179], v[68:71]
  ds_read_b128 a[152:155], v132 offset:51200
  v_mfma_f32_16x16x32_bf16 v[100:103], a[68:71], a[184:187], v[100:103]
  ds_read_b64_tr_b16 a[0:1], v128 offset:45056
  v_mfma_f32_16x16x32_bf16 v[8:11], a[72:75], a[160:163], v[8:11]
  v_mfma_f32_16x16x32_bf16 v[40:43], a[72:75], a[168:171], v[40:43]
  ds_read_b64_tr_b16 a[2:3], v128 offset:46080
  v_mfma_f32_16x16x32_bf16 v[72:75], a[72:75], a[176:179], v[72:75]
  ds_read_b64_tr_b16 a[4:5], v128 offset:45064
  v_mfma_f32_16x16x32_bf16 v[104:107], a[72:75], a[184:187], v[104:107]
  ds_read_b64_tr_b16 a[6:7], v128 offset:46088
  v_mfma_f32_16x16x32_bf16 v[12:15], a[76:79], a[160:163], v[12:15]
  v_mfma_f32_16x16x32_bf16 v[44:47], a[76:79], a[168:171], v[44:47]
  ds_read_b64_tr_b16 a[8:9], v129 offset:45056
  v_mfma_f32_16x16x32_bf16 v[76:79], a[76:79], a[176:179], v[76:79]
  ds_read_b64_tr_b16 a[10:11], v129 offset:46080
  v_mfma_f32_16x16x32_bf16 v[108:111], a[76:79], a[184:187], v[108:111]
  v_mfma_f32_16x16x32_bf16 v[16:19], a[80:83], a[160:163], v[16:19]
  ds_read_b64_tr_b16 a[12:13], v129 offset:45064
  v_mfma_f32_16x16x32_bf16 v[48:51], a[80:83], a[168:171], v[48:51]
  ds_read_b64_tr_b16 a[14:15], v129 offset:46088
  v_mfma_f32_16x16x32_bf16 v[80:83], a[80:83], a[176:179], v[80:83]
  ds_read_b64_tr_b16 a[16:17], v130 offset:45056
  v_mfma_f32_16x16x32_bf16 v[112:115], a[80:83], a[184:187], v[112:115]
  v_mfma_f32_16x16x32_bf16 v[20:23], a[84:87], a[160:163], v[20:23]
  ds_read_b64_tr_b16 a[18:19], v130 offset:46080
  v_mfma_f32_16x16x32_bf16 v[52:55], a[84:87], a[168:171], v[52:55]
  ds_read_b64_tr_b16 a[20:21], v130 offset:45064
  v_mfma_f32_16x16x32_bf16 v[84:87], a[84:87], a[176:179], v[84:87]
  v_mfma_f32_16x16x32_bf16 v[116:119], a[84:87], a[184:187], v[116:119]
  ds_read_b64_tr_b16 a[22:23], v130 offset:46088
  v_mfma_f32_16x16x32_bf16 v[24:27], a[88:91], a[160:163], v[24:27]
  ds_read_b64_tr_b16 a[24:25], v131 offset:45056
  v_mfma_f32_16x16x32_bf16 v[56:59], a[88:91], a[168:171], v[56:59]
  ds_read_b64_tr_b16 a[26:27], v131 offset:46080
  v_mfma_f32_16x16x32_bf16 v[88:91], a[88:91], a[176:179], v[88:91]
  v_mfma_f32_16x16x32_bf16 v[120:123], a[88:91], a[184:187], v[120:123]
  ds_read_b64_tr_b16 a[28:29], v131 offset:45064
  v_mfma_f32_16x16x32_bf16 v[28:31], a[92:95], a[160:163], v[28:31]
  ds_read_b64_tr_b16 a[30:31], v131 offset:46088
  v_mfma_f32_16x16x32_bf16 v[60:63], a[92:95], a[168:171], v[60:63]
  v_mfma_f32_16x16x32_bf16 v[92:95], a[92:95], a[176:179], v[92:95]
  ds_read_b128 a[132:135], v133 offset:45056
  v_mfma_f32_16x16x32_bf16 v[124:127], a[92:95], a[184:187], v[124:127]
  ds_read_b128 a[140:143], v133 offset:47104
  v_mfma_f32_16x16x32_bf16 v[0:3], a[96:99], a[164:167], v[0:3]
  ds_read_b128 a[148:151], v133 offset:49152
  v_mfma_f32_16x16x32_bf16 v[32:35], a[96:99], a[172:175], v[32:35]
  v_mfma_f32_16x16x32_bf16 v[64:67], a[96:99], a[180:183], v[64:67]
  ds_read_b128 a[156:159], v133 offset:51200
  v_mfma_f32_16x16x32_bf16 v[96:99], a[96:99], a[188:191], v[96:99]
  ds_read_b64_tr_b16 a[32:33], v128 offset:53248
  v_mfma_f32_16x16x32_bf16 v[4:7], a[100:103], a[164:167], v[4:7]
  v_mfma_f32_16x16x32_bf16 v[36:39], a[100:103], a[172:175], v[36:39]
  ds_read_b64_tr_b16 a[34:35], v128 offset:54272
  v_mfma_f32_16x16x32_bf16 v[68:71], a[100:103], a[180:183], v[68:71]
  ds_read_b64_tr_b16 a[36:37], v128 offset:53256
  v_mfma_f32_16x16x32_bf16 v[100:103], a[100:103], a[188:191], v[100:103]
  ds_read_b64_tr_b16 a[38:39], v128 offset:54280
  v_mfma_f32_16x16x32_bf16 v[8:11], a[104:107], a[164:167], v[8:11]
  v_mfma_f32_16x16x32_bf16 v[40:43], a[104:107], a[172:175], v[40:43]
  ds_read_b64_tr_b16 a[40:41], v129 offset:53248
  v_mfma_f32_16x16x32_bf16 v[72:75], a[104:107], a[180:183], v[72:75]
  ds_read_b64_tr_b16 a[42:43], v129 offset:54272
  v_mfma_f32_16x16x32_bf16 v[104:107], a[104:107], a[188:191], v[104:107]
  v_mfma_f32_16x16x32_bf16 v[12:15], a[108:111], a[164:167], v[12:15]
  ds_read_b64_tr_b16 a[44:45], v129 offset:53256
  v_mfma_f32_16x16x32_bf16 v[44:47], a[108:111], a[172:175], v[44:47]
  ds_read_b64_tr_b16 a[46:47], v129 offset:54280
  v_mfma_f32_16x16x32_bf16 v[76:79], a[108:111], a[180:183], v[76:79]
  ds_read_b64_tr_b16 a[48:49], v130 offset:53248
  v_mfma_f32_16x16x32_bf16 v[108:111], a[108:111], a[188:191], v[108:111]
  v_mfma_f32_16x16x32_bf16 v[16:19], a[112:115], a[164:167], v[16:19]
  ds_read_b64_tr_b16 a[50:51], v130 offset:54272
  v_mfma_f32_16x16x32_bf16 v[48:51], a[112:115], a[172:175], v[48:51]
  ds_read_b64_tr_b16 a[52:53], v130 offset:53256
  v_mfma_f32_16x16x32_bf16 v[80:83], a[112:115], a[180:183], v[80:83]
  v_mfma_f32_16x16x32_bf16 v[112:115], a[112:115], a[188:191], v[112:115]
  ds_read_b64_tr_b16 a[54:55], v130 offset:54280
  v_mfma_f32_16x16x32_bf16 v[20:23], a[116:119], a[164:167], v[20:23]
  ds_read_b64_tr_b16 a[56:57], v131 offset:53248
  v_mfma_f32_16x16x32_bf16 v[52:55], a[116:119], a[172:175], v[52:55]
  ds_read_b64_tr_b16 a[58:59], v131 offset:54272
  v_mfma_f32_16x16x32_bf16 v[84:87], a[116:119], a[180:183], v[84:87]
  v_mfma_f32_16x16x32_bf16 v[116:119], a[116:119], a[188:191], v[116:119]
  ds_read_b64_tr_b16 a[60:61], v131 offset:53256
  v_mfma_f32_16x16x32_bf16 v[24:27], a[120:123], a[164:167], v[24:27]
  ds_read_b64_tr_b16 a[62:63], v131 offset:54280
  v_mfma_f32_16x16x32_bf16 v[56:59], a[120:123], a[172:175], v[56:59]
  v_mfma_f32_16x16x32_bf16 v[88:91], a[120:123], a[180:183], v[88:91]
  v_mfma_f32_16x16x32_bf16 v[120:123], a[120:123], a[188:191], v[120:123]
  v_mfma_f32_16x16x32_bf16 v[28:31], a[124:127], a[164:167], v[28:31]
  v_mfma_f32_16x16x32_bf16 v[60:63], a[124:127], a[172:175], v[60:63]
  v_mfma_f32_16x16x32_bf16 v[92:95], a[124:127], a[180:183], v[92:95]
  v_mfma_f32_16x16x32_bf16 v[124:127], a[124:127], a[188:191], v[124:127]
  s_waitcnt lgkmcnt(0)
  v_mfma_f32_16x16x32_bf16 v[0:3], a[0:3], a[128:131], v[0:3]
  s_barrier
  v_mfma_f32_16x16x32_bf16 v[32:35], a[0:3], a[136:139], v[32:35]
  v_mfma_f32_16x16x32_bf16 v[64:67], a[0:3], a[144:147], v[64:67]
  ds_read_b128 a[160:163], v134 offset:0
  v_mfma_f32_16x16x32_bf16 v[96:99], a[0:3], a[152:155], v[96:99]
  ds_read_b128 a[168:171], v134 offset:2048
  v_mfma_f32_16x16x32_bf16 v[4:7], a[4:7], a[128:131], v[4:7]
  ds_read_b128 a[176:179], v134 offset:4096
  v_mfma_f32_16x16x32_bf16 v[36:39], a[4:7], a[136:139], v[36:39]
  v_mfma_f32_16x16x32_bf16 v[68:71], a[4:7], a[144:147], v[68:71]
  ds_read_b128 a[184:187], v134 offset:6144
  v_mfma_f32_16x16x32_bf16 v[100:103], a[4:7], a[152:155], v[100:103]
  ds_read_b64_tr_b16 a[64:65], v160 offset:0
  v_mfma_f32_16x16x32_bf16 v[8:11], a[8:11], a[128:131], v[8:11]
  v_mfma_f32_16x16x32_bf16 v[40:43], a[8:11], a[136:139], v[40:43]
  ds_read_b64_tr_b16 a[66:67], v160 offset:1024
  v_mfma_f32_16x16x32_bf16 v[72:75], a[8:11], a[144:147], v[72:75]
  ds_read_b64_tr_b16 a[68:69], v160 offset:8
  v_mfma_f32_16x16x32_bf16 v[104:107], a[8:11], a[152:155], v[104:107]
  ds_read_b64_tr_b16 a[70:71], v160 offset:1032
  v_mfma_f32_16x16x32_bf16 v[12:15], a[12:15], a[128:131], v[12:15]
  v_mfma_f32_16x16x32_bf16 v[44:47], a[12:15], a[136:139], v[44:47]
  ds_read_b64_tr_b16 a[72:73], v161 offset:0
  v_mfma_f32_16x16x32_bf16 v[76:79], a[12:15], a[144:147], v[76:79]
  ds_read_b64_tr_b16 a[74:75], v161 offset:1024
  v_mfma_f32_16x16x32_bf16 v[108:111], a[12:15], a[152:155], v[108:111]
  v_mfma_f32_16x16x32_bf16 v[16:19], a[16:19], a[128:131], v[16:19]
  ds_read_b64_tr_b16 a[76:77], v161 offset:8
  v_mfma_f32_16x16x32_bf16 v[48:51], a[16:19], a[136:139], v[48:51]
  ds_read_b64_tr_b16 a[78:79], v161 offset:1032
  v_mfma_f32_16x16x32_bf16 v[80:83], a[16:19], a[144:147], v[80:83]
  ds_read_b64_tr_b16 a[80:81], v162 offset:0
  v_mfma_f32_16x16x32_bf16 v[112:115], a[16:19], a[152:155], v[112:115]
  v_mfma_f32_16x16x32_bf16 v[20:23], a[20:23], a[128:131], v[20:23]
  ds_read_b64_tr_b16 a[82:83], v162 offset:1024
  v_mfma_f32_16x16x32_bf16 v[52:55], a[20:23], a[136:139], v[52:55]
  ds_read_b64_tr_b16 a[84:85], v162 offset:8
  v_mfma_f32_16x16x32_bf16 v[84:87], a[20:23], a[144:147], v[84:87]
  v_mfma_f32_16x16x32_bf16 v[116:119], a[20:23], a[152:155], v[116:119]
  ds_read_b64_tr_b16 a[86:87], v162 offset:1032
  v_mfma_f32_16x16x32_bf16 v[24:27], a[24:27], a[128:131], v[24:27]
  ds_read_b64_tr_b16 a[88:89], v163 offset:0
  v_mfma_f32_16x16x32_bf16 v[56:59], a[24:27], a[136:139], v[56:59]
  ds_read_b64_tr_b16 a[90:91], v163 offset:1024
  v_mfma_f32_16x16x32_bf16 v[88:91], a[24:27], a[144:147], v[88:91]
  v_mfma_f32_16x16x32_bf16 v[120:123], a[24:27], a[152:155], v[120:123]
  ds_read_b64_tr_b16 a[92:93], v163 offset:8
  v_mfma_f32_16x16x32_bf16 v[28:31], a[28:31], a[128:131], v[28:31]
  ds_read_b64_tr_b16 a[94:95], v163 offset:1032
  v_mfma_f32_16x16x32_bf16 v[60:63], a[28:31], a[136:139], v[60:63]
  v_mfma_f32_16x16x32_bf16 v[92:95], a[28:31], a[144:147], v[92:95]
  ds_read_b128 a[164:167], v135 offset:0
  v_mfma_f32_16x16x32_bf16 v[124:127], a[28:31], a[152:155], v[124:127]
  ds_read_b128 a[172:175], v135 offset:2048
  v_mfma_f32_16x16x32_bf16 v[0:3], a[32:35], a[132:135], v[0:3]
  ds_read_b128 a[180:183], v135 offset:4096
  v_mfma_f32_16x16x32_bf16 v[32:35], a[32:35], a[140:143], v[32:35]
  v_mfma_f32_16x16x32_bf16 v[64:67], a[32:35], a[148:151], v[64:67]
  ds_read_b128 a[188:191], v135 offset:6144
  v_mfma_f32_16x16x32_bf16 v[96:99], a[32:35], a[156:159], v[96:99]
  ds_read_b64_tr_b16 a[96:97], v160 offset:8192
  v_mfma_f32_16x16x32_bf16 v[4:7], a[36:39], a[132:135], v[4:7]
  v_mfma_f32_16x16x32_bf16 v[36:39], a[36:39], a[140:143], v[36:39]
  ds_read_b64_tr_b16 a[98:99], v160 offset:9216
  v_mfma_f32_16x16x32_bf16 v[68:71], a[36:39], a[148:151], v[68:71]
  ds_read_b64_tr_b16 a[100:101], v160 offset:8200
  v_mfma_f32_16x16x32_bf16 v[100:103], a[36:39], a[156:159], v[100:103]
  ds_read_b64_tr_b16 a[102:103], v160 offset:9224
  v_mfma_f32_16x16x32_bf16 v[8:11], a[40:43], a[132:135], v[8:11]
  v_mfma_f32_16x16x32_bf16 v[40:43], a[40:43], a[140:143], v[40:43]
  ds_read_b64_tr_b16 a[104:105], v161 offset:8192
  v_mfma_f32_16x16x32_bf16 v[72:75], a[40:43], a[148:151], v[72:75]
  ds_read_b64_tr_b16 a[106:107], v161 offset:9216
  v_mfma_f32_16x16x32_bf16 v[104:107], a[40:43], a[156:159], v[104:107]
  v_mfma_f32_16x16x32_bf16 v[12:15], a[44:47], a[132:135], v[12:15]
  ds_read_b64_tr_b16 a[108:109], v161 offset:8200
  v_mfma_f32_16x16x32_bf16 v[44:47], a[44:47], a[140:143], v[44:47]
  ds_read_b64_tr_b16 a[110:111], v161 offset:9224
  v_mfma_f32_16x16x32_bf16 v[76:79], a[44:47], a[148:151], v[76:79]
  ds_read_b64_tr_b16 a[112:113], v162 offset:8192
  v_mfma_f32_16x16x32_bf16 v[108:111], a[44:47], a[156:159], v[108:111]
  v_mfma_f32_16x16x32_bf16 v[16:19], a[48:51], a[132:135], v[16:19]
  ds_read_b64_tr_b16 a[114:115], v162 offset:9216
  v_mfma_f32_16x16x32_bf16 v[48:51], a[48:51], a[140:143], v[48:51]
  ds_read_b64_tr_b16 a[116:117], v162 offset:8200
  v_mfma_f32_16x16x32_bf16 v[80:83], a[48:51], a[148:151], v[80:83]
  v_mfma_f32_16x16x32_bf16 v[112:115], a[48:51], a[156:159], v[112:115]
  ds_read_b64_tr_b16 a[118:119], v162 offset:9224
  v_mfma_f32_16x16x32_bf16 v[20:23], a[52:55], a[132:135], v[20:23]
  ds_read_b64_tr_b16 a[120:121], v163 offset:8192
  v_mfma_f32_16x16x32_bf16 v[52:55], a[52:55], a[140:143], v[52:55]
  ds_read_b64_tr_b16 a[122:123], v163 offset:9216
  v_mfma_f32_16x16x32_bf16 v[84:87], a[52:55], a[148:151], v[84:87]
  v_mfma_f32_16x16x32_bf16 v[116:119], a[52:55], a[156:159], v[116:119]
  ds_read_b64_tr_b16 a[124:125], v163 offset:8200
  v_mfma_f32_16x16x32_bf16 v[24:27], a[56:59], a[132:135], v[24:27]
  ds_read_b64_tr_b16 a[126:127], v163 offset:9224
  v_mfma_f32_16x16x32_bf16 v[56:59], a[56:59], a[140:143], v[56:59]
  v_mfma_f32_16x16x32_bf16 v[88:91], a[56:59], a[148:151], v[88:91]
  v_mfma_f32_16x16x32_bf16 v[120:123], a[56:59], a[156:159], v[120:123]
  v_mfma_f32_16x16x32_bf16 v[28:31], a[60:63], a[132:135], v[28:31]
  v_mfma_f32_16x16x32_bf16 v[60:63], a[60:63], a[140:143], v[60:63]
  v_mfma_f32_16x16x32_bf16 v[92:95], a[60:63], a[148:151], v[92:95]
  v_mfma_f32_16x16x32_bf16 v[124:127], a[60:63], a[156:159], v[124:127]
  s_waitcnt lgkmcnt(0)
  v_mfma_f32_16x16x32_bf16 v[0:3], a[64:67], a[160:163], v[0:3]
  s_barrier
  v_mfma_f32_16x16x32_bf16 v[32:35], a[64:67], a[168:171], v[32:35]
  v_mfma_f32_16x16x32_bf16 v[64:67], a[64:67], a[176:179], v[64:67]
  ds_read_b128 a[128:131], v132 offset:0
  v_mfma_f32_16x16x32_bf16 v[96:99], a[64:67], a[184:187], v[96:99]
  ds_read_b128 a[136:139], v132 offset:2048
  v_mfma_f32_16x16x32_bf16 v[4:7], a[68:71], a[160:163], v[4:7]
  ds_read_b128 a[144:147], v132 offset:4096
  v_mfma_f32_16x16x32_bf16 v[36:39], a[68:71], a[168:171], v[36:39]
  v_mfma_f32_16x16x32_bf16 v[68:71], a[68:71], a[176:179], v[68:71]
  ds_read_b128 a[152:155], v132 offset:6144
  v_mfma_f32_16x16x32_bf16 v[100:103], a[68:71], a[184:187], v[100:103]
  ds_read_b64_tr_b16 a[0:1], v128 offset:0
  v_mfma_f32_16x16x32_bf16 v[8:11], a[72:75], a[160:163], v[8:11]
  v_mfma_f32_16x16x32_bf16 v[40:43], a[72:75], a[168:171], v[40:43]
  ds_read_b64_tr_b16 a[2:3], v128 offset:1024
  v_mfma_f32_16x16x32_bf16 v[72:75], a[72:75], a[176:179], v[72:75]
  ds_read_b64_tr_b16 a[4:5], v128 offset:8
  v_mfma_f32_16x16x32_bf16 v[104:107], a[72:75], a[184:187], v[104:107]
  ds_read_b64_tr_b16 a[6:7], v128 offset:1032
  v_mfma_f32_16x16x32_bf16 v[12:15], a[76:79], a[160:163], v[12:15]
  v_mfma_f32_16x16x32_bf16 v[44:47], a[76:79], a[168:171], v[44:47]
  ds_read_b64_tr_b16 a[8:9], v129 offset:0
  v_mfma_f32_16x16x32_bf16 v[76:79], a[76:79], a[176:179], v[76:79]
  ds_read_b64_tr_b16 a[10:11], v129 offset:1024
  v_mfma_f32_16x16x32_bf16 v[108:111], a[76:79], a[184:187], v[108:111]
  v_mfma_f32_16x16x32_bf16 v[16:19], a[80:83], a[160:163], v[16:19]
  ds_read_b64_tr_b16 a[12:13], v129 offset:8
  v_mfma_f32_16x16x32_bf16 v[48:51], a[80:83], a[168:171], v[48:51]
  ds_read_b64_tr_b16 a[14:15], v129 offset:1032
  v_mfma_f32_16x16x32_bf16 v[80:83], a[80:83], a[176:179], v[80:83]
  ds_read_b64_tr_b16 a[16:17], v130 offset:0
  v_mfma_f32_16x16x32_bf16 v[112:115], a[80:83], a[184:187], v[112:115]
  v_mfma_f32_16x16x32_bf16 v[20:23], a[84:87], a[160:163], v[20:23]
  ds_read_b64_tr_b16 a[18:19], v130 offset:1024
  v_mfma_f32_16x16x32_bf16 v[52:55], a[84:87], a[168:171], v[52:55]
  ds_read_b64_tr_b16 a[20:21], v130 offset:8
  v_mfma_f32_16x16x32_bf16 v[84:87], a[84:87], a[176:179], v[84:87]
  v_mfma_f32_16x16x32_bf16 v[116:119], a[84:87], a[184:187], v[116:119]
  ds_read_b64_tr_b16 a[22:23], v130 offset:1032
  v_mfma_f32_16x16x32_bf16 v[24:27], a[88:91], a[160:163], v[24:27]
  ds_read_b64_tr_b16 a[24:25], v131 offset:0
  v_mfma_f32_16x16x32_bf16 v[56:59], a[88:91], a[168:171], v[56:59]
  ds_read_b64_tr_b16 a[26:27], v131 offset:1024
  v_mfma_f32_16x16x32_bf16 v[88:91], a[88:91], a[176:179], v[88:91]
  v_mfma_f32_16x16x32_bf16 v[120:123], a[88:91], a[184:187], v[120:123]
  ds_read_b64_tr_b16 a[28:29], v131 offset:8
  v_mfma_f32_16x16x32_bf16 v[28:31], a[92:95], a[160:163], v[28:31]
  ds_read_b64_tr_b16 a[30:31], v131 offset:1032
  v_mfma_f32_16x16x32_bf16 v[60:63], a[92:95], a[168:171], v[60:63]
  v_mfma_f32_16x16x32_bf16 v[92:95], a[92:95], a[176:179], v[92:95]
  ds_read_b128 a[132:135], v133 offset:0
  v_mfma_f32_16x16x32_bf16 v[124:127], a[92:95], a[184:187], v[124:127]
  ds_read_b128 a[140:143], v133 offset:2048
  v_mfma_f32_16x16x32_bf16 v[0:3], a[96:99], a[164:167], v[0:3]
  ds_read_b128 a[148:151], v133 offset:4096
  v_mfma_f32_16x16x32_bf16 v[32:35], a[96:99], a[172:175], v[32:35]
  v_mfma_f32_16x16x32_bf16 v[64:67], a[96:99], a[180:183], v[64:67]
  ds_read_b128 a[156:159], v133 offset:6144
  v_mfma_f32_16x16x32_bf16 v[96:99], a[96:99], a[188:191], v[96:99]
  ds_read_b64_tr_b16 a[32:33], v128 offset:8192
  v_mfma_f32_16x16x32_bf16 v[4:7], a[100:103], a[164:167], v[4:7]
  v_mfma_f32_16x16x32_bf16 v[36:39], a[100:103], a[172:175], v[36:39]
  ds_read_b64_tr_b16 a[34:35], v128 offset:9216
  v_mfma_f32_16x16x32_bf16 v[68:71], a[100:103], a[180:183], v[68:71]
  ds_read_b64_tr_b16 a[36:37], v128 offset:8200
  v_mfma_f32_16x16x32_bf16 v[100:103], a[100:103], a[188:191], v[100:103]
  ds_read_b64_tr_b16 a[38:39], v128 offset:9224
  v_mfma_f32_16x16x32_bf16 v[8:11], a[104:107], a[164:167], v[8:11]
  v_mfma_f32_16x16x32_bf16 v[40:43], a[104:107], a[172:175], v[40:43]
  ds_read_b64_tr_b16 a[40:41], v129 offset:8192
  v_mfma_f32_16x16x32_bf16 v[72:75], a[104:107], a[180:183], v[72:75]
  ds_read_b64_tr_b16 a[42:43], v129 offset:9216
  v_mfma_f32_16x16x32_bf16 v[104:107], a[104:107], a[188:191], v[104:107]
  v_mfma_f32_16x16x32_bf16 v[12:15], a[108:111], a[164:167], v[12:15]
  ds_read_b64_tr_b16 a[44:45], v129 offset:8200
  v_mfma_f32_16x16x32_bf16 v[44:47], a[108:111], a[172:175], v[44:47]
  ds_read_b64_tr_b16 a[46:47], v129 offset:9224
  v_mfma_f32_16x16x32_bf16 v[76:79], a[108:111], a[180:183], v[76:79]
  ds_read_b64_tr_b16 a[48:49], v130 offset:8192
  v_mfma_f32_16x16x32_bf16 v[108:111], a[108:111], a[188:191], v[108:111]
  v_mfma_f32_16x16x32_bf16 v[16:19], a[112:115], a[164:167], v[16:19]
  ds_read_b64_tr_b16 a[50:51], v130 offset:9216
  v_mfma_f32_16x16x32_bf16 v[48:51], a[112:115], a[172:175], v[48:51]
  ds_read_b64_tr_b16 a[52:53], v130 offset:8200
  v_mfma_f32_16x16x32_bf16 v[80:83], a[112:115], a[180:183], v[80:83]
  v_mfma_f32_16x16x32_bf16 v[112:115], a[112:115], a[188:191], v[112:115]
  ds_read_b64_tr_b16 a[54:55], v130 offset:9224
  v_mfma_f32_16x16x32_bf16 v[20:23], a[116:119], a[164:167], v[20:23]
  ds_read_b64_tr_b16 a[56:57], v131 offset:8192
  v_mfma_f32_16x16x32_bf16 v[52:55], a[116:119], a[172:175], v[52:55]
  ds_read_b64_tr_b16 a[58:59], v131 offset:9216
  v_mfma_f32_16x16x32_bf16 v[84:87], a[116:119], a[180:183], v[84:87]
  v_mfma_f32_16x16x32_bf16 v[116:119], a[116:119], a[188:191], v[116:119]
  ds_read_b64_tr_b16 a[60:61], v131 offset:8200
  v_mfma_f32_16x16x32_bf16 v[24:27], a[120:123], a[164:167], v[24:27]
  ds_read_b64_tr_b16 a[62:63], v131 offset:9224
  v_mfma_f32_16x16x32_bf16 v[56:59], a[120:123], a[172:175], v[56:59]
  v_mfma_f32_16x16x32_bf16 v[88:91], a[120:123], a[180:183], v[88:91]
  v_mfma_f32_16x16x32_bf16 v[120:123], a[120:123], a[188:191], v[120:123]
  v_mfma_f32_16x16x32_bf16 v[28:31], a[124:127], a[164:167], v[28:31]
  v_mfma_f32_16x16x32_bf16 v[60:63], a[124:127], a[172:175], v[60:63]
  v_mfma_f32_16x16x32_bf16 v[92:95], a[124:127], a[180:183], v[92:95]
  v_mfma_f32_16x16x32_bf16 v[124:127], a[124:127], a[188:191], v[124:127]
  s_waitcnt lgkmcnt(0)
  v_mfma_f32_16x16x32_bf16 v[0:3], a[0:3], a[128:131], v[0:3]
  s_barrier
  v_mfma_f32_16x16x32_bf16 v[32:35], a[0:3], a[136:139], v[32:35]
  v_mfma_f32_16x16x32_bf16 v[64:67], a[0:3], a[144:147], v[64:67]
  ds_read_b128 a[160:163], v132 offset:45056
  v_mfma_f32_16x16x32_bf16 v[96:99], a[0:3], a[152:155], v[96:99]
  ds_read_b128 a[168:171], v132 offset:47104
  v_mfma_f32_16x16x32_bf16 v[4:7], a[4:7], a[128:131], v[4:7]
  ds_read_b128 a[176:179], v132 offset:49152
  v_mfma_f32_16x16x32_bf16 v[36:39], a[4:7], a[136:139], v[36:39]
  v_mfma_f32_16x16x32_bf16 v[68:71], a[4:7], a[144:147], v[68:71]
  ds_read_b128 a[184:187], v132 offset:51200
  v_mfma_f32_16x16x32_bf16 v[100:103], a[4:7], a[152:155], v[100:103]
  ds_read_b64_tr_b16 a[64:65], v128 offset:45056
  v_mfma_f32_16x16x32_bf16 v[8:11], a[8:11], a[128:131], v[8:11]
  v_mfma_f32_16x16x32_bf16 v[40:43], a[8:11], a[136:139], v[40:43]
  ds_read_b64_tr_b16 a[66:67], v128 offset:46080
  v_mfma_f32_16x16x32_bf16 v[72:75], a[8:11], a[144:147], v[72:75]
  ds_read_b64_tr_b16 a[68:69], v128 offset:45064
  v_mfma_f32_16x16x32_bf16 v[104:107], a[8:11], a[152:155], v[104:107]
  ds_read_b64_tr_b16 a[70:71], v128 offset:46088
  v_mfma_f32_16x16x32_bf16 v[12:15], a[12:15], a[128:131], v[12:15]
  v_mfma_f32_16x16x32_bf16 v[44:47], a[12:15], a[136:139], v[44:47]
  ds_read_b64_tr_b16 a[72:73], v129 offset:45056
  v_mfma_f32_16x16x32_bf16 v[76:79], a[12:15], a[144:147], v[76:79]
  ds_read_b64_tr_b16 a[74:75], v129 offset:46080
  v_mfma_f32_16x16x32_bf16 v[108:111], a[12:15], a[152:155], v[108:111]
  v_mfma_f32_16x16x32_bf16 v[16:19], a[16:19], a[128:131], v[16:19]
  ds_read_b64_tr_b16 a[76:77], v129 offset:45064
  v_mfma_f32_16x16x32_bf16 v[48:51], a[16:19], a[136:139], v[48:51]
  ds_read_b64_tr_b16 a[78:79], v129 offset:46088
  v_mfma_f32_16x16x32_bf16 v[80:83], a[16:19], a[144:147], v[80:83]
  ds_read_b64_tr_b16 a[80:81], v130 offset:45056
  v_mfma_f32_16x16x32_bf16 v[112:115], a[16:19], a[152:155], v[112:115]
  v_mfma_f32_16x16x32_bf16 v[20:23], a[20:23], a[128:131], v[20:23]
  ds_read_b64_tr_b16 a[82:83], v130 offset:46080
  v_mfma_f32_16x16x32_bf16 v[52:55], a[20:23], a[136:139], v[52:55]
  ds_read_b64_tr_b16 a[84:85], v130 offset:45064
  v_mfma_f32_16x16x32_bf16 v[84:87], a[20:23], a[144:147], v[84:87]
  v_mfma_f32_16x16x32_bf16 v[116:119], a[20:23], a[152:155], v[116:119]
  ds_read_b64_tr_b16 a[86:87], v130 offset:46088
  v_mfma_f32_16x16x32_bf16 v[24:27], a[24:27], a[128:131], v[24:27]
  ds_read_b64_tr_b16 a[88:89], v131 offset:45056
  v_mfma_f32_16x16x32_bf16 v[56:59], a[24:27], a[136:139], v[56:59]
  ds_read_b64_tr_b16 a[90:91], v131 offset:46080
  v_mfma_f32_16x16x32_bf16 v[88:91], a[24:27], a[144:147], v[88:91]
  v_mfma_f32_16x16x32_bf16 v[120:123], a[24:27], a[152:155], v[120:123]
  ds_read_b64_tr_b16 a[92:93], v131 offset:45064
  v_mfma_f32_16x16x32_bf16 v[28:31], a[28:31], a[128:131], v[28:31]
  ds_read_b64_tr_b16 a[94:95], v131 offset:46088
  v_mfma_f32_16x16x32_bf16 v[60:63], a[28:31], a[136:139], v[60:63]
  v_mfma_f32_16x16x32_bf16 v[92:95], a[28:31], a[144:147], v[92:95]
  ds_read_b128 a[164:167], v133 offset:45056
  v_mfma_f32_16x16x32_bf16 v[124:127], a[28:31], a[152:155], v[124:127]
  ds_read_b128 a[172:175], v133 offset:47104
  v_mfma_f32_16x16x32_bf16 v[0:3], a[32:35], a[132:135], v[0:3]
  ds_read_b128 a[180:183], v133 offset:49152
  v_mfma_f32_16x16x32_bf16 v[32:35], a[32:35], a[140:143], v[32:35]
  v_mfma_f32_16x16x32_bf16 v[64:67], a[32:35], a[148:151], v[64:67]
  ds_read_b128 a[188:191], v133 offset:51200
  v_mfma_f32_16x16x32_bf16 v[96:99], a[32:35], a[156:159], v[96:99]
  ds_read_b64_tr_b16 a[96:97], v128 offset:53248
  v_mfma_f32_16x16x32_bf16 v[4:7], a[36:39], a[132:135], v[4:7]
  v_mfma_f32_16x16x32_bf16 v[36:39], a[36:39], a[140:143], v[36:39]
  ds_read_b64_tr_b16 a[98:99], v128 offset:54272
  v_mfma_f32_16x16x32_bf16 v[68:71], a[36:39], a[148:151], v[68:71]
  ds_read_b64_tr_b16 a[100:101], v128 offset:53256
  v_mfma_f32_16x16x32_bf16 v[100:103], a[36:39], a[156:159], v[100:103]
  ds_read_b64_tr_b16 a[102:103], v128 offset:54280
  v_mfma_f32_16x16x32_bf16 v[8:11], a[40:43], a[132:135], v[8:11]
  v_mfma_f32_16x16x32_bf16 v[40:43], a[40:43], a[140:143], v[40:43]
  ds_read_b64_tr_b16 a[104:105], v129 offset:53248
  v_mfma_f32_16x16x32_bf16 v[72:75], a[40:43], a[148:151], v[72:75]
  ds_read_b64_tr_b16 a[106:107], v129 offset:54272
  v_mfma_f32_16x16x32_bf16 v[104:107], a[40:43], a[156:159], v[104:107]
  v_mfma_f32_16x16x32_bf16 v[12:15], a[44:47], a[132:135], v[12:15]
  ds_read_b64_tr_b16 a[108:109], v129 offset:53256
  v_mfma_f32_16x16x32_bf16 v[44:47], a[44:47], a[140:143], v[44:47]
  ds_read_b64_tr_b16 a[110:111], v129 offset:54280
  v_mfma_f32_16x16x32_bf16 v[76:79], a[44:47], a[148:151], v[76:79]
  ds_read_b64_tr_b16 a[112:113], v130 offset:53248
  v_mfma_f32_16x16x32_bf16 v[108:111], a[44:47], a[156:159], v[108:111]
  v_mfma_f32_16x16x32_bf16 v[16:19], a[48:51], a[132:135], v[16:19]
  ds_read_b64_tr_b16 a[114:115], v130 offset:54272
  v_mfma_f32_16x16x32_bf16 v[48:51], a[48:51], a[140:143], v[48:51]
  ds_read_b64_tr_b16 a[116:117], v130 offset:53256
  v_mfma_f32_16x16x32_bf16 v[80:83], a[48:51], a[148:151], v[80:83]
  v_mfma_f32_16x16x32_bf16 v[112:115], a[48:51], a[156:159], v[112:115]
  ds_read_b64_tr_b16 a[118:119], v130 offset:54280
  v_mfma_f32_16x16x32_bf16 v[20:23], a[52:55], a[132:135], v[20:23]
  ds_read_b64_tr_b16 a[120:121], v131 offset:53248
  v_mfma_f32_16x16x32_bf16 v[52:55], a[52:55], a[140:143], v[52:55]
  ds_read_b64_tr_b16 a[122:123], v131 offset:54272
  v_mfma_f32_16x16x32_bf16 v[84:87], a[52:55], a[148:151], v[84:87]
  v_mfma_f32_16x16x32_bf16 v[116:119], a[52:55], a[156:159], v[116:119]
  ds_read_b64_tr_b16 a[124:125], v131 offset:53256
  v_mfma_f32_16x16x32_bf16 v[24:27], a[56:59], a[132:135], v[24:27]
  ds_read_b64_tr_b16 a[126:127], v131 offset:54280
  v_mfma_f32_16x16x32_bf16 v[56:59], a[56:59], a[140:143], v[56:59]
  v_mfma_f32_16x16x32_bf16 v[88:91], a[56:59], a[148:151], v[88:91]
  v_mfma_f32_16x16x32_bf16 v[120:123], a[56:59], a[156:159], v[120:123]
  v_mfma_f32_16x16x32_bf16 v[28:31], a[60:63], a[132:135], v[28:31]
  v_mfma_f32_16x16x32_bf16 v[60:63], a[60:63], a[140:143], v[60:63]
  v_mfma_f32_16x16x32_bf16 v[92:95], a[60:63], a[148:151], v[92:95]
  v_mfma_f32_16x16x32_bf16 v[124:127], a[60:63], a[156:159], v[124:127]
  s_mov_b32 s42, 0x3e0293ee
  s_waitcnt lgkmcnt(0)
  v_mfma_f32_16x16x32_bf16 v[0:3], a[64:67], a[160:163], v[0:3]
  v_mfma_f32_16x16x32_bf16 v[0:3], a[96:99], a[164:167], v[0:3]
  v_mfma_f32_16x16x32_bf16 v[4:7], a[68:71], a[160:163], v[4:7]
  v_mfma_f32_16x16x32_bf16 v[4:7], a[100:103], a[164:167], v[4:7]
  v_mfma_f32_16x16x32_bf16 v[8:11], a[72:75], a[160:163], v[8:11]
  v_mfma_f32_16x16x32_bf16 v[8:11], a[104:107], a[164:167], v[8:11]
  v_mfma_f32_16x16x32_bf16 v[12:15], a[76:79], a[160:163], v[12:15]
  v_mfma_f32_16x16x32_bf16 v[12:15], a[108:111], a[164:167], v[12:15]
  v_mfma_f32_16x16x32_bf16 v[16:19], a[80:83], a[160:163], v[16:19]
  v_mul_f32 v0, s42, v0
  v_mul_f32 v1, s42, v1
  v_mfma_f32_16x16x32_bf16 v[16:19], a[112:115], a[164:167], v[16:19]
  v_mul_f32 v2, s42, v2
  v_mul_f32 v3, s42, v3
  v_mfma_f32_16x16x32_bf16 v[20:23], a[84:87], a[160:163], v[20:23]
  v_mul_f32 v4, s42, v4
  v_mul_f32 v5, s42, v5
  v_mfma_f32_16x16x32_bf16 v[20:23], a[116:119], a[164:167], v[20:23]
  v_mul_f32 v6, s42, v6
  v_mul_f32 v7, s42, v7
  v_mfma_f32_16x16x32_bf16 v[24:27], a[88:91], a[160:163], v[24:27]
  v_cvt_pk_bf16_f32 v0, v0, v1
  v_cvt_pk_bf16_f32 v2, v2, v3
  v_mfma_f32_16x16x32_bf16 v[24:27], a[120:123], a[164:167], v[24:27]
  v_cvt_pk_bf16_f32 v4, v4, v5
  v_cvt_pk_bf16_f32 v6, v6, v7
  v_mfma_f32_16x16x32_bf16 v[28:31], a[92:95], a[160:163], v[28:31]
  v_accvgpr_write_b32 a128, v0
  v_accvgpr_write_b32 a129, v2
  v_mfma_f32_16x16x32_bf16 v[28:31], a[124:127], a[164:167], v[28:31]
  v_accvgpr_write_b32 a130, v4
  v_accvgpr_write_b32 a131, v6
  v_mfma_f32_16x16x32_bf16 v[32:35], a[64:67], a[168:171], v[32:35]
  v_mul_f32 v8, s42, v8
  v_mul_f32 v9, s42, v9
  v_mfma_f32_16x16x32_bf16 v[32:35], a[96:99], a[172:175], v[32:35]
  v_mul_f32 v10, s42, v10
  v_mul_f32 v11, s42, v11
  v_mfma_f32_16x16x32_bf16 v[36:39], a[68:71], a[168:171], v[36:39]
  v_mul_f32 v12, s42, v12
  v_mul_f32 v13, s42, v13
  v_mfma_f32_16x16x32_bf16 v[36:39], a[100:103], a[172:175], v[36:39]
  v_mul_f32 v14, s42, v14
  v_mul_f32 v15, s42, v15
  v_mfma_f32_16x16x32_bf16 v[40:43], a[72:75], a[168:171], v[40:43]
  v_cvt_pk_bf16_f32 v8, v8, v9
  v_cvt_pk_bf16_f32 v10, v10, v11
  v_mfma_f32_16x16x32_bf16 v[40:43], a[104:107], a[172:175], v[40:43]
  v_cvt_pk_bf16_f32 v12, v12, v13
  v_cvt_pk_bf16_f32 v14, v14, v15
  v_mfma_f32_16x16x32_bf16 v[44:47], a[76:79], a[168:171], v[44:47]
  v_accvgpr_write_b32 a132, v8
  v_accvgpr_write_b32 a133, v10
  v_mfma_f32_16x16x32_bf16 v[44:47], a[108:111], a[172:175], v[44:47]
  v_accvgpr_write_b32 a134, v12
  v_accvgpr_write_b32 a135, v14
  v_mfma_f32_16x16x32_bf16 v[48:51], a[80:83], a[168:171], v[48:51]
  v_mul_f32 v16, s42, v16
  v_mul_f32 v17, s42, v17
  v_mfma_f32_16x16x32_bf16 v[48:51], a[112:115], a[172:175], v[48:51]
  v_mul_f32 v18, s42, v18
  v_mul_f32 v19, s42, v19
  v_mfma_f32_16x16x32_bf16 v[52:55], a[84:87], a[168:171], v[52:55]
  v_mul_f32 v20, s42, v20
  v_mul_f32 v21, s42, v21
  v_mfma_f32_16x16x32_bf16 v[52:55], a[116:119], a[172:175], v[52:55]
  v_mul_f32 v22, s42, v22
  v_mul_f32 v23, s42, v23
  v_mfma_f32_16x16x32_bf16 v[56:59], a[88:91], a[168:171], v[56:59]
  v_cvt_pk_bf16_f32 v16, v16, v17
  v_cvt_pk_bf16_f32 v18, v18, v19
  v_mfma_f32_16x16x32_bf16 v[56:59], a[120:123], a[172:175], v[56:59]
  v_cvt_pk_bf16_f32 v20, v20, v21
  v_cvt_pk_bf16_f32 v22, v22, v23
  v_mfma_f32_16x16x32_bf16 v[60:63], a[92:95], a[168:171], v[60:63]
  v_accvgpr_write_b32 a136, v16
  v_accvgpr_write_b32 a137, v18
  v_mfma_f32_16x16x32_bf16 v[60:63], a[124:127], a[172:175], v[60:63]
  v_accvgpr_write_b32 a138, v20
  v_accvgpr_write_b32 a139, v22
  v_mfma_f32_16x16x32_bf16 v[64:67], a[64:67], a[176:179], v[64:67]
  v_mul_f32 v24, s42, v24
  v_mul_f32 v25, s42, v25
  v_mfma_f32_16x16x32_bf16 v[64:67], a[96:99], a[180:183], v[64:67]
  v_mul_f32 v26, s42, v26
  v_mul_f32 v27, s42, v27
  v_mfma_f32_16x16x32_bf16 v[68:71], a[68:71], a[176:179], v[68:71]
  v_mul_f32 v28, s42, v28
  v_mul_f32 v29, s42, v29
  v_mfma_f32_16x16x32_bf16 v[68:71], a[100:103], a[180:183], v[68:71]
  v_mul_f32 v30, s42, v30
  v_mul_f32 v31, s42, v31
  v_mfma_f32_16x16x32_bf16 v[72:75], a[72:75], a[176:179], v[72:75]
  v_cvt_pk_bf16_f32 v24, v24, v25
  v_cvt_pk_bf16_f32 v26, v26, v27
  v_mfma_f32_16x16x32_bf16 v[72:75], a[104:107], a[180:183], v[72:75]
  v_cvt_pk_bf16_f32 v28, v28, v29
  v_cvt_pk_bf16_f32 v30, v30, v31
  v_mfma_f32_16x16x32_bf16 v[76:79], a[76:79], a[176:179], v[76:79]
  v_accvgpr_write_b32 a140, v24
  v_accvgpr_write_b32 a141, v26
  v_mfma_f32_16x16x32_bf16 v[76:79], a[108:111], a[180:183], v[76:79]
  v_accvgpr_write_b32 a142, v28
  v_accvgpr_write_b32 a143, v30
  v_mfma_f32_16x16x32_bf16 v[80:83], a[80:83], a[176:179], v[80:83]
  v_mul_f32 v32, s42, v32
  v_mul_f32 v33, s42, v33
  v_mfma_f32_16x16x32_bf16 v[80:83], a[112:115], a[180:183], v[80:83]
  v_mul_f32 v34, s42, v34
  v_mul_f32 v35, s42, v35
  v_mfma_f32_16x16x32_bf16 v[84:87], a[84:87], a[176:179], v[84:87]
  v_mul_f32 v36, s42, v36
  v_mul_f32 v37, s42, v37
  v_mfma_f32_16x16x32_bf16 v[84:87], a[116:119], a[180:183], v[84:87]
  v_mul_f32 v38, s42, v38
  v_mul_f32 v39, s42, v39
  v_mfma_f32_16x16x32_bf16 v[88:91], a[88:91], a[176:179], v[88:91]
  v_cvt_pk_bf16_f32 v32, v32, v33
  v_cvt_pk_bf16_f32 v34, v34, v35
  v_mfma_f32_16x16x32_bf16 v[88:91], a[120:123], a[180:183], v[88:91]
  v_cvt_pk_bf16_f32 v36, v36, v37
  v_cvt_pk_bf16_f32 v38, v38, v39
  v_mfma_f32_16x16x32_bf16 v[92:95], a[92:95], a[176:179], v[92:95]
  v_accvgpr_write_b32 a144, v32
  v_accvgpr_write_b32 a145, v34
  v_mfma_f32_16x16x32_bf16 v[92:95], a[124:127], a[180:183], v[92:95]
  v_accvgpr_write_b32 a146, v36
  v_accvgpr_write_b32 a147, v38
  v_mfma_f32_16x16x32_bf16 v[96:99], a[64:67], a[184:187], v[96:99]
  v_mul_f32 v40, s42, v40
  v_mul_f32 v41, s42, v41
  v_mfma_f32_16x16x32_bf16 v[96:99], a[96:99], a[188:191], v[96:99]
  v_mul_f32 v42, s42, v42
  v_mul_f32 v43, s42, v43
  v_mfma_f32_16x16x32_bf16 v[100:103], a[68:71], a[184:187], v[100:103]
  v_mul_f32 v44, s42, v44
  v_mul_f32 v45, s42, v45
  v_mfma_f32_16x16x32_bf16 v[100:103], a[100:103], a[188:191], v[100:103]
  v_mul_f32 v46, s42, v46
  v_mul_f32 v47, s42, v47
  v_mfma_f32_16x16x32_bf16 v[104:107], a[72:75], a[184:187], v[104:107]
  v_cvt_pk_bf16_f32 v40, v40, v41
  v_cvt_pk_bf16_f32 v42, v42, v43
  v_mfma_f32_16x16x32_bf16 v[104:107], a[104:107], a[188:191], v[104:107]
  v_cvt_pk_bf16_f32 v44, v44, v45
  v_cvt_pk_bf16_f32 v46, v46, v47
  v_mfma_f32_16x16x32_bf16 v[108:111], a[76:79], a[184:187], v[108:111]
  v_accvgpr_write_b32 a148, v40
  v_accvgpr_write_b32 a149, v42
  v_mfma_f32_16x16x32_bf16 v[108:111], a[108:111], a[188:191], v[108:111]
  v_accvgpr_write_b32 a150, v44
  v_accvgpr_write_b32 a151, v46
  v_mfma_f32_16x16x32_bf16 v[112:115], a[80:83], a[184:187], v[112:115]
  v_mul_f32 v48, s42, v48
  v_mul_f32 v49, s42, v49
  v_mfma_f32_16x16x32_bf16 v[112:115], a[112:115], a[188:191], v[112:115]
  v_mul_f32 v50, s42, v50
  v_mul_f32 v51, s42, v51
  s_barrier
  v_mfma_f32_16x16x32_bf16 v[116:119], a[84:87], a[184:187], v[116:119]
  ds_read_b128 a[192:195], v240 offset:40960
  ds_read_b128 a[196:199], v241 offset:40960
  v_mul_f32 v52, s42, v52
  v_mul_f32 v53, s42, v53
  v_mfma_f32_16x16x32_bf16 v[116:119], a[116:119], a[188:191], v[116:119]
  ds_read_b128 a[200:203], v242 offset:40960
  ds_read_b128 a[204:207], v243 offset:40960
  v_mul_f32 v54, s42, v54
  v_mul_f32 v55, s42, v55
  v_mfma_f32_16x16x32_bf16 v[120:123], a[88:91], a[184:187], v[120:123]
  ds_read_b128 a[208:211], v240 offset:45056
  ds_read_b128 a[212:215], v241 offset:45056
  v_cvt_pk_bf16_f32 v48, v48, v49
  v_cvt_pk_bf16_f32 v50, v50, v51
  v_mfma_f32_16x16x32_bf16 v[120:123], a[120:123], a[188:191], v[120:123]
  ds_read_b128 a[216:219], v242 offset:45056
  ds_read_b128 a[220:223], v243 offset:45056
  v_cvt_pk_bf16_f32 v52, v52, v53
  v_cvt_pk_bf16_f32 v54, v54, v55
  v_mfma_f32_16x16x32_bf16 v[124:127], a[92:95], a[184:187], v[124:127]
  v_accvgpr_write_b32 a152, v48
  v_accvgpr_write_b32 a153, v50
  v_mfma_f32_16x16x32_bf16 v[124:127], a[124:127], a[188:191], v[124:127]
  v_accvgpr_write_b32 a154, v52
  v_accvgpr_write_b32 a155, v54
  v_mfma_f32_32x32x16_bf16 v[0:15], v[192:195], v[192:195], 0
  v_mul_f32 v56, s42, v56
  v_mul_f32 v57, s42, v57
  v_mul_f32 v58, s42, v58
  v_mul_f32 v59, s42, v59
  v_mul_f32 v60, s42, v60
  v_mul_f32 v61, s42, v61
  v_mul_f32 v62, s42, v62
  v_mul_f32 v63, s42, v63
  v_mfma_f32_32x32x16_bf16 v[16:31], v[192:195], v[192:195], 0
  v_cvt_pk_bf16_f32 v56, v56, v57
  v_cvt_pk_bf16_f32 v58, v58, v59
  v_cvt_pk_bf16_f32 v60, v60, v61
  v_cvt_pk_bf16_f32 v62, v62, v63
  v_accvgpr_write_b32 a156, v56
  v_accvgpr_write_b32 a157, v58
  v_accvgpr_write_b32 a158, v60
  v_accvgpr_write_b32 a159, v62
  v_mfma_f32_32x32x16_bf16 v[32:47], v[192:195], v[192:195], 0
  v_mul_f32 v64, s42, v64
  v_mul_f32 v65, s42, v65
  v_mul_f32 v66, s42, v66
  v_mul_f32 v67, s42, v67
  v_mul_f32 v68, s42, v68
  v_mul_f32 v69, s42, v69
  v_mul_f32 v70, s42, v70
  v_mul_f32 v71, s42, v71
  v_mfma_f32_32x32x16_bf16 v[48:63], v[192:195], v[192:195], 0
  v_cvt_pk_bf16_f32 v64, v64, v65
  v_cvt_pk_bf16_f32 v66, v66, v67
  v_cvt_pk_bf16_f32 v68, v68, v69
  v_cvt_pk_bf16_f32 v70, v70, v71
  v_mul_f32 v72, s42, v72
  v_mul_f32 v73, s42, v73
  v_mul_f32 v74, s42, v74
  v_mul_f32 v75, s42, v75
  s_waitcnt lgkmcnt(0)
  v_mfma_f32_16x16x32_bf16 v[128:131], a[192:195], a[128:131], 0
  v_mul_f32 v76, s42, v76
  v_mul_f32 v77, s42, v77
  v_mfma_f32_16x16x32_bf16 v[136:139], a[192:195], a[144:147], 0
  v_mul_f32 v78, s42, v78
  v_mul_f32 v79, s42, v79
  v_mfma_f32_16x16x32_bf16 v[128:131], a[196:199], a[132:135], v[128:131]
  v_cvt_pk_bf16_f32 v72, v72, v73
  v_cvt_pk_bf16_f32 v74, v74, v75
  v_mfma_f32_16x16x32_bf16 v[136:139], a[196:199], a[148:151], v[136:139]
  v_cvt_pk_bf16_f32 v76, v76, v77
  v_cvt_pk_bf16_f32 v78, v78, v79
  v_mfma_f32_16x16x32_bf16 v[128:131], a[200:203], a[136:139], v[128:131]
  v_mul_f32 v80, s42, v80
  v_mul_f32 v81, s42, v81
  v_mfma_f32_16x16x32_bf16 v[136:139], a[200:203], a[152:155], v[136:139]
  v_mul_f32 v82, s42, v82
  v_mul_f32 v83, s42, v83
  v_mfma_f32_16x16x32_bf16 v[128:131], a[204:207], a[140:143], v[128:131]
  v_mul_f32 v84, s42, v84
  v_mul_f32 v85, s42, v85
  v_mfma_f32_16x16x32_bf16 v[136:139], a[204:207], a[156:159], v[136:139]
  v_mul_f32 v86, s42, v86
  v_mul_f32 v87, s42, v87
  v_mfma_f32_16x16x32_bf16 v[132:135], a[208:211], a[128:131], 0
  v_cvt_pk_bf16_f32 v80, v80, v81
  v_cvt_pk_bf16_f32 v82, v82, v83
  v_mfma_f32_16x16x32_bf16 v[140:143], a[208:211], a[144:147], 0
  v_cvt_pk_bf16_f32 v84, v84, v85
  v_cvt_pk_bf16_f32 v86, v86, v87
  v_mfma_f32_16x16x32_bf16 v[132:135], a[212:215], a[132:135], v[132:135]
  v_mul_f32 v88, s42, v88
  v_mul_f32 v89, s42, v89
  v_mfma_f32_16x16x32_bf16 v[140:143], a[212:215], a[148:151], v[140:143]
  v_mul_f32 v90, s42, v90
  v_mul_f32 v91, s42, v91
  v_mfma_f32_16x16x32_bf16 v[132:135], a[216:219], a[136:139], v[132:135]
  v_mul_f32 v92, s42, v92
  v_mul_f32 v93, s42, v93
  v_mfma_f32_16x16x32_bf16 v[140:143], a[216:219], a[152:155], v[140:143]
  v_mul_f32 v94, s42, v94
  v_mul_f32 v95, s42, v95
  v_mfma_f32_16x16x32_bf16 v[132:135], a[220:223], a[140:143], v[132:135]
  v_cvt_pk_bf16_f32 v88, v88, v89
  v_cvt_pk_bf16_f32 v90, v90, v91
  v_mfma_f32_16x16x32_bf16 v[140:143], a[220:223], a[156:159], v[140:143]
  v_cvt_pk_bf16_f32 v92, v92, v93
  v_cvt_pk_bf16_f32 v94, v94, v95
  v_mul_f32 v96, s42, v96
  v_mul_f32 v97, s42, v97
  v_mul_f32 v98, s42, v98
  v_mul_f32 v99, s42, v99
  v_mul_f32 v100, s42, v100
  v_mul_f32 v101, s42, v101
  v_mul_f32 v102, s42, v102
  v_mul_f32 v103, s42, v103
  v_cvt_pk_bf16_f32 v96, v96, v97
  v_cvt_pk_bf16_f32 v98, v98, v99
  v_cvt_pk_bf16_f32 v100, v100, v101
  v_cvt_pk_bf16_f32 v102, v102, v103
  v_mul_f32 v104, s42, v104
  v_mul_f32 v105, s42, v105
  v_mul_f32 v106, s42, v106
  v_mul_f32 v107, s42, v107
  v_mul_f32 v108, s42, v108
  v_mul_f32 v109, s42, v109
  v_mul_f32 v110, s42, v110
  v_mul_f32 v111, s42, v111
  v_cvt_pk_bf16_f32 v104, v104, v105
  v_cvt_pk_bf16_f32 v106, v106, v107
  v_cvt_pk_bf16_f32 v108, v108, v109
  v_cvt_pk_bf16_f32 v110, v110, v111
  v_mul_f32 v112, s42, v112
  v_mul_f32 v113, s42, v113
  v_mul_f32 v114, s42, v114
  v_mul_f32 v115, s42, v115
  v_mul_f32 v116, s42, v116
  v_mul_f32 v117, s42, v117
  v_mul_f32 v118, s42, v118
  v_mul_f32 v119, s42, v119
  v_cvt_pk_bf16_f32 v112, v112, v113
  v_cvt_pk_bf16_f32 v114, v114, v115
  v_cvt_pk_bf16_f32 v116, v116, v117
  v_cvt_pk_bf16_f32 v118, v118, v119
  v_mul_f32 v120, s42, v120
  v_mul_f32 v121, s42, v121
  v_mul_f32 v122, s42, v122
  v_mul_f32 v123, s42, v123
  v_mul_f32 v124, s42, v124
  v_mul_f32 v125, s42, v125
  v_mul_f32 v126, s42, v126
  v_mul_f32 v127, s42, v127
  v_cvt_pk_bf16_f32 v120, v120, v121
  v_cvt_pk_bf16_f32 v122, v122, v123
  v_cvt_pk_bf16_f32 v124, v124, v125
  v_cvt_pk_bf16_f32 v126, v126, v127
  v_accvgpr_write_b32 a160, v64
  v_accvgpr_write_b32 a161, v66
  v_accvgpr_write_b32 a162, v68
  v_accvgpr_write_b32 a163, v70
  v_accvgpr_write_b32 a164, v72
  v_accvgpr_write_b32 a165, v74
  v_accvgpr_write_b32 a166, v76
  v_accvgpr_write_b32 a167, v78
  v_mfma_f32_32x32x16_bf16 v[64:79], v[192:195], v[192:195], 0
  v_accvgpr_write_b32 a168, v80
  v_accvgpr_write_b32 a169, v82
  v_accvgpr_write_b32 a170, v84
  v_accvgpr_write_b32 a171, v86
  v_accvgpr_write_b32 a172, v88
  v_accvgpr_write_b32 a173, v90
  v_accvgpr_write_b32 a174, v92
  v_accvgpr_write_b32 a175, v94
  v_mfma_f32_32x32x16_bf16 v[80:95], v[192:195], v[192:195], 0
  v_accvgpr_write_b32 a176, v96
  v_accvgpr_write_b32 a177, v98
  v_accvgpr_write_b32 a178, v100
  v_accvgpr_write_b32 a179, v102
  v_accvgpr_write_b32 a180, v104
  v_accvgpr_write_b32 a181, v106
  v_accvgpr_write_b32 a182, v108
  v_accvgpr_write_b32 a183, v110
  v_mfma_f32_32x32x16_bf16 v[96:111], v[192:195], v[192:195], 0
  v_accvgpr_write_b32 a184, v112
  v_accvgpr_write_b32 a185, v114
  v_accvgpr_write_b32 a186, v116
  v_accvgpr_write_b32 a187, v118
  v_accvgpr_write_b32 a188, v120
  v_accvgpr_write_b32 a189, v122
  v_accvgpr_write_b32 a190, v124
  v_accvgpr_write_b32 a191, v126
  v_mfma_f32_32x32x16_bf16 v[112:127], v[192:195], v[192:195], 0
  s_mov_b32 s60, s28
  s_mov_b32 s61, s29
  s_mov_b32 s62, 0x10000000
  s_mov_b32 s63, 0x20000
  s_mov_b32 s64, s24
  s_mov_b32 s65, s25
  s_mov_b32 s66, 1835008
  s_mov_b32 s67, 0x20000
  v_lshlrev_b32 v204, 4, v255
  s_lshl_b32 s38, s30, 14
  v_add_u32 v204, s38, v204
  v_subrev_u32 v192, 98304, v244
  v_add_u32 v205, 65536, v192
  v_subrev_u32 v193, 98304, v245
  v_add_u32 v206, 65536, v193
  v_subrev_u32 v194, 98304, v246
  v_add_u32 v207, 65536, v194
  v_subrev_u32 v195, 98304, v247
  v_add_u32 v208, 65536, v195
  v_subrev_u32 v196, 98304, v248
  v_add_u32 v209, 65536, v196
  v_subrev_u32 v197, 98304, v249
  v_add_u32 v210, 65536, v197
  v_subrev_u32 v198, 98304, v250
  v_add_u32 v211, 65536, v198
  v_subrev_u32 v199, 98304, v251
  v_add_u32 v212, 65536, v199
  s_lshl_b32 s76, s2, 16
  s_add_u32 s77, s76, 0x1200000
  s_add_u32 s76, s76, 0x100000
  s_add_u32 s38, s33, 1
  s_and_b32 s38, s38, 3
  s_lshl_b32 s38, s38, 3
  s_andn2_b32 s39, s2, 24
  s_or_b32 s38, s38, s39
  s_lshl_b32 s38, s38, 16
  s_add_u32 s78, s38, 0x100000
  s_add_u32 s38, s33, 2
  s_and_b32 s38, s38, 3
  s_lshl_b32 s38, s38, 3
  s_andn2_b32 s39, s2, 24
  s_or_b32 s38, s38, s39
  s_lshl_b32 s38, s38, 16
  s_add_u32 s79, s38, 0x100000
  s_add_u32 s38, s33, 3
  s_and_b32 s38, s38, 3
  s_lshl_b32 s38, s38, 3
  s_andn2_b32 s39, s2, 24
  s_or_b32 s38, s38, s39
  s_lshl_b32 s38, s38, 16
  s_add_u32 s80, s38, 0x100000
  s_andn2_b32 s38, s2, 7
  v_add_u32 v224, s38, v255
  v_lshlrev_b32 v224, 7, v224
  s_lshl_b32 s38, s38, 16
  s_lshr_b32 s39, s34, 1
  s_lshl_b32 s39, s39, 14
  s_add_u32 s38, s38, s39
  s_and_b32 s39, s34, 1
  s_lshl_b32 s39, s39, 11
  s_add_u32 s38, s38, s39
  s_lshr_b32 s39, s30, 1
  s_lshl_b32 s39, s39, 12
  s_add_u32 s38, s38, s39
  s_and_b32 s39, s30, 1
  s_lshl_b32 s39, s39, 10
  s_add_u32 s38, s38, s39
  s_add_u32 s81, s38, 0x1200000
  s_mul_i32 s82, s31, 229376
  s_lshr_b32 s39, s34, 1
  s_lshl_b32 s39, s39, 16
  s_add_u32 s82, s82, s39
  s_lshr_b32 s39, s30, 1
  s_lshl_b32 s39, s39, 14
  s_add_u32 s82, s82, s39
  s_lshl_b32 s39, s33, 8
  s_add_u32 s82, s82, s39
  s_and_b32 s39, s34, 1
  s_lshl_b32 s39, s39, 7
  s_add_u32 s82, s82, s39
  s_and_b32 s39, s30, 1
  s_lshl_b32 s39, s39, 6
  s_add_u32 s82, s82, s39
  v_and_b32 v225, 15, v255
  v_lshlrev_b32 v225, 10, v225
  v_bfe_u32 v226, v255, 4, 1
  v_lshl_add_u32 v225, v226, 5, v225
  v_lshrrev_b32 v226, 5, v255
  v_lshl_add_u32 v225, v226, 4, v225
  v_lshlrev_b32 v226, 4, v255
  s_mov_b32 s83, 0x3f80
  s_mov_b32 s84, 0x3f800000
  s_lshl_b32 s86, s87, 12
  s_add_u32 m0, s91, s86
  s_lshl_b32 s86, s87, 14
  s_add_u32 s86, s86, s90
  buffer_load_dwordx4 v234, s[20:23], s86 offen offset:0 lds
  buffer_load_dwordx4 v235, s[20:23], s86 offen offset:1024 lds
  buffer_load_dwordx4 v236, s[20:23], s86 offen offset:2048 lds
  buffer_load_dwordx4 v237, s[20:23], s86 offen offset:3072 lds
  s_add_u32 s87, s87, 1
  s_and_b32 s87, s87, 7
  v_exp_f32 v128, v128
  s_nop 0
  v_add_f32 v238, v128, v238
  v_exp_f32 v129, v129
  s_nop 0
  v_add_f32 v238, v129, v238
  v_exp_f32 v130, v130
  s_nop 0
  v_add_f32 v238, v130, v238
  v_exp_f32 v131, v131
  s_nop 0
  v_add_f32 v238, v131, v238
  v_exp_f32 v132, v132
  s_nop 0
  v_add_f32 v238, v132, v238
  v_exp_f32 v133, v133
  s_nop 0
  v_add_f32 v238, v133, v238
  v_exp_f32 v134, v134
  s_barrier
  v_mfma_f32_16x16x32_bf16 v[144:147], a[192:195], a[160:163], 0
  v_exp_f32 v135, v135
  v_mfma_f32_16x16x32_bf16 v[152:155], a[192:195], a[176:179], 0
  v_add_f32 v238, v135, v238
  v_cvt_pk_bf16_f32 v160, v128, v129
  v_mfma_f32_16x16x32_bf16 v[144:147], a[196:199], a[164:167], v[144:147]
  ds_read_b128 a[192:195], v240 offset:57344
  v_exp_f32 v136, v136
  v_mfma_f32_16x16x32_bf16 v[152:155], a[196:199], a[180:183], v[152:155]
  v_add_f32 v239, v136, v239
  v_cvt_pk_bf16_f32 v161, v130, v131
  v_mfma_f32_16x16x32_bf16 v[144:147], a[200:203], a[168:171], v[144:147]
  ds_read_b128 a[196:199], v241 offset:57344
  v_exp_f32 v137, v137
  v_mfma_f32_16x16x32_bf16 v[152:155], a[200:203], a[184:187], v[152:155]
  v_add_f32 v239, v137, v239
  v_cvt_pk_bf16_f32 v162, v132, v133
  v_mfma_f32_16x16x32_bf16 v[144:147], a[204:207], a[172:175], v[144:147]
  ds_read_b128 a[200:203], v242 offset:57344
  v_exp_f32 v138, v138
  v_mfma_f32_16x16x32_bf16 v[152:155], a[204:207], a[188:191], v[152:155]
  v_add_f32 v239, v138, v239
  v_cvt_pk_bf16_f32 v163, v134, v135
  v_mfma_f32_16x16x32_bf16 v[148:151], a[208:211], a[160:163], 0
  ds_read_b128 a[204:207], v243 offset:57344
  v_exp_f32 v139, v139
  v_mfma_f32_16x16x32_bf16 v[156:159], a[208:211], a[176:179], 0
  v_add_f32 v239, v139, v239
  v_cvt_pk_bf16_f32 v164, v136, v137
  v_mfma_f32_16x16x32_bf16 v[148:151], a[212:215], a[164:167], v[148:151]
  ds_read_b128 a[208:211], v240 offset:61440
  v_exp_f32 v140, v140
  v_mfma_f32_16x16x32_bf16 v[156:159], a[212:215], a[180:183], v[156:159]
  v_add_f32 v239, v140, v239
  v_cvt_pk_bf16_f32 v165, v138, v139
  v_mfma_f32_16x16x32_bf16 v[148:151], a[216:219], a[168:171], v[148:151]
  ds_read_b128 a[212:215], v241 offset:61440
  v_exp_f32 v141, v141
  v_mfma_f32_16x16x32_bf16 v[156:159], a[216:219], a[184:187], v[156:159]
  v_add_f32 v239, v141, v239
  v_cvt_pk_bf16_f32 v166, v140, v141
  v_mfma_f32_16x16x32_bf16 v[148:151], a[220:223], a[172:175], v[148:151]
  ds_read_b128 a[216:219], v242 offset:61440
  v_exp_f32 v142, v142
  v_mfma_f32_16x16x32_bf16 v[156:159], a[220:223], a[188:191], v[156:159]
  v_add_f32 v238, v134, v238
  v_add_f32 v239, v142, v239
  ds_read_b128 a[220:223], v243 offset:61440
  v_exp_f32 v143, v143
  s_nop 0
  v_add_f32 v239, v143, v239
  v_cvt_pk_bf16_f32 v167, v142, v143
  ds_read_b64_tr_b16 a[224:225], v244 offset:49152
  ds_read_b64_tr_b16 a[226:227], v244 offset:53248
  v_exp_f32 v144, v144
  s_nop 0
  v_add_f32 v222, v144, v222
  ds_read_b64_tr_b16 a[228:229], v245 offset:49152
  ds_read_b64_tr_b16 a[230:231], v245 offset:53248
  v_exp_f32 v145, v145
  s_nop 0
  v_add_f32 v222, v145, v222
  ds_read_b64_tr_b16 a[232:233], v246 offset:49152
  ds_read_b64_tr_b16 a[234:235], v246 offset:53248
  v_exp_f32 v146, v146
  s_nop 0
  v_add_f32 v222, v146, v222
  ds_read_b64_tr_b16 a[236:237], v247 offset:49152
  ds_read_b64_tr_b16 a[238:239], v247 offset:53248
  v_exp_f32 v147, v147
  s_nop 0
  v_add_f32 v222, v147, v222
  ds_read_b64_tr_b16 a[240:241], v248 offset:49152
  ds_read_b64_tr_b16 a[242:243], v248 offset:53248
  v_exp_f32 v148, v148
  s_nop 0
  v_add_f32 v222, v148, v222
  ds_read_b64_tr_b16 a[244:245], v249 offset:49152
  ds_read_b64_tr_b16 a[246:247], v249 offset:53248
  v_exp_f32 v149, v149
  s_nop 0
  v_add_f32 v222, v149, v222
  ds_read_b64_tr_b16 a[248:249], v250 offset:49152
  ds_read_b64_tr_b16 a[250:251], v250 offset:53248
  v_exp_f32 v150, v150
  ds_read_b64_tr_b16 a[252:253], v251 offset:49152
  ds_read_b64_tr_b16 a[254:255], v251 offset:53248
  s_mov_b32 s37, 0
.p2align 4
L_attn_CW:
  s_waitcnt lgkmcnt(15)
  v_mfma_f32_16x16x32_bf16 v[128:131], a[192:195], a[128:131], 0
  v_exp_f32 v151, v151
  v_mfma_f32_16x16x32_bf16 v[136:139], a[192:195], a[144:147], 0
  v_add_f32 v222, v150, v222
  v_cvt_pk_bf16_f32 v168, v144, v145
  v_mfma_f32_16x16x32_bf16 v[128:131], a[196:199], a[132:135], v[128:131]
  s_lshl_b32 s86, s87, 12
  s_add_u32 m0, s91, s86
  s_lshl_b32 s86, s87, 14
  s_add_u32 s86, s86, s90
  v_exp_f32 v152, v152
  v_mfma_f32_16x16x32_bf16 v[136:139], a[196:199], a[148:151], v[136:139]
  v_add_f32 v222, v151, v222
  v_cvt_pk_bf16_f32 v169, v146, v147
  v_mfma_f32_16x16x32_bf16 v[128:131], a[200:203], a[136:139], v[128:131]
  buffer_load_dwordx4 v234, s[20:23], s86 offen offset:0 lds
  buffer_load_dwordx4 v235, s[20:23], s86 offen offset:1024 lds
  buffer_load_dwordx4 v236, s[20:23], s86 offen offset:2048 lds
  v_exp_f32 v153, v153
  v_mfma_f32_16x16x32_bf16 v[136:139], a[200:203], a[152:155], v[136:139]
  v_add_f32 v223, v152, v223
  v_cvt_pk_bf16_f32 v170, v148, v149
  v_mfma_f32_16x16x32_bf16 v[128:131], a[204:207], a[140:143], v[128:131]
  buffer_load_dwordx4 v237, s[20:23], s86 offen offset:3072 lds
  s_add_u32 s87, s87, 1
  s_and_b32 s87, s87, 7
  v_exp_f32 v154, v154
  v_mfma_f32_16x16x32_bf16 v[136:139], a[204:207], a[156:159], v[136:139]
  v_add_f32 v223, v153, v223
  v_cvt_pk_bf16_f32 v171, v150, v151
  v_mfma_f32_16x16x32_bf16 v[132:135], a[208:211], a[128:131], 0
  v_exp_f32 v155, v155
  v_mfma_f32_16x16x32_bf16 v[140:143], a[208:211], a[144:147], 0
  v_add_f32 v223, v154, v223
  v_cvt_pk_bf16_f32 v172, v152, v153
  v_mfma_f32_16x16x32_bf16 v[132:135], a[212:215], a[132:135], v[132:135]
  v_exp_f32 v156, v156
  v_mfma_f32_16x16x32_bf16 v[140:143], a[212:215], a[148:151], v[140:143]
  v_add_f32 v223, v155, v223
  v_cvt_pk_bf16_f32 v173, v154, v155
  v_mfma_f32_16x16x32_bf16 v[132:135], a[216:219], a[136:139], v[132:135]
  v_exp_f32 v157, v157
  v_mfma_f32_16x16x32_bf16 v[140:143], a[216:219], a[152:155], v[140:143]
  v_add_f32 v223, v156, v223
  v_cvt_pk_bf16_f32 v174, v156, v157
  v_mfma_f32_16x16x32_bf16 v[132:135], a[220:223], a[140:143], v[132:135]
  v_exp_f32 v158, v158
  v_mfma_f32_16x16x32_bf16 v[140:143], a[220:223], a[156:159], v[140:143]
  v_add_f32 v223, v157, v223
  v_add_f32 v223, v158, v223
  s_waitcnt lgkmcnt(0)
  v_mfma_f32_16x16x32_bf16 v[0:3], a[224:227], v[160:163], v[0:3]
  v_exp_f32 v159, v159
  v_mfma_f32_16x16x32_bf16 v[32:35], a[224:227], v[164:167], v[32:35]
  v_add_f32 v223, v159, v223
  v_cvt_pk_bf16_f32 v175, v158, v159
  v_mfma_f32_16x16x32_bf16 v[4:7], a[228:231], v[160:163], v[4:7]
  v_exp_f32 v128, v128
  v_mfma_f32_16x16x32_bf16 v[36:39], a[228:231], v[164:167], v[36:39]
  v_add_f32 v238, v128, v238
  v_mfma_f32_16x16x32_bf16 v[8:11], a[232:235], v[160:163], v[8:11]
  v_exp_f32 v129, v129
  v_mfma_f32_16x16x32_bf16 v[40:43], a[232:235], v[164:167], v[40:43]
  v_add_f32 v238, v129, v238
  v_mfma_f32_16x16x32_bf16 v[12:15], a[236:239], v[160:163], v[12:15]
  v_exp_f32 v130, v130
  v_mfma_f32_16x16x32_bf16 v[44:47], a[236:239], v[164:167], v[44:47]
  v_add_f32 v238, v130, v238
  v_mfma_f32_16x16x32_bf16 v[16:19], a[240:243], v[160:163], v[16:19]
  v_exp_f32 v131, v131
  v_mfma_f32_16x16x32_bf16 v[48:51], a[240:243], v[164:167], v[48:51]
  v_add_f32 v238, v131, v238
  v_mfma_f32_16x16x32_bf16 v[20:23], a[244:247], v[160:163], v[20:23]
  v_exp_f32 v132, v132
  v_mfma_f32_16x16x32_bf16 v[52:55], a[244:247], v[164:167], v[52:55]
  v_add_f32 v238, v132, v238
  v_mfma_f32_16x16x32_bf16 v[24:27], a[248:251], v[160:163], v[24:27]
  v_exp_f32 v133, v133
  v_mfma_f32_16x16x32_bf16 v[56:59], a[248:251], v[164:167], v[56:59]
  v_add_f32 v238, v133, v238
  v_mfma_f32_16x16x32_bf16 v[28:31], a[252:255], v[160:163], v[28:31]
  v_exp_f32 v134, v134
  v_mfma_f32_16x16x32_bf16 v[60:63], a[252:255], v[164:167], v[60:63]
  s_barrier
  v_mfma_f32_16x16x32_bf16 v[144:147], a[192:195], a[160:163], 0
  v_exp_f32 v135, v135
  v_mfma_f32_16x16x32_bf16 v[152:155], a[192:195], a[176:179], 0
  v_add_f32 v238, v135, v238
  v_cvt_pk_bf16_f32 v160, v128, v129
  v_mfma_f32_16x16x32_bf16 v[144:147], a[196:199], a[164:167], v[144:147]
  ds_read_b128 a[192:195], v240 offset:24576
  v_exp_f32 v136, v136
  v_mfma_f32_16x16x32_bf16 v[152:155], a[196:199], a[180:183], v[152:155]
  v_add_f32 v239, v136, v239
  v_cvt_pk_bf16_f32 v161, v130, v131
  v_mfma_f32_16x16x32_bf16 v[144:147], a[200:203], a[168:171], v[144:147]
  ds_read_b128 a[196:199], v241 offset:24576
  v_exp_f32 v137, v137
  v_mfma_f32_16x16x32_bf16 v[152:155], a[200:203], a[184:187], v[152:155]
  v_add_f32 v239, v137, v239
  v_cvt_pk_bf16_f32 v162, v132, v133
  v_mfma_f32_16x16x32_bf16 v[144:147], a[204:207], a[172:175], v[144:147]
  ds_read_b128 a[200:203], v242 offset:24576
  v_exp_f32 v138, v138
  v_mfma_f32_16x16x32_bf16 v[152:155], a[204:207], a[188:191], v[152:155]
  v_add_f32 v239, v138, v239
  v_cvt_pk_bf16_f32 v163, v134, v135
  v_mfma_f32_16x16x32_bf16 v[148:151], a[208:211], a[160:163], 0
  ds_read_b128 a[204:207], v243 offset:24576
  v_exp_f32 v139, v139
  v_mfma_f32_16x16x32_bf16 v[156:159], a[208:211], a[176:179], 0
  v_add_f32 v239, v139, v239
  v_cvt_pk_bf16_f32 v164, v136, v137
  v_mfma_f32_16x16x32_bf16 v[148:151], a[212:215], a[164:167], v[148:151]
  ds_read_b128 a[208:211], v240 offset:28672
  v_exp_f32 v140, v140
  v_mfma_f32_16x16x32_bf16 v[156:159], a[212:215], a[180:183], v[156:159]
  v_add_f32 v239, v140, v239
  v_cvt_pk_bf16_f32 v165, v138, v139
  v_mfma_f32_16x16x32_bf16 v[148:151], a[216:219], a[168:171], v[148:151]
  ds_read_b128 a[212:215], v241 offset:28672
  v_exp_f32 v141, v141
  v_mfma_f32_16x16x32_bf16 v[156:159], a[216:219], a[184:187], v[156:159]
  v_add_f32 v239, v141, v239
  v_cvt_pk_bf16_f32 v166, v140, v141
  v_mfma_f32_16x16x32_bf16 v[148:151], a[220:223], a[172:175], v[148:151]
  ds_read_b128 a[216:219], v242 offset:28672
  v_exp_f32 v142, v142
  v_mfma_f32_16x16x32_bf16 v[156:159], a[220:223], a[188:191], v[156:159]
  v_add_f32 v238, v134, v238
  v_add_f32 v239, v142, v239
  v_mfma_f32_16x16x32_bf16 v[64:67], a[224:227], v[168:171], v[64:67]
  ds_read_b128 a[220:223], v243 offset:28672
  v_exp_f32 v143, v143
  v_mfma_f32_16x16x32_bf16 v[96:99], a[224:227], v[172:175], v[96:99]
  v_add_f32 v239, v143, v239
  v_cvt_pk_bf16_f32 v167, v142, v143
  v_mfma_f32_16x16x32_bf16 v[68:71], a[228:231], v[168:171], v[68:71]
  ds_read_b64_tr_b16 a[224:225], v244 offset:0
  ds_read_b64_tr_b16 a[226:227], v244 offset:4096
  v_exp_f32 v144, v144
  v_mfma_f32_16x16x32_bf16 v[100:103], a[228:231], v[172:175], v[100:103]
  v_add_f32 v222, v144, v222
  v_mfma_f32_16x16x32_bf16 v[72:75], a[232:235], v[168:171], v[72:75]
  ds_read_b64_tr_b16 a[228:229], v245 offset:0
  ds_read_b64_tr_b16 a[230:231], v245 offset:4096
  v_exp_f32 v145, v145
  v_mfma_f32_16x16x32_bf16 v[104:107], a[232:235], v[172:175], v[104:107]
  v_add_f32 v222, v145, v222
  v_mfma_f32_16x16x32_bf16 v[76:79], a[236:239], v[168:171], v[76:79]
  ds_read_b64_tr_b16 a[232:233], v246 offset:0
  ds_read_b64_tr_b16 a[234:235], v246 offset:4096
  v_exp_f32 v146, v146
  v_mfma_f32_16x16x32_bf16 v[108:111], a[236:239], v[172:175], v[108:111]
  v_add_f32 v222, v146, v222
  v_mfma_f32_16x16x32_bf16 v[80:83], a[240:243], v[168:171], v[80:83]
  ds_read_b64_tr_b16 a[236:237], v247 offset:0
  ds_read_b64_tr_b16 a[238:239], v247 offset:4096
  v_exp_f32 v147, v147
  v_mfma_f32_16x16x32_bf16 v[112:115], a[240:243], v[172:175], v[112:115]
  v_add_f32 v222, v147, v222
  v_mfma_f32_16x16x32_bf16 v[84:87], a[244:247], v[168:171], v[84:87]
  ds_read_b64_tr_b16 a[240:241], v248 offset:0
  ds_read_b64_tr_b16 a[242:243], v248 offset:4096
  v_exp_f32 v148, v148
  v_mfma_f32_16x16x32_bf16 v[116:119], a[244:247], v[172:175], v[116:119]
  v_add_f32 v222, v148, v222
  v_mfma_f32_16x16x32_bf16 v[88:91], a[248:251], v[168:171], v[88:91]
  ds_read_b64_tr_b16 a[244:245], v249 offset:0
  ds_read_b64_tr_b16 a[246:247], v249 offset:4096
  v_exp_f32 v149, v149
  v_mfma_f32_16x16x32_bf16 v[120:123], a[248:251], v[172:175], v[120:123]
  v_add_f32 v222, v149, v222
  v_mfma_f32_16x16x32_bf16 v[92:95], a[252:255], v[168:171], v[92:95]
  ds_read_b64_tr_b16 a[248:249], v250 offset:0
  ds_read_b64_tr_b16 a[250:251], v250 offset:4096
  v_exp_f32 v150, v150
  v_mfma_f32_16x16x32_bf16 v[124:127], a[252:255], v[172:175], v[124:127]
  ds_read_b64_tr_b16 a[252:253], v251 offset:0
  ds_read_b64_tr_b16 a[254:255], v251 offset:4096
  s_waitcnt lgkmcnt(15)
  v_mfma_f32_16x16x32_bf16 v[128:131], a[192:195], a[128:131], 0
  v_exp_f32 v151, v151
  v_mfma_f32_16x16x32_bf16 v[136:139], a[192:195], a[144:147], 0
  v_add_f32 v222, v150, v222
  v_cvt_pk_bf16_f32 v168, v144, v145
  v_mfma_f32_16x16x32_bf16 v[128:131], a[196:199], a[132:135], v[128:131]
  v_exp_f32 v152, v152
  v_mfma_f32_16x16x32_bf16 v[136:139], a[196:199], a[148:151], v[136:139]
  v_add_f32 v222, v151, v222
  v_cvt_pk_bf16_f32 v169, v146, v147
  v_mfma_f32_16x16x32_bf16 v[128:131], a[200:203], a[136:139], v[128:131]
  v_exp_f32 v153, v153
  v_mfma_f32_16x16x32_bf16 v[136:139], a[200:203], a[152:155], v[136:139]
  v_add_f32 v223, v152, v223
  v_cvt_pk_bf16_f32 v170, v148, v149
  v_mfma_f32_16x16x32_bf16 v[128:131], a[204:207], a[140:143], v[128:131]
  v_exp_f32 v154, v154
  v_mfma_f32_16x16x32_bf16 v[136:139], a[204:207], a[156:159], v[136:139]
  v_add_f32 v223, v153, v223
  v_cvt_pk_bf16_f32 v171, v150, v151
  v_mfma_f32_16x16x32_bf16 v[132:135], a[208:211], a[128:131], 0
  v_exp_f32 v155, v155
  v_mfma_f32_16x16x32_bf16 v[140:143], a[208:211], a[144:147], 0
  v_add_f32 v223, v154, v223
  v_cvt_pk_bf16_f32 v172, v152, v153
  v_mfma_f32_16x16x32_bf16 v[132:135], a[212:215], a[132:135], v[132:135]
  v_exp_f32 v156, v156
  v_mfma_f32_16x16x32_bf16 v[140:143], a[212:215], a[148:151], v[140:143]
  v_add_f32 v223, v155, v223
  v_cvt_pk_bf16_f32 v173, v154, v155
  v_mfma_f32_16x16x32_bf16 v[132:135], a[216:219], a[136:139], v[132:135]
  v_exp_f32 v157, v157
  v_mfma_f32_16x16x32_bf16 v[140:143], a[216:219], a[152:155], v[140:143]
  v_add_f32 v223, v156, v223
  v_cvt_pk_bf16_f32 v174, v156, v157
  v_mfma_f32_16x16x32_bf16 v[132:135], a[220:223], a[140:143], v[132:135]
  v_exp_f32 v158, v158
  v_mfma_f32_16x16x32_bf16 v[140:143], a[220:223], a[156:159], v[140:143]
  v_add_f32 v223, v157, v223
  v_add_f32 v223, v158, v223
  s_waitcnt lgkmcnt(0)
  v_mfma_f32_16x16x32_bf16 v[0:3], a[224:227], v[160:163], v[0:3]
  v_exp_f32 v159, v159
  v_mfma_f32_16x16x32_bf16 v[32:35], a[224:227], v[164:167], v[32:35]
  v_add_f32 v223, v159, v223
  v_cvt_pk_bf16_f32 v175, v158, v159
  v_mfma_f32_16x16x32_bf16 v[4:7], a[228:231], v[160:163], v[4:7]
  v_exp_f32 v128, v128
  v_mfma_f32_16x16x32_bf16 v[36:39], a[228:231], v[164:167], v[36:39]
  v_add_f32 v238, v128, v238
  v_mfma_f32_16x16x32_bf16 v[8:11], a[232:235], v[160:163], v[8:11]
  v_exp_f32 v129, v129
  v_mfma_f32_16x16x32_bf16 v[40:43], a[232:235], v[164:167], v[40:43]
  v_add_f32 v238, v129, v238
  v_mfma_f32_16x16x32_bf16 v[12:15], a[236:239], v[160:163], v[12:15]
  v_exp_f32 v130, v130
  v_mfma_f32_16x16x32_bf16 v[44:47], a[236:239], v[164:167], v[44:47]
  v_add_f32 v238, v130, v238
  v_mfma_f32_16x16x32_bf16 v[16:19], a[240:243], v[160:163], v[16:19]
  v_exp_f32 v131, v131
  v_mfma_f32_16x16x32_bf16 v[48:51], a[240:243], v[164:167], v[48:51]
  v_add_f32 v238, v131, v238
  v_mfma_f32_16x16x32_bf16 v[20:23], a[244:247], v[160:163], v[20:23]
  v_exp_f32 v132, v132
  v_mfma_f32_16x16x32_bf16 v[52:55], a[244:247], v[164:167], v[52:55]
  v_add_f32 v238, v132, v238
  v_mfma_f32_16x16x32_bf16 v[24:27], a[248:251], v[160:163], v[24:27]
  v_exp_f32 v133, v133
  v_mfma_f32_16x16x32_bf16 v[56:59], a[248:251], v[164:167], v[56:59]
  v_add_f32 v238, v133, v238
  v_mfma_f32_16x16x32_bf16 v[28:31], a[252:255], v[160:163], v[28:31]
  v_exp_f32 v134, v134
  v_mfma_f32_16x16x32_bf16 v[60:63], a[252:255], v[164:167], v[60:63]
  s_barrier
  v_mfma_f32_16x16x32_bf16 v[144:147], a[192:195], a[160:163], 0
  v_exp_f32 v135, v135
  v_mfma_f32_16x16x32_bf16 v[152:155], a[192:195], a[176:179], 0
  v_add_f32 v238, v135, v238
  v_cvt_pk_bf16_f32 v160, v128, v129
  v_mfma_f32_16x16x32_bf16 v[144:147], a[196:199], a[164:167], v[144:147]
  ds_read_b128 a[192:195], v240 offset:32768
  v_exp_f32 v136, v136
  v_mfma_f32_16x16x32_bf16 v[152:155], a[196:199], a[180:183], v[152:155]
  v_add_f32 v239, v136, v239
  v_cvt_pk_bf16_f32 v161, v130, v131
  v_mfma_f32_16x16x32_bf16 v[144:147], a[200:203], a[168:171], v[144:147]
  ds_read_b128 a[196:199], v241 offset:32768
  v_exp_f32 v137, v137
  v_mfma_f32_16x16x32_bf16 v[152:155], a[200:203], a[184:187], v[152:155]
  v_add_f32 v239, v137, v239
  v_cvt_pk_bf16_f32 v162, v132, v133
  v_mfma_f32_16x16x32_bf16 v[144:147], a[204:207], a[172:175], v[144:147]
  ds_read_b128 a[200:203], v242 offset:32768
  v_exp_f32 v138, v138
  v_mfma_f32_16x16x32_bf16 v[152:155], a[204:207], a[188:191], v[152:155]
  v_add_f32 v239, v138, v239
  v_cvt_pk_bf16_f32 v163, v134, v135
  v_mfma_f32_16x16x32_bf16 v[148:151], a[208:211], a[160:163], 0
  ds_read_b128 a[204:207], v243 offset:32768
  v_exp_f32 v139, v139
  v_mfma_f32_16x16x32_bf16 v[156:159], a[208:211], a[176:179], 0
  v_add_f32 v239, v139, v239
  v_cvt_pk_bf16_f32 v164, v136, v137
  v_mfma_f32_16x16x32_bf16 v[148:151], a[212:215], a[164:167], v[148:151]
  ds_read_b128 a[208:211], v240 offset:36864
  v_exp_f32 v140, v140
  v_mfma_f32_16x16x32_bf16 v[156:159], a[212:215], a[180:183], v[156:159]
  v_add_f32 v239, v140, v239
  v_cvt_pk_bf16_f32 v165, v138, v139
  v_mfma_f32_16x16x32_bf16 v[148:151], a[216:219], a[168:171], v[148:151]
  ds_read_b128 a[212:215], v241 offset:36864
  v_exp_f32 v141, v141
  v_mfma_f32_16x16x32_bf16 v[156:159], a[216:219], a[184:187], v[156:159]
  v_add_f32 v239, v141, v239
  v_cvt_pk_bf16_f32 v166, v140, v141
  v_mfma_f32_16x16x32_bf16 v[148:151], a[220:223], a[172:175], v[148:151]
  ds_read_b128 a[216:219], v242 offset:36864
  v_exp_f32 v142, v142
  v_mfma_f32_16x16x32_bf16 v[156:159], a[220:223], a[188:191], v[156:159]
  v_add_f32 v238, v134, v238
  v_add_f32 v239, v142, v239
  v_mfma_f32_16x16x32_bf16 v[64:67], a[224:227], v[168:171], v[64:67]
  ds_read_b128 a[220:223], v243 offset:36864
  v_exp_f32 v143, v143
  v_mfma_f32_16x16x32_bf16 v[96:99], a[224:227], v[172:175], v[96:99]
  v_add_f32 v239, v143, v239
  v_cvt_pk_bf16_f32 v167, v142, v143
  v_mfma_f32_16x16x32_bf16 v[68:71], a[228:231], v[168:171], v[68:71]
  ds_read_b64_tr_b16 a[224:225], v244 offset:8192
  ds_read_b64_tr_b16 a[226:227], v244 offset:12288
  v_exp_f32 v144, v144
  v_mfma_f32_16x16x32_bf16 v[100:103], a[228:231], v[172:175], v[100:103]
  v_add_f32 v222, v144, v222
  v_mfma_f32_16x16x32_bf16 v[72:75], a[232:235], v[168:171], v[72:75]
  ds_read_b64_tr_b16 a[228:229], v245 offset:8192
  ds_read_b64_tr_b16 a[230:231], v245 offset:12288
  v_exp_f32 v145, v145
  v_mfma_f32_16x16x32_bf16 v[104:107], a[232:235], v[172:175], v[104:107]
  v_add_f32 v222, v145, v222
  v_mfma_f32_16x16x32_bf16 v[76:79], a[236:239], v[168:171], v[76:79]
  ds_read_b64_tr_b16 a[232:233], v246 offset:8192
  ds_read_b64_tr_b16 a[234:235], v246 offset:12288
  v_exp_f32 v146, v146
  v_mfma_f32_16x16x32_bf16 v[108:111], a[236:239], v[172:175], v[108:111]
  v_add_f32 v222, v146, v222
  v_mfma_f32_16x16x32_bf16 v[80:83], a[240:243], v[168:171], v[80:83]
  ds_read_b64_tr_b16 a[236:237], v247 offset:8192
  ds_read_b64_tr_b16 a[238:239], v247 offset:12288
  v_exp_f32 v147, v147
  v_mfma_f32_16x16x32_bf16 v[112:115], a[240:243], v[172:175], v[112:115]
  v_add_f32 v222, v147, v222
  v_mfma_f32_16x16x32_bf16 v[84:87], a[244:247], v[168:171], v[84:87]
  ds_read_b64_tr_b16 a[240:241], v248 offset:8192
  ds_read_b64_tr_b16 a[242:243], v248 offset:12288
  v_exp_f32 v148, v148
  v_mfma_f32_16x16x32_bf16 v[116:119], a[244:247], v[172:175], v[116:119]
  v_add_f32 v222, v148, v222
  v_mfma_f32_16x16x32_bf16 v[88:91], a[248:251], v[168:171], v[88:91]
  ds_read_b64_tr_b16 a[244:245], v249 offset:8192
  ds_read_b64_tr_b16 a[246:247], v249 offset:12288
  v_exp_f32 v149, v149
  v_mfma_f32_16x16x32_bf16 v[120:123], a[248:251], v[172:175], v[120:123]
  v_add_f32 v222, v149, v222
  v_mfma_f32_16x16x32_bf16 v[92:95], a[252:255], v[168:171], v[92:95]
  ds_read_b64_tr_b16 a[248:249], v250 offset:8192
  ds_read_b64_tr_b16 a[250:251], v250 offset:12288
  v_exp_f32 v150, v150
  v_mfma_f32_16x16x32_bf16 v[124:127], a[252:255], v[172:175], v[124:127]
  ds_read_b64_tr_b16 a[252:253], v251 offset:8192
  ds_read_b64_tr_b16 a[254:255], v251 offset:12288
  s_waitcnt lgkmcnt(15)
  v_mfma_f32_16x16x32_bf16 v[128:131], a[192:195], a[128:131], 0
  v_exp_f32 v151, v151
  v_mfma_f32_16x16x32_bf16 v[136:139], a[192:195], a[144:147], 0
  v_add_f32 v222, v150, v222
  v_cvt_pk_bf16_f32 v168, v144, v145
  v_mfma_f32_16x16x32_bf16 v[128:131], a[196:199], a[132:135], v[128:131]
  v_exp_f32 v152, v152
  v_mfma_f32_16x16x32_bf16 v[136:139], a[196:199], a[148:151], v[136:139]
  v_add_f32 v222, v151, v222
  v_cvt_pk_bf16_f32 v169, v146, v147
  v_mfma_f32_16x16x32_bf16 v[128:131], a[200:203], a[136:139], v[128:131]
  v_exp_f32 v153, v153
  v_mfma_f32_16x16x32_bf16 v[136:139], a[200:203], a[152:155], v[136:139]
  v_add_f32 v223, v152, v223
  v_cvt_pk_bf16_f32 v170, v148, v149
  v_mfma_f32_16x16x32_bf16 v[128:131], a[204:207], a[140:143], v[128:131]
  v_exp_f32 v154, v154
  v_mfma_f32_16x16x32_bf16 v[136:139], a[204:207], a[156:159], v[136:139]
  v_add_f32 v223, v153, v223
  v_cvt_pk_bf16_f32 v171, v150, v151
  v_mfma_f32_16x16x32_bf16 v[132:135], a[208:211], a[128:131], 0
  v_exp_f32 v155, v155
  v_mfma_f32_16x16x32_bf16 v[140:143], a[208:211], a[144:147], 0
  v_add_f32 v223, v154, v223
  v_cvt_pk_bf16_f32 v172, v152, v153
  v_mfma_f32_16x16x32_bf16 v[132:135], a[212:215], a[132:135], v[132:135]
  v_exp_f32 v156, v156
  v_mfma_f32_16x16x32_bf16 v[140:143], a[212:215], a[148:151], v[140:143]
  v_add_f32 v223, v155, v223
  v_cvt_pk_bf16_f32 v173, v154, v155
  v_mfma_f32_16x16x32_bf16 v[132:135], a[216:219], a[136:139], v[132:135]
  v_exp_f32 v157, v157
  v_mfma_f32_16x16x32_bf16 v[140:143], a[216:219], a[152:155], v[140:143]
  v_add_f32 v223, v156, v223
  v_cvt_pk_bf16_f32 v174, v156, v157
  v_mfma_f32_16x16x32_bf16 v[132:135], a[220:223], a[140:143], v[132:135]
  v_exp_f32 v158, v158
  v_mfma_f32_16x16x32_bf16 v[140:143], a[220:223], a[156:159], v[140:143]
  v_add_f32 v223, v157, v223
  v_add_f32 v223, v158, v223
  s_waitcnt lgkmcnt(0)
  v_mfma_f32_16x16x32_bf16 v[0:3], a[224:227], v[160:163], v[0:3]
  v_exp_f32 v159, v159
  v_mfma_f32_16x16x32_bf16 v[32:35], a[224:227], v[164:167], v[32:35]
  v_add_f32 v223, v159, v223
  v_cvt_pk_bf16_f32 v175, v158, v159
  v_mfma_f32_16x16x32_bf16 v[4:7], a[228:231], v[160:163], v[4:7]
  v_exp_f32 v128, v128
  v_mfma_f32_16x16x32_bf16 v[36:39], a[228:231], v[164:167], v[36:39]
  v_add_f32 v238, v128, v238
  v_mfma_f32_16x16x32_bf16 v[8:11], a[232:235], v[160:163], v[8:11]
  v_exp_f32 v129, v129
  v_mfma_f32_16x16x32_bf16 v[40:43], a[232:235], v[164:167], v[40:43]
  v_add_f32 v238, v129, v238
  v_mfma_f32_16x16x32_bf16 v[12:15], a[236:239], v[160:163], v[12:15]
  v_exp_f32 v130, v130
  v_mfma_f32_16x16x32_bf16 v[44:47], a[236:239], v[164:167], v[44:47]
  v_add_f32 v238, v130, v238
  v_mfma_f32_16x16x32_bf16 v[16:19], a[240:243], v[160:163], v[16:19]
  v_exp_f32 v131, v131
  v_mfma_f32_16x16x32_bf16 v[48:51], a[240:243], v[164:167], v[48:51]
  v_add_f32 v238, v131, v238
  v_mfma_f32_16x16x32_bf16 v[20:23], a[244:247], v[160:163], v[20:23]
  v_exp_f32 v132, v132
  v_mfma_f32_16x16x32_bf16 v[52:55], a[244:247], v[164:167], v[52:55]
  v_add_f32 v238, v132, v238
  v_mfma_f32_16x16x32_bf16 v[24:27], a[248:251], v[160:163], v[24:27]
  v_exp_f32 v133, v133
  v_mfma_f32_16x16x32_bf16 v[56:59], a[248:251], v[164:167], v[56:59]
  v_add_f32 v238, v133, v238
  v_mfma_f32_16x16x32_bf16 v[28:31], a[252:255], v[160:163], v[28:31]
  v_exp_f32 v134, v134
  v_mfma_f32_16x16x32_bf16 v[60:63], a[252:255], v[164:167], v[60:63]
  s_barrier
  v_mfma_f32_16x16x32_bf16 v[144:147], a[192:195], a[160:163], 0
  v_exp_f32 v135, v135
  v_mfma_f32_16x16x32_bf16 v[152:155], a[192:195], a[176:179], 0
  v_add_f32 v238, v135, v238
  v_cvt_pk_bf16_f32 v160, v128, v129
  v_mfma_f32_16x16x32_bf16 v[144:147], a[196:199], a[164:167], v[144:147]
  ds_read_b128 a[192:195], v240 offset:40960
  v_exp_f32 v136, v136
  v_mfma_f32_16x16x32_bf16 v[152:155], a[196:199], a[180:183], v[152:155]
  v_add_f32 v239, v136, v239
  v_cvt_pk_bf16_f32 v161, v130, v131
  v_mfma_f32_16x16x32_bf16 v[144:147], a[200:203], a[168:171], v[144:147]
  ds_read_b128 a[196:199], v241 offset:40960
  v_exp_f32 v137, v137
  v_mfma_f32_16x16x32_bf16 v[152:155], a[200:203], a[184:187], v[152:155]
  v_add_f32 v239, v137, v239
  v_cvt_pk_bf16_f32 v162, v132, v133
  v_mfma_f32_16x16x32_bf16 v[144:147], a[204:207], a[172:175], v[144:147]
  ds_read_b128 a[200:203], v242 offset:40960
  v_exp_f32 v138, v138
  v_mfma_f32_16x16x32_bf16 v[152:155], a[204:207], a[188:191], v[152:155]
  v_add_f32 v239, v138, v239
  v_cvt_pk_bf16_f32 v163, v134, v135
  v_mfma_f32_16x16x32_bf16 v[148:151], a[208:211], a[160:163], 0
  ds_read_b128 a[204:207], v243 offset:40960
  v_exp_f32 v139, v139
  v_mfma_f32_16x16x32_bf16 v[156:159], a[208:211], a[176:179], 0
  v_add_f32 v239, v139, v239
  v_cvt_pk_bf16_f32 v164, v136, v137
  v_mfma_f32_16x16x32_bf16 v[148:151], a[212:215], a[164:167], v[148:151]
  ds_read_b128 a[208:211], v240 offset:45056
  v_exp_f32 v140, v140
  v_mfma_f32_16x16x32_bf16 v[156:159], a[212:215], a[180:183], v[156:159]
  v_add_f32 v239, v140, v239
  v_cvt_pk_bf16_f32 v165, v138, v139
  v_mfma_f32_16x16x32_bf16 v[148:151], a[216:219], a[168:171], v[148:151]
  ds_read_b128 a[212:215], v241 offset:45056
  v_exp_f32 v141, v141
  v_mfma_f32_16x16x32_bf16 v[156:159], a[216:219], a[184:187], v[156:159]
  v_add_f32 v239, v141, v239
  v_cvt_pk_bf16_f32 v166, v140, v141
  v_mfma_f32_16x16x32_bf16 v[148:151], a[220:223], a[172:175], v[148:151]
  ds_read_b128 a[216:219], v242 offset:45056
  v_exp_f32 v142, v142
  v_mfma_f32_16x16x32_bf16 v[156:159], a[220:223], a[188:191], v[156:159]
  v_add_f32 v238, v134, v238
  v_add_f32 v239, v142, v239
  v_mfma_f32_16x16x32_bf16 v[64:67], a[224:227], v[168:171], v[64:67]
  ds_read_b128 a[220:223], v243 offset:45056
  v_exp_f32 v143, v143
  v_mfma_f32_16x16x32_bf16 v[96:99], a[224:227], v[172:175], v[96:99]
  v_add_f32 v239, v143, v239
  v_cvt_pk_bf16_f32 v167, v142, v143
  v_mfma_f32_16x16x32_bf16 v[68:71], a[228:231], v[168:171], v[68:71]
  ds_read_b64_tr_b16 a[224:225], v244 offset:16384
  ds_read_b64_tr_b16 a[226:227], v244 offset:20480
  v_exp_f32 v144, v144
  v_mfma_f32_16x16x32_bf16 v[100:103], a[228:231], v[172:175], v[100:103]
  v_add_f32 v222, v144, v222
  v_mfma_f32_16x16x32_bf16 v[72:75], a[232:235], v[168:171], v[72:75]
  ds_read_b64_tr_b16 a[228:229], v245 offset:16384
  ds_read_b64_tr_b16 a[230:231], v245 offset:20480
  v_exp_f32 v145, v145
  v_mfma_f32_16x16x32_bf16 v[104:107], a[232:235], v[172:175], v[104:107]
  v_add_f32 v222, v145, v222
  v_mfma_f32_16x16x32_bf16 v[76:79], a[236:239], v[168:171], v[76:79]
  ds_read_b64_tr_b16 a[232:233], v246 offset:16384
  ds_read_b64_tr_b16 a[234:235], v246 offset:20480
  v_exp_f32 v146, v146
  v_mfma_f32_16x16x32_bf16 v[108:111], a[236:239], v[172:175], v[108:111]
  v_add_f32 v222, v146, v222
  v_mfma_f32_16x16x32_bf16 v[80:83], a[240:243], v[168:171], v[80:83]
  ds_read_b64_tr_b16 a[236:237], v247 offset:16384
  ds_read_b64_tr_b16 a[238:239], v247 offset:20480
  v_exp_f32 v147, v147
  v_mfma_f32_16x16x32_bf16 v[112:115], a[240:243], v[172:175], v[112:115]
  v_add_f32 v222, v147, v222
  v_mfma_f32_16x16x32_bf16 v[84:87], a[244:247], v[168:171], v[84:87]
  ds_read_b64_tr_b16 a[240:241], v248 offset:16384
  ds_read_b64_tr_b16 a[242:243], v248 offset:20480
  v_exp_f32 v148, v148
  v_mfma_f32_16x16x32_bf16 v[116:119], a[244:247], v[172:175], v[116:119]
  v_add_f32 v222, v148, v222
  v_mfma_f32_16x16x32_bf16 v[88:91], a[248:251], v[168:171], v[88:91]
  ds_read_b64_tr_b16 a[244:245], v249 offset:16384
  ds_read_b64_tr_b16 a[246:247], v249 offset:20480
  v_exp_f32 v149, v149
  v_mfma_f32_16x16x32_bf16 v[120:123], a[248:251], v[172:175], v[120:123]
  v_add_f32 v222, v149, v222
  v_mfma_f32_16x16x32_bf16 v[92:95], a[252:255], v[168:171], v[92:95]
  ds_read_b64_tr_b16 a[248:249], v250 offset:16384
  ds_read_b64_tr_b16 a[250:251], v250 offset:20480
  v_exp_f32 v150, v150
  v_mfma_f32_16x16x32_bf16 v[124:127], a[252:255], v[172:175], v[124:127]
  ds_read_b64_tr_b16 a[252:253], v251 offset:16384
  ds_read_b64_tr_b16 a[254:255], v251 offset:20480
  s_waitcnt lgkmcnt(15)
  v_mfma_f32_16x16x32_bf16 v[128:131], a[192:195], a[128:131], 0
  v_exp_f32 v151, v151
  v_mfma_f32_16x16x32_bf16 v[136:139], a[192:195], a[144:147], 0
  v_add_f32 v222, v150, v222
  v_cvt_pk_bf16_f32 v168, v144, v145
  v_mfma_f32_16x16x32_bf16 v[128:131], a[196:199], a[132:135], v[128:131]
  v_exp_f32 v152, v152
  v_mfma_f32_16x16x32_bf16 v[136:139], a[196:199], a[148:151], v[136:139]
  v_add_f32 v222, v151, v222
  v_cvt_pk_bf16_f32 v169, v146, v147
  v_mfma_f32_16x16x32_bf16 v[128:131], a[200:203], a[136:139], v[128:131]
  v_exp_f32 v153, v153
  v_mfma_f32_16x16x32_bf16 v[136:139], a[200:203], a[152:155], v[136:139]
  v_add_f32 v223, v152, v223
  v_cvt_pk_bf16_f32 v170, v148, v149
  v_mfma_f32_16x16x32_bf16 v[128:131], a[204:207], a[140:143], v[128:131]
  v_exp_f32 v154, v154
  v_mfma_f32_16x16x32_bf16 v[136:139], a[204:207], a[156:159], v[136:139]
  v_add_f32 v223, v153, v223
  v_cvt_pk_bf16_f32 v171, v150, v151
  v_mfma_f32_16x16x32_bf16 v[132:135], a[208:211], a[128:131], 0
  v_exp_f32 v155, v155
  v_mfma_f32_16x16x32_bf16 v[140:143], a[208:211], a[144:147], 0
  v_add_f32 v223, v154, v223
  v_cvt_pk_bf16_f32 v172, v152, v153
  v_mfma_f32_16x16x32_bf16 v[132:135], a[212:215], a[132:135], v[132:135]
  v_exp_f32 v156, v156
  v_mfma_f32_16x16x32_bf16 v[140:143], a[212:215], a[148:151], v[140:143]
  v_add_f32 v223, v155, v223
  v_cvt_pk_bf16_f32 v173, v154, v155
  v_mfma_f32_16x16x32_bf16 v[132:135], a[216:219], a[136:139], v[132:135]
  v_exp_f32 v157, v157
  v_mfma_f32_16x16x32_bf16 v[140:143], a[216:219], a[152:155], v[140:143]
  v_add_f32 v223, v156, v223
  v_cvt_pk_bf16_f32 v174, v156, v157
  v_mfma_f32_16x16x32_bf16 v[132:135], a[220:223], a[140:143], v[132:135]
  v_exp_f32 v158, v158
  v_mfma_f32_16x16x32_bf16 v[140:143], a[220:223], a[156:159], v[140:143]
  v_add_f32 v223, v157, v223
  v_add_f32 v223, v158, v223
  s_waitcnt lgkmcnt(0)
  v_mfma_f32_16x16x32_bf16 v[0:3], a[224:227], v[160:163], v[0:3]
  v_exp_f32 v159, v159
  v_mfma_f32_16x16x32_bf16 v[32:35], a[224:227], v[164:167], v[32:35]
  v_add_f32 v223, v159, v223
  v_cvt_pk_bf16_f32 v175, v158, v159
  v_mfma_f32_16x16x32_bf16 v[4:7], a[228:231], v[160:163], v[4:7]
  v_exp_f32 v128, v128
  v_mfma_f32_16x16x32_bf16 v[36:39], a[228:231], v[164:167], v[36:39]
  v_add_f32 v238, v128, v238
  v_mfma_f32_16x16x32_bf16 v[8:11], a[232:235], v[160:163], v[8:11]
  v_exp_f32 v129, v129
  v_mfma_f32_16x16x32_bf16 v[40:43], a[232:235], v[164:167], v[40:43]
  v_add_f32 v238, v129, v238
  v_mfma_f32_16x16x32_bf16 v[12:15], a[236:239], v[160:163], v[12:15]
  v_exp_f32 v130, v130
  v_mfma_f32_16x16x32_bf16 v[44:47], a[236:239], v[164:167], v[44:47]
  v_add_f32 v238, v130, v238
  v_mfma_f32_16x16x32_bf16 v[16:19], a[240:243], v[160:163], v[16:19]
  v_exp_f32 v131, v131
  v_mfma_f32_16x16x32_bf16 v[48:51], a[240:243], v[164:167], v[48:51]
  v_add_f32 v238, v131, v238
  v_mfma_f32_16x16x32_bf16 v[20:23], a[244:247], v[160:163], v[20:23]
  v_exp_f32 v132, v132
  v_mfma_f32_16x16x32_bf16 v[52:55], a[244:247], v[164:167], v[52:55]
  v_add_f32 v238, v132, v238
  v_mfma_f32_16x16x32_bf16 v[24:27], a[248:251], v[160:163], v[24:27]
  v_exp_f32 v133, v133
  v_mfma_f32_16x16x32_bf16 v[56:59], a[248:251], v[164:167], v[56:59]
  v_add_f32 v238, v133, v238
  v_mfma_f32_16x16x32_bf16 v[28:31], a[252:255], v[160:163], v[28:31]
  v_exp_f32 v134, v134
  v_mfma_f32_16x16x32_bf16 v[60:63], a[252:255], v[164:167], v[60:63]
  s_barrier
  v_mfma_f32_16x16x32_bf16 v[144:147], a[192:195], a[160:163], 0
  v_exp_f32 v135, v135
  v_mfma_f32_16x16x32_bf16 v[152:155], a[192:195], a[176:179], 0
  v_add_f32 v238, v135, v238
  v_cvt_pk_bf16_f32 v160, v128, v129
  v_mfma_f32_16x16x32_bf16 v[144:147], a[196:199], a[164:167], v[144:147]
  ds_read_b128 a[192:195], v240 offset:57344
  v_exp_f32 v136, v136
  v_mfma_f32_16x16x32_bf16 v[152:155], a[196:199], a[180:183], v[152:155]
  v_add_f32 v239, v136, v239
  v_cvt_pk_bf16_f32 v161, v130, v131
  v_mfma_f32_16x16x32_bf16 v[144:147], a[200:203], a[168:171], v[144:147]
  ds_read_b128 a[196:199], v241 offset:57344
  v_exp_f32 v137, v137
  v_mfma_f32_16x16x32_bf16 v[152:155], a[200:203], a[184:187], v[152:155]
  v_add_f32 v239, v137, v239
  v_cvt_pk_bf16_f32 v162, v132, v133
  v_mfma_f32_16x16x32_bf16 v[144:147], a[204:207], a[172:175], v[144:147]
  ds_read_b128 a[200:203], v242 offset:57344
  v_exp_f32 v138, v138
  v_mfma_f32_16x16x32_bf16 v[152:155], a[204:207], a[188:191], v[152:155]
  v_add_f32 v239, v138, v239
  v_cvt_pk_bf16_f32 v163, v134, v135
  v_mfma_f32_16x16x32_bf16 v[148:151], a[208:211], a[160:163], 0
  ds_read_b128 a[204:207], v243 offset:57344
  v_exp_f32 v139, v139
  v_mfma_f32_16x16x32_bf16 v[156:159], a[208:211], a[176:179], 0
  v_add_f32 v239, v139, v239
  v_cvt_pk_bf16_f32 v164, v136, v137
  v_mfma_f32_16x16x32_bf16 v[148:151], a[212:215], a[164:167], v[148:151]
  ds_read_b128 a[208:211], v240 offset:61440
  v_exp_f32 v140, v140
  v_mfma_f32_16x16x32_bf16 v[156:159], a[212:215], a[180:183], v[156:159]
  v_add_f32 v239, v140, v239
  v_cvt_pk_bf16_f32 v165, v138, v139
  v_mfma_f32_16x16x32_bf16 v[148:151], a[216:219], a[168:171], v[148:151]
  ds_read_b128 a[212:215], v241 offset:61440
  v_exp_f32 v141, v141
  v_mfma_f32_16x16x32_bf16 v[156:159], a[216:219], a[184:187], v[156:159]
  v_add_f32 v239, v141, v239
  v_cvt_pk_bf16_f32 v166, v140, v141
  v_mfma_f32_16x16x32_bf16 v[148:151], a[220:223], a[172:175], v[148:151]
  ds_read_b128 a[216:219], v242 offset:61440
  v_exp_f32 v142, v142
  v_mfma_f32_16x16x32_bf16 v[156:159], a[220:223], a[188:191], v[156:159]
  v_add_f32 v238, v134, v238
  v_add_f32 v239, v142, v239
  v_mfma_f32_16x16x32_bf16 v[64:67], a[224:227], v[168:171], v[64:67]
  ds_read_b128 a[220:223], v243 offset:61440
  v_exp_f32 v143, v143
  v_mfma_f32_16x16x32_bf16 v[96:99], a[224:227], v[172:175], v[96:99]
  v_add_f32 v239, v143, v239
  v_cvt_pk_bf16_f32 v167, v142, v143
  v_mfma_f32_16x16x32_bf16 v[68:71], a[228:231], v[168:171], v[68:71]
  ds_read_b64_tr_b16 a[224:225], v244 offset:49152
  ds_read_b64_tr_b16 a[226:227], v244 offset:53248
  v_exp_f32 v144, v144
  v_mfma_f32_16x16x32_bf16 v[100:103], a[228:231], v[172:175], v[100:103]
  v_add_f32 v222, v144, v222
  v_mfma_f32_16x16x32_bf16 v[72:75], a[232:235], v[168:171], v[72:75]
  ds_read_b64_tr_b16 a[228:229], v245 offset:49152
  ds_read_b64_tr_b16 a[230:231], v245 offset:53248
  v_exp_f32 v145, v145
  v_mfma_f32_16x16x32_bf16 v[104:107], a[232:235], v[172:175], v[104:107]
  v_add_f32 v222, v145, v222
  v_mfma_f32_16x16x32_bf16 v[76:79], a[236:239], v[168:171], v[76:79]
  ds_read_b64_tr_b16 a[232:233], v246 offset:49152
  ds_read_b64_tr_b16 a[234:235], v246 offset:53248
  v_exp_f32 v146, v146
  v_mfma_f32_16x16x32_bf16 v[108:111], a[236:239], v[172:175], v[108:111]
  v_add_f32 v222, v146, v222
  v_mfma_f32_16x16x32_bf16 v[80:83], a[240:243], v[168:171], v[80:83]
  ds_read_b64_tr_b16 a[236:237], v247 offset:49152
  ds_read_b64_tr_b16 a[238:239], v247 offset:53248
  v_exp_f32 v147, v147
  v_mfma_f32_16x16x32_bf16 v[112:115], a[240:243], v[172:175], v[112:115]
  v_add_f32 v222, v147, v222
  v_mfma_f32_16x16x32_bf16 v[84:87], a[244:247], v[168:171], v[84:87]
  ds_read_b64_tr_b16 a[240:241], v248 offset:49152
  ds_read_b64_tr_b16 a[242:243], v248 offset:53248
  v_exp_f32 v148, v148
  v_mfma_f32_16x16x32_bf16 v[116:119], a[244:247], v[172:175], v[116:119]
  v_add_f32 v222, v148, v222
  v_mfma_f32_16x16x32_bf16 v[88:91], a[248:251], v[168:171], v[88:91]
  ds_read_b64_tr_b16 a[244:245], v249 offset:49152
  ds_read_b64_tr_b16 a[246:247], v249 offset:53248
  v_exp_f32 v149, v149
  v_mfma_f32_16x16x32_bf16 v[120:123], a[248:251], v[172:175], v[120:123]
  v_add_f32 v222, v149, v222
  v_mfma_f32_16x16x32_bf16 v[92:95], a[252:255], v[168:171], v[92:95]
  ds_read_b64_tr_b16 a[248:249], v250 offset:49152
  ds_read_b64_tr_b16 a[250:251], v250 offset:53248
  v_exp_f32 v150, v150
  v_mfma_f32_16x16x32_bf16 v[124:127], a[252:255], v[172:175], v[124:127]
  ds_read_b64_tr_b16 a[252:253], v251 offset:49152
  ds_read_b64_tr_b16 a[254:255], v251 offset:53248
  s_add_u32 s37, s37, 1
  s_cmp_lt_u32 s37, 7
  s_cbranch_scc1 L_attn_CW
  s_waitcnt lgkmcnt(15)
  v_mfma_f32_16x16x32_bf16 v[128:131], a[192:195], a[128:131], 0
  v_exp_f32 v151, v151
  v_mfma_f32_16x16x32_bf16 v[136:139], a[192:195], a[144:147], 0
  v_add_f32 v222, v150, v222
  v_cvt_pk_bf16_f32 v168, v144, v145
  v_mfma_f32_16x16x32_bf16 v[128:131], a[196:199], a[132:135], v[128:131]
  v_exp_f32 v152, v152
  v_mfma_f32_16x16x32_bf16 v[136:139], a[196:199], a[148:151], v[136:139]
  v_add_f32 v222, v151, v222
  v_cvt_pk_bf16_f32 v169, v146, v147
  v_mfma_f32_16x16x32_bf16 v[128:131], a[200:203], a[136:139], v[128:131]
  v_exp_f32 v153, v153
  v_mfma_f32_16x16x32_bf16 v[136:139], a[200:203], a[152:155], v[136:139]
  v_add_f32 v223, v152, v223
  v_cvt_pk_bf16_f32 v170, v148, v149
  v_mfma_f32_16x16x32_bf16 v[128:131], a[204:207], a[140:143], v[128:131]
  v_exp_f32 v154, v154
  v_mfma_f32_16x16x32_bf16 v[136:139], a[204:207], a[156:159], v[136:139]
  v_add_f32 v223, v153, v223
  v_cvt_pk_bf16_f32 v171, v150, v151
  v_mfma_f32_16x16x32_bf16 v[132:135], a[208:211], a[128:131], 0
  v_exp_f32 v155, v155
  v_mfma_f32_16x16x32_bf16 v[140:143], a[208:211], a[144:147], 0
  v_add_f32 v223, v154, v223
  v_cvt_pk_bf16_f32 v172, v152, v153
  v_mfma_f32_16x16x32_bf16 v[132:135], a[212:215], a[132:135], v[132:135]
  v_exp_f32 v156, v156
  v_mfma_f32_16x16x32_bf16 v[140:143], a[212:215], a[148:151], v[140:143]
  v_add_f32 v223, v155, v223
  v_cvt_pk_bf16_f32 v173, v154, v155
  v_mfma_f32_16x16x32_bf16 v[132:135], a[216:219], a[136:139], v[132:135]
  v_exp_f32 v157, v157
  v_mfma_f32_16x16x32_bf16 v[140:143], a[216:219], a[152:155], v[140:143]
  v_add_f32 v223, v156, v223
  v_cvt_pk_bf16_f32 v174, v156, v157
  v_mfma_f32_16x16x32_bf16 v[132:135], a[220:223], a[140:143], v[132:135]
  v_exp_f32 v158, v158
  v_mfma_f32_16x16x32_bf16 v[140:143], a[220:223], a[156:159], v[140:143]
  v_add_f32 v223, v157, v223
  v_add_f32 v223, v158, v223
  s_waitcnt lgkmcnt(0)
  v_mfma_f32_16x16x32_bf16 v[0:3], a[224:227], v[160:163], v[0:3]
  v_exp_f32 v159, v159
  v_mfma_f32_16x16x32_bf16 v[32:35], a[224:227], v[164:167], v[32:35]
  v_add_f32 v223, v159, v223
  v_cvt_pk_bf16_f32 v175, v158, v159
  v_mfma_f32_16x16x32_bf16 v[4:7], a[228:231], v[160:163], v[4:7]
  v_exp_f32 v128, v128
  v_mfma_f32_16x16x32_bf16 v[36:39], a[228:231], v[164:167], v[36:39]
  v_add_f32 v238, v128, v238
  v_mfma_f32_16x16x32_bf16 v[8:11], a[232:235], v[160:163], v[8:11]
  v_exp_f32 v129, v129
  v_mfma_f32_16x16x32_bf16 v[40:43], a[232:235], v[164:167], v[40:43]
  v_add_f32 v238, v129, v238
  v_mfma_f32_16x16x32_bf16 v[12:15], a[236:239], v[160:163], v[12:15]
  v_exp_f32 v130, v130
  v_mfma_f32_16x16x32_bf16 v[44:47], a[236:239], v[164:167], v[44:47]
  v_add_f32 v238, v130, v238
  v_mfma_f32_16x16x32_bf16 v[16:19], a[240:243], v[160:163], v[16:19]
  v_exp_f32 v131, v131
  v_mfma_f32_16x16x32_bf16 v[48:51], a[240:243], v[164:167], v[48:51]
  v_add_f32 v238, v131, v238
  v_mfma_f32_16x16x32_bf16 v[20:23], a[244:247], v[160:163], v[20:23]
  v_exp_f32 v132, v132
  v_mfma_f32_16x16x32_bf16 v[52:55], a[244:247], v[164:167], v[52:55]
  v_add_f32 v238, v132, v238
  v_mfma_f32_16x16x32_bf16 v[24:27], a[248:251], v[160:163], v[24:27]
  v_exp_f32 v133, v133
  v_mfma_f32_16x16x32_bf16 v[56:59], a[248:251], v[164:167], v[56:59]
  v_add_f32 v238, v133, v238
  v_mfma_f32_16x16x32_bf16 v[28:31], a[252:255], v[160:163], v[28:31]
  v_exp_f32 v134, v134
  v_mfma_f32_16x16x32_bf16 v[60:63], a[252:255], v[164:167], v[60:63]
  s_barrier
  v_mfma_f32_16x16x32_bf16 v[144:147], a[192:195], a[160:163], 0
  v_exp_f32 v135, v135
  v_mfma_f32_16x16x32_bf16 v[152:155], a[192:195], a[176:179], 0
  v_add_f32 v238, v135, v238
  v_cvt_pk_bf16_f32 v160, v128, v129
  v_mfma_f32_16x16x32_bf16 v[144:147], a[196:199], a[164:167], v[144:147]
  ds_read_b128 a[192:195], v240 offset:24576
  v_exp_f32 v136, v136
  v_mfma_f32_16x16x32_bf16 v[152:155], a[196:199], a[180:183], v[152:155]
  v_add_f32 v239, v136, v239
  v_cvt_pk_bf16_f32 v161, v130, v131
  v_mfma_f32_16x16x32_bf16 v[144:147], a[200:203], a[168:171], v[144:147]
  ds_read_b128 a[196:199], v241 offset:24576
  v_exp_f32 v137, v137
  v_mfma_f32_16x16x32_bf16 v[152:155], a[200:203], a[184:187], v[152:155]
  v_add_f32 v239, v137, v239
  v_cvt_pk_bf16_f32 v162, v132, v133
  v_mfma_f32_16x16x32_bf16 v[144:147], a[204:207], a[172:175], v[144:147]
  ds_read_b128 a[200:203], v242 offset:24576
  v_exp_f32 v138, v138
  v_mfma_f32_16x16x32_bf16 v[152:155], a[204:207], a[188:191], v[152:155]
  v_add_f32 v239, v138, v239
  v_cvt_pk_bf16_f32 v163, v134, v135
  v_mfma_f32_16x16x32_bf16 v[148:151], a[208:211], a[160:163], 0
  ds_read_b128 a[204:207], v243 offset:24576
  v_exp_f32 v139, v139
  v_mfma_f32_16x16x32_bf16 v[156:159], a[208:211], a[176:179], 0
  v_add_f32 v239, v139, v239
  v_cvt_pk_bf16_f32 v164, v136, v137
  v_mfma_f32_16x16x32_bf16 v[148:151], a[212:215], a[164:167], v[148:151]
  ds_read_b128 a[208:211], v240 offset:28672
  v_exp_f32 v140, v140
  v_mfma_f32_16x16x32_bf16 v[156:159], a[212:215], a[180:183], v[156:159]
  v_add_f32 v239, v140, v239
  v_cvt_pk_bf16_f32 v165, v138, v139
  v_mfma_f32_16x16x32_bf16 v[148:151], a[216:219], a[168:171], v[148:151]
  ds_read_b128 a[212:215], v241 offset:28672
  v_exp_f32 v141, v141
  v_mfma_f32_16x16x32_bf16 v[156:159], a[216:219], a[184:187], v[156:159]
  v_add_f32 v239, v141, v239
  v_cvt_pk_bf16_f32 v166, v140, v141
  v_mfma_f32_16x16x32_bf16 v[148:151], a[220:223], a[172:175], v[148:151]
  ds_read_b128 a[216:219], v242 offset:28672
  v_exp_f32 v142, v142
  v_mfma_f32_16x16x32_bf16 v[156:159], a[220:223], a[188:191], v[156:159]
  v_add_f32 v238, v134, v238
  v_add_f32 v239, v142, v239
  v_mfma_f32_16x16x32_bf16 v[64:67], a[224:227], v[168:171], v[64:67]
  ds_read_b128 a[220:223], v243 offset:28672
  v_exp_f32 v143, v143
  v_mfma_f32_16x16x32_bf16 v[96:99], a[224:227], v[172:175], v[96:99]
  v_add_f32 v239, v143, v239
  v_cvt_pk_bf16_f32 v167, v142, v143
  v_mfma_f32_16x16x32_bf16 v[68:71], a[228:231], v[168:171], v[68:71]
  ds_read_b64_tr_b16 a[224:225], v244 offset:0
  ds_read_b64_tr_b16 a[226:227], v244 offset:4096
  v_exp_f32 v144, v144
  v_mfma_f32_16x16x32_bf16 v[100:103], a[228:231], v[172:175], v[100:103]
  v_add_f32 v222, v144, v222
  v_mfma_f32_16x16x32_bf16 v[72:75], a[232:235], v[168:171], v[72:75]
  ds_read_b64_tr_b16 a[228:229], v245 offset:0
  ds_read_b64_tr_b16 a[230:231], v245 offset:4096
  v_exp_f32 v145, v145
  v_mfma_f32_16x16x32_bf16 v[104:107], a[232:235], v[172:175], v[104:107]
  v_add_f32 v222, v145, v222
  v_mfma_f32_16x16x32_bf16 v[76:79], a[236:239], v[168:171], v[76:79]
  ds_read_b64_tr_b16 a[232:233], v246 offset:0
  ds_read_b64_tr_b16 a[234:235], v246 offset:4096
  v_exp_f32 v146, v146
  v_mfma_f32_16x16x32_bf16 v[108:111], a[236:239], v[172:175], v[108:111]
  v_add_f32 v222, v146, v222
  v_mfma_f32_16x16x32_bf16 v[80:83], a[240:243], v[168:171], v[80:83]
  ds_read_b64_tr_b16 a[236:237], v247 offset:0
  ds_read_b64_tr_b16 a[238:239], v247 offset:4096
  v_exp_f32 v147, v147
  v_mfma_f32_16x16x32_bf16 v[112:115], a[240:243], v[172:175], v[112:115]
  v_add_f32 v222, v147, v222
  v_mfma_f32_16x16x32_bf16 v[84:87], a[244:247], v[168:171], v[84:87]
  ds_read_b64_tr_b16 a[240:241], v248 offset:0
  ds_read_b64_tr_b16 a[242:243], v248 offset:4096
  v_exp_f32 v148, v148
  v_mfma_f32_16x16x32_bf16 v[116:119], a[244:247], v[172:175], v[116:119]
  v_add_f32 v222, v148, v222
  v_mfma_f32_16x16x32_bf16 v[88:91], a[248:251], v[168:171], v[88:91]
  ds_read_b64_tr_b16 a[244:245], v249 offset:0
  ds_read_b64_tr_b16 a[246:247], v249 offset:4096
  v_exp_f32 v149, v149
  v_mfma_f32_16x16x32_bf16 v[120:123], a[248:251], v[172:175], v[120:123]
  v_add_f32 v222, v149, v222
  v_mfma_f32_16x16x32_bf16 v[92:95], a[252:255], v[168:171], v[92:95]
  ds_read_b64_tr_b16 a[248:249], v250 offset:0
  ds_read_b64_tr_b16 a[250:251], v250 offset:4096
  v_exp_f32 v150, v150
  v_mfma_f32_16x16x32_bf16 v[124:127], a[252:255], v[172:175], v[124:127]
  ds_read_b64_tr_b16 a[252:253], v251 offset:0
  ds_read_b64_tr_b16 a[254:255], v251 offset:4096
  s_waitcnt lgkmcnt(15)
  v_mfma_f32_16x16x32_bf16 v[128:131], a[192:195], a[128:131], 0
  v_exp_f32 v151, v151
  v_mfma_f32_16x16x32_bf16 v[136:139], a[192:195], a[144:147], 0
  v_add_f32 v222, v150, v222
  v_cvt_pk_bf16_f32 v168, v144, v145
  v_mfma_f32_16x16x32_bf16 v[128:131], a[196:199], a[132:135], v[128:131]
  v_exp_f32 v152, v152
  v_mfma_f32_16x16x32_bf16 v[136:139], a[196:199], a[148:151], v[136:139]
  v_add_f32 v222, v151, v222
  v_cvt_pk_bf16_f32 v169, v146, v147
  v_mfma_f32_16x16x32_bf16 v[128:131], a[200:203], a[136:139], v[128:131]
  v_exp_f32 v153, v153
  v_mfma_f32_16x16x32_bf16 v[136:139], a[200:203], a[152:155], v[136:139]
  v_add_f32 v223, v152, v223
  v_cvt_pk_bf16_f32 v170, v148, v149
  v_mfma_f32_16x16x32_bf16 v[128:131], a[204:207], a[140:143], v[128:131]
  v_exp_f32 v154, v154
  v_mfma_f32_16x16x32_bf16 v[136:139], a[204:207], a[156:159], v[136:139]
  v_add_f32 v223, v153, v223
  v_cvt_pk_bf16_f32 v171, v150, v151
  v_mfma_f32_16x16x32_bf16 v[132:135], a[208:211], a[128:131], 0
  v_exp_f32 v155, v155
  v_mfma_f32_16x16x32_bf16 v[140:143], a[208:211], a[144:147], 0
  v_add_f32 v223, v154, v223
  v_cvt_pk_bf16_f32 v172, v152, v153
  v_mfma_f32_16x16x32_bf16 v[132:135], a[212:215], a[132:135], v[132:135]
  v_exp_f32 v156, v156
  v_mfma_f32_16x16x32_bf16 v[140:143], a[212:215], a[148:151], v[140:143]
  v_add_f32 v223, v155, v223
  v_cvt_pk_bf16_f32 v173, v154, v155
  v_mfma_f32_16x16x32_bf16 v[132:135], a[216:219], a[136:139], v[132:135]
  v_exp_f32 v157, v157
  v_mfma_f32_16x16x32_bf16 v[140:143], a[216:219], a[152:155], v[140:143]
  v_add_f32 v223, v156, v223
  v_cvt_pk_bf16_f32 v174, v156, v157
  v_mfma_f32_16x16x32_bf16 v[132:135], a[220:223], a[140:143], v[132:135]
  v_exp_f32 v158, v158
  v_mfma_f32_16x16x32_bf16 v[140:143], a[220:223], a[156:159], v[140:143]
  v_add_f32 v223, v157, v223
  v_add_f32 v223, v158, v223
  s_waitcnt lgkmcnt(0)
  v_mfma_f32_16x16x32_bf16 v[0:3], a[224:227], v[160:163], v[0:3]
  v_exp_f32 v159, v159
  v_mfma_f32_16x16x32_bf16 v[32:35], a[224:227], v[164:167], v[32:35]
  v_add_f32 v223, v159, v223
  v_cvt_pk_bf16_f32 v175, v158, v159
  v_mfma_f32_16x16x32_bf16 v[4:7], a[228:231], v[160:163], v[4:7]
  v_exp_f32 v128, v128
  v_mfma_f32_16x16x32_bf16 v[36:39], a[228:231], v[164:167], v[36:39]
  v_add_f32 v238, v128, v238
  v_mfma_f32_16x16x32_bf16 v[8:11], a[232:235], v[160:163], v[8:11]
  v_exp_f32 v129, v129
  v_mfma_f32_16x16x32_bf16 v[40:43], a[232:235], v[164:167], v[40:43]
  v_add_f32 v238, v129, v238
  v_mfma_f32_16x16x32_bf16 v[12:15], a[236:239], v[160:163], v[12:15]
  v_exp_f32 v130, v130
  v_mfma_f32_16x16x32_bf16 v[44:47], a[236:239], v[164:167], v[44:47]
  v_add_f32 v238, v130, v238
  v_mfma_f32_16x16x32_bf16 v[16:19], a[240:243], v[160:163], v[16:19]
  v_exp_f32 v131, v131
  v_mfma_f32_16x16x32_bf16 v[48:51], a[240:243], v[164:167], v[48:51]
  v_add_f32 v238, v131, v238
  v_mfma_f32_16x16x32_bf16 v[20:23], a[244:247], v[160:163], v[20:23]
  v_exp_f32 v132, v132
  v_mfma_f32_16x16x32_bf16 v[52:55], a[244:247], v[164:167], v[52:55]
  v_add_f32 v238, v132, v238
  v_mfma_f32_16x16x32_bf16 v[24:27], a[248:251], v[160:163], v[24:27]
  v_exp_f32 v133, v133
  v_mfma_f32_16x16x32_bf16 v[56:59], a[248:251], v[164:167], v[56:59]
  v_add_f32 v238, v133, v238
  v_mfma_f32_16x16x32_bf16 v[28:31], a[252:255], v[160:163], v[28:31]
  v_exp_f32 v134, v134
  v_mfma_f32_16x16x32_bf16 v[60:63], a[252:255], v[164:167], v[60:63]
  s_barrier
  v_mfma_f32_16x16x32_bf16 v[144:147], a[192:195], a[160:163], 0
  v_exp_f32 v135, v135
  v_mfma_f32_16x16x32_bf16 v[152:155], a[192:195], a[176:179], 0
  v_add_f32 v238, v135, v238
  v_cvt_pk_bf16_f32 v160, v128, v129
  v_mfma_f32_16x16x32_bf16 v[144:147], a[196:199], a[164:167], v[144:147]
  ds_read_b128 a[192:195], v240 offset:32768
  v_exp_f32 v136, v136
  v_mfma_f32_16x16x32_bf16 v[152:155], a[196:199], a[180:183], v[152:155]
  v_add_f32 v239, v136, v239
  v_cvt_pk_bf16_f32 v161, v130, v131
  v_mfma_f32_16x16x32_bf16 v[144:147], a[200:203], a[168:171], v[144:147]
  ds_read_b128 a[196:199], v241 offset:32768
  v_exp_f32 v137, v137
  v_mfma_f32_16x16x32_bf16 v[152:155], a[200:203], a[184:187], v[152:155]
  v_add_f32 v239, v137, v239
  v_cvt_pk_bf16_f32 v162, v132, v133
  v_mfma_f32_16x16x32_bf16 v[144:147], a[204:207], a[172:175], v[144:147]
  ds_read_b128 a[200:203], v242 offset:32768
  v_exp_f32 v138, v138
  v_mfma_f32_16x16x32_bf16 v[152:155], a[204:207], a[188:191], v[152:155]
  v_add_f32 v239, v138, v239
  v_cvt_pk_bf16_f32 v163, v134, v135
  v_mfma_f32_16x16x32_bf16 v[148:151], a[208:211], a[160:163], 0
  ds_read_b128 a[204:207], v243 offset:32768
  v_exp_f32 v139, v139
  v_mfma_f32_16x16x32_bf16 v[156:159], a[208:211], a[176:179], 0
  v_add_f32 v239, v139, v239
  v_cvt_pk_bf16_f32 v164, v136, v137
  v_mfma_f32_16x16x32_bf16 v[148:151], a[212:215], a[164:167], v[148:151]
  ds_read_b128 a[208:211], v240 offset:36864
  v_exp_f32 v140, v140
  v_mfma_f32_16x16x32_bf16 v[156:159], a[212:215], a[180:183], v[156:159]
  v_add_f32 v239, v140, v239
  v_cvt_pk_bf16_f32 v165, v138, v139
  v_mfma_f32_16x16x32_bf16 v[148:151], a[216:219], a[168:171], v[148:151]
  ds_read_b128 a[212:215], v241 offset:36864
  v_exp_f32 v141, v141
  v_mfma_f32_16x16x32_bf16 v[156:159], a[216:219], a[184:187], v[156:159]
  v_add_f32 v239, v141, v239
  v_cvt_pk_bf16_f32 v166, v140, v141
  v_mfma_f32_16x16x32_bf16 v[148:151], a[220:223], a[172:175], v[148:151]
  ds_read_b128 a[216:219], v242 offset:36864
  v_exp_f32 v142, v142
  v_mfma_f32_16x16x32_bf16 v[156:159], a[220:223], a[188:191], v[156:159]
  v_add_f32 v238, v134, v238
  v_add_f32 v239, v142, v239
  v_mfma_f32_16x16x32_bf16 v[64:67], a[224:227], v[168:171], v[64:67]
  ds_read_b128 a[220:223], v243 offset:36864
  v_exp_f32 v143, v143
  v_mfma_f32_16x16x32_bf16 v[96:99], a[224:227], v[172:175], v[96:99]
  v_add_f32 v239, v143, v239
  v_cvt_pk_bf16_f32 v167, v142, v143
  v_mfma_f32_16x16x32_bf16 v[68:71], a[228:231], v[168:171], v[68:71]
  ds_read_b64_tr_b16 a[224:225], v244 offset:8192
  ds_read_b64_tr_b16 a[226:227], v244 offset:12288
  v_exp_f32 v144, v144
  v_mfma_f32_16x16x32_bf16 v[100:103], a[228:231], v[172:175], v[100:103]
  v_add_f32 v222, v144, v222
  v_mfma_f32_16x16x32_bf16 v[72:75], a[232:235], v[168:171], v[72:75]
  ds_read_b64_tr_b16 a[228:229], v245 offset:8192
  ds_read_b64_tr_b16 a[230:231], v245 offset:12288
  v_exp_f32 v145, v145
  v_mfma_f32_16x16x32_bf16 v[104:107], a[232:235], v[172:175], v[104:107]
  v_add_f32 v222, v145, v222
  v_mfma_f32_16x16x32_bf16 v[76:79], a[236:239], v[168:171], v[76:79]
  ds_read_b64_tr_b16 a[232:233], v246 offset:8192
  ds_read_b64_tr_b16 a[234:235], v246 offset:12288
  v_exp_f32 v146, v146
  v_mfma_f32_16x16x32_bf16 v[108:111], a[236:239], v[172:175], v[108:111]
  v_add_f32 v222, v146, v222
  v_mfma_f32_16x16x32_bf16 v[80:83], a[240:243], v[168:171], v[80:83]
  ds_read_b64_tr_b16 a[236:237], v247 offset:8192
  ds_read_b64_tr_b16 a[238:239], v247 offset:12288
  v_exp_f32 v147, v147
  v_mfma_f32_16x16x32_bf16 v[112:115], a[240:243], v[172:175], v[112:115]
  v_add_f32 v222, v147, v222
  v_mfma_f32_16x16x32_bf16 v[84:87], a[244:247], v[168:171], v[84:87]
  ds_read_b64_tr_b16 a[240:241], v248 offset:8192
  ds_read_b64_tr_b16 a[242:243], v248 offset:12288
  v_exp_f32 v148, v148
  v_mfma_f32_16x16x32_bf16 v[116:119], a[244:247], v[172:175], v[116:119]
  v_add_f32 v222, v148, v222
  v_mfma_f32_16x16x32_bf16 v[88:91], a[248:251], v[168:171], v[88:91]
  ds_read_b64_tr_b16 a[244:245], v249 offset:8192
  ds_read_b64_tr_b16 a[246:247], v249 offset:12288
  v_exp_f32 v149, v149
  v_mfma_f32_16x16x32_bf16 v[120:123], a[248:251], v[172:175], v[120:123]
  v_add_f32 v222, v149, v222
  v_mfma_f32_16x16x32_bf16 v[92:95], a[252:255], v[168:171], v[92:95]
  ds_read_b64_tr_b16 a[248:249], v250 offset:8192
  ds_read_b64_tr_b16 a[250:251], v250 offset:12288
  v_exp_f32 v150, v150
  v_mfma_f32_16x16x32_bf16 v[124:127], a[252:255], v[172:175], v[124:127]
  ds_read_b64_tr_b16 a[252:253], v251 offset:8192
  ds_read_b64_tr_b16 a[254:255], v251 offset:12288
  s_waitcnt lgkmcnt(15)
  v_mfma_f32_16x16x32_bf16 v[128:131], a[192:195], a[128:131], 0
  v_exp_f32 v151, v151
  v_mfma_f32_16x16x32_bf16 v[136:139], a[192:195], a[144:147], 0
  v_add_f32 v222, v150, v222
  v_cvt_pk_bf16_f32 v168, v144, v145
  v_mfma_f32_16x16x32_bf16 v[128:131], a[196:199], a[132:135], v[128:131]
  v_exp_f32 v152, v152
  v_mfma_f32_16x16x32_bf16 v[136:139], a[196:199], a[148:151], v[136:139]
  v_add_f32 v222, v151, v222
  v_cvt_pk_bf16_f32 v169, v146, v147
  v_mfma_f32_16x16x32_bf16 v[128:131], a[200:203], a[136:139], v[128:131]
  v_exp_f32 v153, v153
  v_mfma_f32_16x16x32_bf16 v[136:139], a[200:203], a[152:155], v[136:139]
  v_add_f32 v223, v152, v223
  v_cvt_pk_bf16_f32 v170, v148, v149
  v_mfma_f32_16x16x32_bf16 v[128:131], a[204:207], a[140:143], v[128:131]
  v_exp_f32 v154, v154
  v_mfma_f32_16x16x32_bf16 v[136:139], a[204:207], a[156:159], v[136:139]
  v_add_f32 v223, v153, v223
  v_cvt_pk_bf16_f32 v171, v150, v151
  v_mfma_f32_16x16x32_bf16 v[132:135], a[208:211], a[128:131], 0
  v_exp_f32 v155, v155
  v_mfma_f32_16x16x32_bf16 v[140:143], a[208:211], a[144:147], 0
  v_add_f32 v223, v154, v223
  v_cvt_pk_bf16_f32 v172, v152, v153
  v_mfma_f32_16x16x32_bf16 v[132:135], a[212:215], a[132:135], v[132:135]
  v_exp_f32 v156, v156
  v_mfma_f32_16x16x32_bf16 v[140:143], a[212:215], a[148:151], v[140:143]
  v_add_f32 v223, v155, v223
  v_cvt_pk_bf16_f32 v173, v154, v155
  v_mfma_f32_16x16x32_bf16 v[132:135], a[216:219], a[136:139], v[132:135]
  v_exp_f32 v157, v157
  v_mfma_f32_16x16x32_bf16 v[140:143], a[216:219], a[152:155], v[140:143]
  v_add_f32 v223, v156, v223
  v_cvt_pk_bf16_f32 v174, v156, v157
  v_mfma_f32_16x16x32_bf16 v[132:135], a[220:223], a[140:143], v[132:135]
  v_exp_f32 v158, v158
  v_mfma_f32_16x16x32_bf16 v[140:143], a[220:223], a[156:159], v[140:143]
  v_add_f32 v223, v157, v223
  v_add_f32 v223, v158, v223
  s_waitcnt lgkmcnt(0)
  v_mfma_f32_16x16x32_bf16 v[0:3], a[224:227], v[160:163], v[0:3]
  v_exp_f32 v159, v159
  v_mfma_f32_16x16x32_bf16 v[32:35], a[224:227], v[164:167], v[32:35]
  v_add_f32 v223, v159, v223
  v_cvt_pk_bf16_f32 v175, v158, v159
  v_mfma_f32_16x16x32_bf16 v[4:7], a[228:231], v[160:163], v[4:7]
  v_exp_f32 v128, v128
  v_mfma_f32_16x16x32_bf16 v[36:39], a[228:231], v[164:167], v[36:39]
  v_add_f32 v238, v128, v238
  v_mfma_f32_16x16x32_bf16 v[8:11], a[232:235], v[160:163], v[8:11]
  v_exp_f32 v129, v129
  v_mfma_f32_16x16x32_bf16 v[40:43], a[232:235], v[164:167], v[40:43]
  v_add_f32 v238, v129, v238
  v_mfma_f32_16x16x32_bf16 v[12:15], a[236:239], v[160:163], v[12:15]
  v_exp_f32 v130, v130
  v_mfma_f32_16x16x32_bf16 v[44:47], a[236:239], v[164:167], v[44:47]
  v_add_f32 v238, v130, v238
  v_mfma_f32_16x16x32_bf16 v[16:19], a[240:243], v[160:163], v[16:19]
  v_exp_f32 v131, v131
  v_mfma_f32_16x16x32_bf16 v[48:51], a[240:243], v[164:167], v[48:51]
  v_add_f32 v238, v131, v238
  v_mfma_f32_16x16x32_bf16 v[20:23], a[244:247], v[160:163], v[20:23]
  v_exp_f32 v132, v132
  v_mfma_f32_16x16x32_bf16 v[52:55], a[244:247], v[164:167], v[52:55]
  v_add_f32 v238, v132, v238
  v_mfma_f32_16x16x32_bf16 v[24:27], a[248:251], v[160:163], v[24:27]
  v_exp_f32 v133, v133
  v_mfma_f32_16x16x32_bf16 v[56:59], a[248:251], v[164:167], v[56:59]
  v_add_f32 v238, v133, v238
  v_mfma_f32_16x16x32_bf16 v[28:31], a[252:255], v[160:163], v[28:31]
  v_exp_f32 v134, v134
  v_mfma_f32_16x16x32_bf16 v[60:63], a[252:255], v[164:167], v[60:63]
  s_barrier
  v_mfma_f32_16x16x32_bf16 v[144:147], a[192:195], a[160:163], 0
  v_exp_f32 v135, v135
  v_mfma_f32_16x16x32_bf16 v[152:155], a[192:195], a[176:179], 0
  v_add_f32 v238, v135, v238
  v_cvt_pk_bf16_f32 v160, v128, v129
  v_mfma_f32_16x16x32_bf16 v[144:147], a[196:199], a[164:167], v[144:147]
  v_exp_f32 v136, v136
  v_mfma_f32_16x16x32_bf16 v[152:155], a[196:199], a[180:183], v[152:155]
  v_add_f32 v239, v136, v239
  v_cvt_pk_bf16_f32 v161, v130, v131
  v_mfma_f32_16x16x32_bf16 v[144:147], a[200:203], a[168:171], v[144:147]
  v_exp_f32 v137, v137
  v_mfma_f32_16x16x32_bf16 v[152:155], a[200:203], a[184:187], v[152:155]
  v_add_f32 v239, v137, v239
  v_cvt_pk_bf16_f32 v162, v132, v133
  v_mfma_f32_16x16x32_bf16 v[144:147], a[204:207], a[172:175], v[144:147]
  v_exp_f32 v138, v138
  v_mfma_f32_16x16x32_bf16 v[152:155], a[204:207], a[188:191], v[152:155]
  v_add_f32 v239, v138, v239
  v_cvt_pk_bf16_f32 v163, v134, v135
  v_mfma_f32_16x16x32_bf16 v[148:151], a[208:211], a[160:163], 0
  v_exp_f32 v139, v139
  v_mfma_f32_16x16x32_bf16 v[156:159], a[208:211], a[176:179], 0
  v_add_f32 v239, v139, v239
  v_cvt_pk_bf16_f32 v164, v136, v137
  v_mfma_f32_16x16x32_bf16 v[148:151], a[212:215], a[164:167], v[148:151]
  v_exp_f32 v140, v140
  v_mfma_f32_16x16x32_bf16 v[156:159], a[212:215], a[180:183], v[156:159]
  v_add_f32 v239, v140, v239
  v_cvt_pk_bf16_f32 v165, v138, v139
  v_mfma_f32_16x16x32_bf16 v[148:151], a[216:219], a[168:171], v[148:151]
  v_exp_f32 v141, v141
  v_mfma_f32_16x16x32_bf16 v[156:159], a[216:219], a[184:187], v[156:159]
  v_add_f32 v239, v141, v239
  v_cvt_pk_bf16_f32 v166, v140, v141
  v_mfma_f32_16x16x32_bf16 v[148:151], a[220:223], a[172:175], v[148:151]
  v_exp_f32 v142, v142
  v_mfma_f32_16x16x32_bf16 v[156:159], a[220:223], a[188:191], v[156:159]
  v_add_f32 v238, v134, v238
  v_add_f32 v239, v142, v239
  v_mfma_f32_16x16x32_bf16 v[64:67], a[224:227], v[168:171], v[64:67]
  v_exp_f32 v143, v143
  v_mfma_f32_16x16x32_bf16 v[96:99], a[224:227], v[172:175], v[96:99]
  v_add_f32 v239, v143, v239
  v_cvt_pk_bf16_f32 v167, v142, v143
  v_mfma_f32_16x16x32_bf16 v[68:71], a[228:231], v[168:171], v[68:71]
  ds_read_b64_tr_b16 a[224:225], v244 offset:16384
  ds_read_b64_tr_b16 a[226:227], v244 offset:20480
  v_exp_f32 v144, v144
  v_mfma_f32_16x16x32_bf16 v[100:103], a[228:231], v[172:175], v[100:103]
  v_add_f32 v222, v144, v222
  v_mfma_f32_16x16x32_bf16 v[72:75], a[232:235], v[168:171], v[72:75]
  ds_read_b64_tr_b16 a[228:229], v245 offset:16384
  ds_read_b64_tr_b16 a[230:231], v245 offset:20480
  v_exp_f32 v145, v145
  v_mfma_f32_16x16x32_bf16 v[104:107], a[232:235], v[172:175], v[104:107]
  v_add_f32 v222, v145, v222
  v_mfma_f32_16x16x32_bf16 v[76:79], a[236:239], v[168:171], v[76:79]
  ds_read_b64_tr_b16 a[232:233], v246 offset:16384
  ds_read_b64_tr_b16 a[234:235], v246 offset:20480
  v_exp_f32 v146, v146
  v_mfma_f32_16x16x32_bf16 v[108:111], a[236:239], v[172:175], v[108:111]
  v_add_f32 v222, v146, v222
  v_mfma_f32_16x16x32_bf16 v[80:83], a[240:243], v[168:171], v[80:83]
  ds_read_b64_tr_b16 a[236:237], v247 offset:16384
  ds_read_b64_tr_b16 a[238:239], v247 offset:20480
  v_exp_f32 v147, v147
  v_mfma_f32_16x16x32_bf16 v[112:115], a[240:243], v[172:175], v[112:115]
  v_add_f32 v222, v147, v222
  v_mfma_f32_16x16x32_bf16 v[84:87], a[244:247], v[168:171], v[84:87]
  ds_read_b64_tr_b16 a[240:241], v248 offset:16384
  ds_read_b64_tr_b16 a[242:243], v248 offset:20480
  v_exp_f32 v148, v148
  v_mfma_f32_16x16x32_bf16 v[116:119], a[244:247], v[172:175], v[116:119]
  v_add_f32 v222, v148, v222
  v_mfma_f32_16x16x32_bf16 v[88:91], a[248:251], v[168:171], v[88:91]
  ds_read_b64_tr_b16 a[244:245], v249 offset:16384
  ds_read_b64_tr_b16 a[246:247], v249 offset:20480
  v_exp_f32 v149, v149
  v_mfma_f32_16x16x32_bf16 v[120:123], a[248:251], v[172:175], v[120:123]
  v_add_f32 v222, v149, v222
  v_mfma_f32_16x16x32_bf16 v[92:95], a[252:255], v[168:171], v[92:95]
  ds_read_b64_tr_b16 a[248:249], v250 offset:16384
  ds_read_b64_tr_b16 a[250:251], v250 offset:20480
  v_exp_f32 v150, v150
  v_mfma_f32_16x16x32_bf16 v[124:127], a[252:255], v[172:175], v[124:127]
  ds_read_b64_tr_b16 a[252:253], v251 offset:16384
  ds_read_b64_tr_b16 a[254:255], v251 offset:20480
  v_exp_f32 v151, v151
  v_add_f32 v222, v150, v222
  v_cvt_pk_bf16_f32 v168, v144, v145
  v_exp_f32 v152, v152
  v_add_f32 v222, v151, v222
  v_cvt_pk_bf16_f32 v169, v146, v147
  v_exp_f32 v153, v153
  v_add_f32 v223, v152, v223
  v_cvt_pk_bf16_f32 v170, v148, v149
  v_exp_f32 v154, v154
  v_add_f32 v223, v153, v223
  v_cvt_pk_bf16_f32 v171, v150, v151
  v_exp_f32 v155, v155
  v_add_f32 v223, v154, v223
  v_cvt_pk_bf16_f32 v172, v152, v153
  v_exp_f32 v156, v156
  v_add_f32 v223, v155, v223
  v_cvt_pk_bf16_f32 v173, v154, v155
  v_exp_f32 v157, v157
  v_add_f32 v223, v156, v223
  v_cvt_pk_bf16_f32 v174, v156, v157
  v_exp_f32 v158, v158
  v_add_f32 v223, v157, v223
  v_add_f32 v223, v158, v223
  s_waitcnt lgkmcnt(0)
  v_mfma_f32_16x16x32_bf16 v[0:3], a[224:227], v[160:163], v[0:3]
  v_exp_f32 v159, v159
  v_mfma_f32_16x16x32_bf16 v[32:35], a[224:227], v[164:167], v[32:35]
  v_add_f32 v223, v159, v223
  v_cvt_pk_bf16_f32 v175, v158, v159
  v_mfma_f32_16x16x32_bf16 v[4:7], a[228:231], v[160:163], v[4:7]
  v_mfma_f32_16x16x32_bf16 v[36:39], a[228:231], v[164:167], v[36:39]
  v_mfma_f32_16x16x32_bf16 v[8:11], a[232:235], v[160:163], v[8:11]
  v_mfma_f32_16x16x32_bf16 v[40:43], a[232:235], v[164:167], v[40:43]
  v_mfma_f32_16x16x32_bf16 v[12:15], a[236:239], v[160:163], v[12:15]
  v_mfma_f32_16x16x32_bf16 v[44:47], a[236:239], v[164:167], v[44:47]
  v_mfma_f32_16x16x32_bf16 v[16:19], a[240:243], v[160:163], v[16:19]
  v_mfma_f32_16x16x32_bf16 v[48:51], a[240:243], v[164:167], v[48:51]
  v_mfma_f32_16x16x32_bf16 v[20:23], a[244:247], v[160:163], v[20:23]
  v_mfma_f32_16x16x32_bf16 v[52:55], a[244:247], v[164:167], v[52:55]
  v_mfma_f32_16x16x32_bf16 v[24:27], a[248:251], v[160:163], v[24:27]
  v_mfma_f32_16x16x32_bf16 v[56:59], a[248:251], v[164:167], v[56:59]
  v_mfma_f32_16x16x32_bf16 v[28:31], a[252:255], v[160:163], v[28:31]
  v_mfma_f32_16x16x32_bf16 v[60:63], a[252:255], v[164:167], v[60:63]
  s_waitcnt vmcnt(0)
  s_barrier
  v_mfma_f32_16x16x32_bf16 v[64:67], a[224:227], v[168:171], v[64:67]
  v_mfma_f32_16x16x32_bf16 v[96:99], a[224:227], v[172:175], v[96:99]
  v_mfma_f32_16x16x32_bf16 v[68:71], a[228:231], v[168:171], v[68:71]
  v_mfma_f32_16x16x32_bf16 v[100:103], a[228:231], v[172:175], v[100:103]
  v_mfma_f32_16x16x32_bf16 v[72:75], a[232:235], v[168:171], v[72:75]
  v_mfma_f32_16x16x32_bf16 v[104:107], a[232:235], v[172:175], v[104:107]
  v_mfma_f32_16x16x32_bf16 v[76:79], a[236:239], v[168:171], v[76:79]
  v_mfma_f32_16x16x32_bf16 v[108:111], a[236:239], v[172:175], v[108:111]
  v_mfma_f32_16x16x32_bf16 v[80:83], a[240:243], v[168:171], v[80:83]
  v_mfma_f32_16x16x32_bf16 v[112:115], a[240:243], v[172:175], v[112:115]
  v_mfma_f32_16x16x32_bf16 v[84:87], a[244:247], v[168:171], v[84:87]
  v_mfma_f32_16x16x32_bf16 v[116:119], a[244:247], v[172:175], v[116:119]
  v_mfma_f32_16x16x32_bf16 v[88:91], a[248:251], v[168:171], v[88:91]
  v_mfma_f32_16x16x32_bf16 v[120:123], a[248:251], v[172:175], v[120:123]
  v_mfma_f32_16x16x32_bf16 v[92:95], a[252:255], v[168:171], v[92:95]
  v_mfma_f32_16x16x32_bf16 v[124:127], a[252:255], v[172:175], v[124:127]
  v_mov_b32 v252, v238
  v_mov_b32 v254, v239
  v_mov_b32 v200, v222
  v_mov_b32 v202, v223
  s_nop 1
  v_permlane16_swap_b32 v238, v252
  v_permlane16_swap_b32 v239, v254
  v_permlane16_swap_b32 v222, v200
  v_permlane16_swap_b32 v223, v202
  v_add_f32 v238, v238, v252
  v_add_f32 v239, v239, v254
  v_add_f32 v222, v222, v200
  v_add_f32 v223, v223, v202
  v_mov_b32 v252, v238
  v_mov_b32 v254, v239
  v_mov_b32 v200, v222
  v_mov_b32 v202, v223
  s_nop 1
  v_permlane32_swap_b32 v238, v252
  v_permlane32_swap_b32 v239, v254
  v_permlane32_swap_b32 v222, v200
  v_permlane32_swap_b32 v223, v202
  v_add_f32 v238, v238, v252
  v_add_f32 v239, v239, v254
  v_add_f32 v222, v222, v200
  v_add_f32 v223, v223, v202
  v_rcp_f32 v252, v238
  v_rcp_f32 v254, v239
  v_rcp_f32 v200, v222
  v_rcp_f32 v202, v223
  s_nop 0
  s_mov_b32 s38, 0x2b800000
  s_mov_b32 s39, 0x53800000
  v_cmp_nle_f32 s[42:43], s38, v238
  v_cmp_nge_f32 vcc, s39, v238
  s_nop 1
  s_or_b64 s[42:43], s[42:43], vcc
  v_cmp_nle_f32 vcc, s38, v239
  s_nop 1
  s_or_b64 s[42:43], s[42:43], vcc
  v_cmp_nge_f32 vcc, s39, v239
  s_nop 1
  s_or_b64 s[42:43], s[42:43], vcc
  v_cmp_nle_f32 vcc, s38, v222
  s_nop 1
  s_or_b64 s[42:43], s[42:43], vcc
  v_cmp_nge_f32 vcc, s39, v222
  s_nop 1
  s_or_b64 s[42:43], s[42:43], vcc
  v_cmp_nle_f32 vcc, s38, v223
  s_nop 1
  s_or_b64 s[42:43], s[42:43], vcc
  v_cmp_nge_f32 vcc, s39, v223
  s_nop 1
  s_or_b64 s[42:43], s[42:43], vcc
  s_cmp_lg_u64 s[42:43], 0
  s_cbranch_scc1 L_slow_CW
L_resume_CW:
  ds_read_b64_tr_b16 a[192:193], v192 offset:0
  ds_read_b64_tr_b16 a[194:195], v192 offset:4096
  ds_read_b64_tr_b16 a[196:197], v193 offset:0
  ds_read_b64_tr_b16 a[198:199], v193 offset:4096
  ds_read_b64_tr_b16 a[200:201], v194 offset:0
  ds_read_b64_tr_b16 a[202:203], v194 offset:4096
  ds_read_b64_tr_b16 a[204:205], v195 offset:0
  ds_read_b64_tr_b16 a[206:207], v195 offset:4096
  ds_read_b64_tr_b16 a[208:209], v196 offset:0
  ds_read_b64_tr_b16 a[210:211], v196 offset:4096
  ds_read_b64_tr_b16 a[212:213], v197 offset:0
  ds_read_b64_tr_b16 a[214:215], v197 offset:4096
  ds_read_b64_tr_b16 a[216:217], v198 offset:0
  ds_read_b64_tr_b16 a[218:219], v198 offset:4096
  ds_read_b64_tr_b16 a[220:221], v199 offset:0
  ds_read_b64_tr_b16 a[222:223], v199 offset:4096
  v_pk_mul_f32 v[0:1], v[0:1], v[252:253] op_sel_hi:[1,0]
  v_pk_mul_f32 v[2:3], v[2:3], v[252:253] op_sel_hi:[1,0]
  v_pk_mul_f32 v[4:5], v[4:5], v[252:253] op_sel_hi:[1,0]
  v_pk_mul_f32 v[6:7], v[6:7], v[252:253] op_sel_hi:[1,0]
  v_cvt_pk_bf16_f32 v128, v0, v1
  v_cvt_pk_bf16_f32 v129, v2, v3
  v_cvt_pk_bf16_f32 v130, v4, v5
  v_cvt_pk_bf16_f32 v131, v6, v7
  s_add_u32 s39, s76, 0
  buffer_store_dwordx4 v[128:131], v204, s[60:63], s39 offen offset:0 sc1
  v_pk_mul_f32 v[8:9], v[8:9], v[252:253] op_sel_hi:[1,0]
  v_pk_mul_f32 v[10:11], v[10:11], v[252:253] op_sel_hi:[1,0]
  v_pk_mul_f32 v[12:13], v[12:13], v[252:253] op_sel_hi:[1,0]
  v_pk_mul_f32 v[14:15], v[14:15], v[252:253] op_sel_hi:[1,0]
  v_cvt_pk_bf16_f32 v132, v8, v9
  v_cvt_pk_bf16_f32 v133, v10, v11
  v_cvt_pk_bf16_f32 v134, v12, v13
  v_cvt_pk_bf16_f32 v135, v14, v15
  buffer_store_dwordx4 v[132:135], v204, s[60:63], s39 offen offset:1024 sc1
  v_pk_mul_f32 v[16:17], v[16:17], v[252:253] op_sel_hi:[1,0]
  v_pk_mul_f32 v[18:19], v[18:19], v[252:253] op_sel_hi:[1,0]
  v_pk_mul_f32 v[20:21], v[20:21], v[252:253] op_sel_hi:[1,0]
  v_pk_mul_f32 v[22:23], v[22:23], v[252:253] op_sel_hi:[1,0]
  v_cvt_pk_bf16_f32 v136, v16, v17
  v_cvt_pk_bf16_f32 v137, v18, v19
  v_cvt_pk_bf16_f32 v138, v20, v21
  v_cvt_pk_bf16_f32 v139, v22, v23
  buffer_store_dwordx4 v[136:139], v204, s[60:63], s39 offen offset:2048 sc1
  v_pk_mul_f32 v[24:25], v[24:25], v[252:253] op_sel_hi:[1,0]
  v_pk_mul_f32 v[26:27], v[26:27], v[252:253] op_sel_hi:[1,0]
  v_pk_mul_f32 v[28:29], v[28:29], v[252:253] op_sel_hi:[1,0]
  v_pk_mul_f32 v[30:31], v[30:31], v[252:253] op_sel_hi:[1,0]
  v_cvt_pk_bf16_f32 v140, v24, v25
  v_cvt_pk_bf16_f32 v141, v26, v27
  v_cvt_pk_bf16_f32 v142, v28, v29
  v_cvt_pk_bf16_f32 v143, v30, v31
  buffer_store_dwordx4 v[140:143], v204, s[60:63], s39 offen offset:3072 sc1
  v_pk_mul_f32 v[32:33], v[32:33], v[254:255] op_sel_hi:[1,0]
  v_pk_mul_f32 v[34:35], v[34:35], v[254:255] op_sel_hi:[1,0]
  v_pk_mul_f32 v[36:37], v[36:37], v[254:255] op_sel_hi:[1,0]
  v_pk_mul_f32 v[38:39], v[38:39], v[254:255] op_sel_hi:[1,0]
  v_cvt_pk_bf16_f32 v144, v32, v33
  v_cvt_pk_bf16_f32 v145, v34, v35
  v_cvt_pk_bf16_f32 v146, v36, v37
  v_cvt_pk_bf16_f32 v147, v38, v39
  s_add_u32 s39, s76, 4096
  buffer_store_dwordx4 v[144:147], v204, s[60:63], s39 offen offset:0 sc1
  v_pk_mul_f32 v[40:41], v[40:41], v[254:255] op_sel_hi:[1,0]
  v_pk_mul_f32 v[42:43], v[42:43], v[254:255] op_sel_hi:[1,0]
  v_pk_mul_f32 v[44:45], v[44:45], v[254:255] op_sel_hi:[1,0]
  v_pk_mul_f32 v[46:47], v[46:47], v[254:255] op_sel_hi:[1,0]
  v_cvt_pk_bf16_f32 v148, v40, v41
  v_cvt_pk_bf16_f32 v149, v42, v43
  v_cvt_pk_bf16_f32 v150, v44, v45
  v_cvt_pk_bf16_f32 v151, v46, v47
  buffer_store_dwordx4 v[148:151], v204, s[60:63], s39 offen offset:1024 sc1
  v_pk_mul_f32 v[48:49], v[48:49], v[254:255] op_sel_hi:[1,0]
  v_pk_mul_f32 v[50:51], v[50:51], v[254:255] op_sel_hi:[1,0]
  v_pk_mul_f32 v[52:53], v[52:53], v[254:255] op_sel_hi:[1,0]
  v_pk_mul_f32 v[54:55], v[54:55], v[254:255] op_sel_hi:[1,0]
  v_cvt_pk_bf16_f32 v152, v48, v49
  v_cvt_pk_bf16_f32 v153, v50, v51
  v_cvt_pk_bf16_f32 v154, v52, v53
  v_cvt_pk_bf16_f32 v155, v54, v55
  buffer_store_dwordx4 v[152:155], v204, s[60:63], s39 offen offset:2048 sc1
  v_pk_mul_f32 v[56:57], v[56:57], v[254:255] op_sel_hi:[1,0]
  v_pk_mul_f32 v[58:59], v[58:59], v[254:255] op_sel_hi:[1,0]
  v_pk_mul_f32 v[60:61], v[60:61], v[254:255] op_sel_hi:[1,0]
  v_pk_mul_f32 v[62:63], v[62:63], v[254:255] op_sel_hi:[1,0]
  v_cvt_pk_bf16_f32 v156, v56, v57
  v_cvt_pk_bf16_f32 v157, v58, v59
  v_cvt_pk_bf16_f32 v158, v60, v61
  v_cvt_pk_bf16_f32 v159, v62, v63
  buffer_store_dwordx4 v[156:159], v204, s[60:63], s39 offen offset:3072 sc1
  v_pk_mul_f32 v[64:65], v[64:65], v[200:201] op_sel_hi:[1,0]
  v_pk_mul_f32 v[66:67], v[66:67], v[200:201] op_sel_hi:[1,0]
  v_pk_mul_f32 v[68:69], v[68:69], v[200:201] op_sel_hi:[1,0]
  v_pk_mul_f32 v[70:71], v[70:71], v[200:201] op_sel_hi:[1,0]
  v_cvt_pk_bf16_f32 v160, v64, v65
  v_cvt_pk_bf16_f32 v161, v66, v67
  v_cvt_pk_bf16_f32 v162, v68, v69
  v_cvt_pk_bf16_f32 v163, v70, v71
  s_add_u32 s39, s76, 8192
  buffer_store_dwordx4 v[160:163], v204, s[60:63], s39 offen offset:0 sc1
  v_pk_mul_f32 v[72:73], v[72:73], v[200:201] op_sel_hi:[1,0]
  v_pk_mul_f32 v[74:75], v[74:75], v[200:201] op_sel_hi:[1,0]
  v_pk_mul_f32 v[76:77], v[76:77], v[200:201] op_sel_hi:[1,0]
  v_pk_mul_f32 v[78:79], v[78:79], v[200:201] op_sel_hi:[1,0]
  v_cvt_pk_bf16_f32 v164, v72, v73
  v_cvt_pk_bf16_f32 v165, v74, v75
  v_cvt_pk_bf16_f32 v166, v76, v77
  v_cvt_pk_bf16_f32 v167, v78, v79
  buffer_store_dwordx4 v[164:167], v204, s[60:63], s39 offen offset:1024 sc1
  v_pk_mul_f32 v[80:81], v[80:81], v[200:201] op_sel_hi:[1,0]
  v_pk_mul_f32 v[82:83], v[82:83], v[200:201] op_sel_hi:[1,0]
  v_pk_mul_f32 v[84:85], v[84:85], v[200:201] op_sel_hi:[1,0]
  v_pk_mul_f32 v[86:87], v[86:87], v[200:201] op_sel_hi:[1,0]
  v_cvt_pk_bf16_f32 v168, v80, v81
  v_cvt_pk_bf16_f32 v169, v82, v83
  v_cvt_pk_bf16_f32 v170, v84, v85
  v_cvt_pk_bf16_f32 v171, v86, v87
  buffer_store_dwordx4 v[168:171], v204, s[60:63], s39 offen offset:2048 sc1
  v_pk_mul_f32 v[88:89], v[88:89], v[200:201] op_sel_hi:[1,0]
  v_pk_mul_f32 v[90:91], v[90:91], v[200:201] op_sel_hi:[1,0]
  v_pk_mul_f32 v[92:93], v[92:93], v[200:201] op_sel_hi:[1,0]
  v_pk_mul_f32 v[94:95], v[94:95], v[200:201] op_sel_hi:[1,0]
  v_cvt_pk_bf16_f32 v172, v88, v89
  v_cvt_pk_bf16_f32 v173, v90, v91
  v_cvt_pk_bf16_f32 v174, v92, v93
  v_cvt_pk_bf16_f32 v175, v94, v95
  buffer_store_dwordx4 v[172:175], v204, s[60:63], s39 offen offset:3072 sc1
  v_pk_mul_f32 v[96:97], v[96:97], v[202:203] op_sel_hi:[1,0]
  v_pk_mul_f32 v[98:99], v[98:99], v[202:203] op_sel_hi:[1,0]
  v_pk_mul_f32 v[100:101], v[100:101], v[202:203] op_sel_hi:[1,0]
  v_pk_mul_f32 v[102:103], v[102:103], v[202:203] op_sel_hi:[1,0]
  v_cvt_pk_bf16_f32 v176, v96, v97
  v_cvt_pk_bf16_f32 v177, v98, v99
  v_cvt_pk_bf16_f32 v178, v100, v101
  v_cvt_pk_bf16_f32 v179, v102, v103
  s_add_u32 s39, s76, 12288
  buffer_store_dwordx4 v[176:179], v204, s[60:63], s39 offen offset:0 sc1
  v_pk_mul_f32 v[104:105], v[104:105], v[202:203] op_sel_hi:[1,0]
  v_pk_mul_f32 v[106:107], v[106:107], v[202:203] op_sel_hi:[1,0]
  v_pk_mul_f32 v[108:109], v[108:109], v[202:203] op_sel_hi:[1,0]
  v_pk_mul_f32 v[110:111], v[110:111], v[202:203] op_sel_hi:[1,0]
  v_cvt_pk_bf16_f32 v180, v104, v105
  v_cvt_pk_bf16_f32 v181, v106, v107
  v_cvt_pk_bf16_f32 v182, v108, v109
  v_cvt_pk_bf16_f32 v183, v110, v111
  buffer_store_dwordx4 v[180:183], v204, s[60:63], s39 offen offset:1024 sc1
  v_pk_mul_f32 v[112:113], v[112:113], v[202:203] op_sel_hi:[1,0]
  v_pk_mul_f32 v[114:115], v[114:115], v[202:203] op_sel_hi:[1,0]
  v_pk_mul_f32 v[116:117], v[116:117], v[202:203] op_sel_hi:[1,0]
  v_pk_mul_f32 v[118:119], v[118:119], v[202:203] op_sel_hi:[1,0]
  v_cvt_pk_bf16_f32 v184, v112, v113
  v_cvt_pk_bf16_f32 v185, v114, v115
  v_cvt_pk_bf16_f32 v186, v116, v117
  v_cvt_pk_bf16_f32 v187, v118, v119
  buffer_store_dwordx4 v[184:187], v204, s[60:63], s39 offen offset:2048 sc1
  v_pk_mul_f32 v[120:121], v[120:121], v[202:203] op_sel_hi:[1,0]
  v_pk_mul_f32 v[122:123], v[122:123], v[202:203] op_sel_hi:[1,0]
  v_pk_mul_f32 v[124:125], v[124:125], v[202:203] op_sel_hi:[1,0]
  v_pk_mul_f32 v[126:127], v[126:127], v[202:203] op_sel_hi:[1,0]
  v_cvt_pk_bf16_f32 v188, v120, v121
  v_cvt_pk_bf16_f32 v189, v122, v123
  v_cvt_pk_bf16_f32 v190, v124, v125
  v_cvt_pk_bf16_f32 v191, v126, v127
  buffer_store_dwordx4 v[188:191], v204, s[60:63], s39 offen offset:3072 sc1
  s_waitcnt lgkmcnt(0)
  v_mfma_f32_16x16x32_bf16 v[0:3], a[192:195], v[128:131], 0
  ds_read_b64_tr_b16 a[224:225], v192 offset:8192
  v_mfma_f32_16x16x32_bf16 v[32:35], a[192:195], v[144:147], 0
  ds_read_b64_tr_b16 a[226:227], v192 offset:12288
  v_mfma_f32_16x16x32_bf16 v[64:67], a[192:195], v[160:163], 0
  v_mfma_f32_16x16x32_bf16 v[96:99], a[192:195], v[176:179], 0
  ds_read_b64_tr_b16 a[228:229], v193 offset:8192
  v_mfma_f32_16x16x32_bf16 v[4:7], a[196:199], v[128:131], 0
  ds_read_b64_tr_b16 a[230:231], v193 offset:12288
  v_mfma_f32_16x16x32_bf16 v[36:39], a[196:199], v[144:147], 0
  v_mfma_f32_16x16x32_bf16 v[68:71], a[196:199], v[160:163], 0
  ds_read_b64_tr_b16 a[232:233], v194 offset:8192
  v_mfma_f32_16x16x32_bf16 v[100:103], a[196:199], v[176:179], 0
  ds_read_b64_tr_b16 a[234:235], v194 offset:12288
  v_mfma_f32_16x16x32_bf16 v[8:11], a[200:203], v[128:131], 0
  v_mfma_f32_16x16x32_bf16 v[40:43], a[200:203], v[144:147], 0
  ds_read_b64_tr_b16 a[236:237], v195 offset:8192
  v_mfma_f32_16x16x32_bf16 v[72:75], a[200:203], v[160:163], 0
  ds_read_b64_tr_b16 a[238:239], v195 offset:12288
  v_mfma_f32_16x16x32_bf16 v[104:107], a[200:203], v[176:179], 0
  v_mfma_f32_16x16x32_bf16 v[12:15], a[204:207], v[128:131], 0
  ds_read_b64_tr_b16 a[240:241], v196 offset:8192
  v_mfma_f32_16x16x32_bf16 v[44:47], a[204:207], v[144:147], 0
  ds_read_b64_tr_b16 a[242:243], v196 offset:12288
  v_mfma_f32_16x16x32_bf16 v[76:79], a[204:207], v[160:163], 0
  v_mfma_f32_16x16x32_bf16 v[108:111], a[204:207], v[176:179], 0
  ds_read_b64_tr_b16 a[244:245], v197 offset:8192
  v_mfma_f32_16x16x32_bf16 v[16:19], a[208:211], v[128:131], 0
  ds_read_b64_tr_b16 a[246:247], v197 offset:12288
  v_mfma_f32_16x16x32_bf16 v[48:51], a[208:211], v[144:147], 0
  v_mfma_f32_16x16x32_bf16 v[80:83], a[208:211], v[160:163], 0
  ds_read_b64_tr_b16 a[248:249], v198 offset:8192
  v_mfma_f32_16x16x32_bf16 v[112:115], a[208:211], v[176:179], 0
  ds_read_b64_tr_b16 a[250:251], v198 offset:12288
  v_mfma_f32_16x16x32_bf16 v[20:23], a[212:215], v[128:131], 0
  v_mfma_f32_16x16x32_bf16 v[52:55], a[212:215], v[144:147], 0
  ds_read_b64_tr_b16 a[252:253], v199 offset:8192
  v_mfma_f32_16x16x32_bf16 v[84:87], a[212:215], v[160:163], 0
  ds_read_b64_tr_b16 a[254:255], v199 offset:12288
  v_mfma_f32_16x16x32_bf16 v[116:119], a[212:215], v[176:179], 0
  v_mfma_f32_16x16x32_bf16 v[24:27], a[216:219], v[128:131], 0
  v_mfma_f32_16x16x32_bf16 v[56:59], a[216:219], v[144:147], 0
  v_mfma_f32_16x16x32_bf16 v[88:91], a[216:219], v[160:163], 0
  v_mfma_f32_16x16x32_bf16 v[120:123], a[216:219], v[176:179], 0
  v_mfma_f32_16x16x32_bf16 v[28:31], a[220:223], v[128:131], 0
  v_mfma_f32_16x16x32_bf16 v[60:63], a[220:223], v[144:147], 0
  v_mfma_f32_16x16x32_bf16 v[92:95], a[220:223], v[160:163], 0
  v_mfma_f32_16x16x32_bf16 v[124:127], a[220:223], v[176:179], 0
  s_waitcnt lgkmcnt(0)
  v_mfma_f32_16x16x32_bf16 v[0:3], a[224:227], v[132:135], v[0:3]
  ds_read_b64_tr_b16 a[192:193], v192 offset:16384
  v_mfma_f32_16x16x32_bf16 v[32:35], a[224:227], v[148:151], v[32:35]
  ds_read_b64_tr_b16 a[194:195], v192 offset:20480
  v_mfma_f32_16x16x32_bf16 v[64:67], a[224:227], v[164:167], v[64:67]
  v_mfma_f32_16x16x32_bf16 v[96:99], a[224:227], v[180:183], v[96:99]
  ds_read_b64_tr_b16 a[196:197], v193 offset:16384
  v_mfma_f32_16x16x32_bf16 v[4:7], a[228:231], v[132:135], v[4:7]
  ds_read_b64_tr_b16 a[198:199], v193 offset:20480
  v_mfma_f32_16x16x32_bf16 v[36:39], a[228:231], v[148:151], v[36:39]
  v_mfma_f32_16x16x32_bf16 v[68:71], a[228:231], v[164:167], v[68:71]
  ds_read_b64_tr_b16 a[200:201], v194 offset:16384
  v_mfma_f32_16x16x32_bf16 v[100:103], a[228:231], v[180:183], v[100:103]
  ds_read_b64_tr_b16 a[202:203], v194 offset:20480
  v_mfma_f32_16x16x32_bf16 v[8:11], a[232:235], v[132:135], v[8:11]
  v_mfma_f32_16x16x32_bf16 v[40:43], a[232:235], v[148:151], v[40:43]
  ds_read_b64_tr_b16 a[204:205], v195 offset:16384
  v_mfma_f32_16x16x32_bf16 v[72:75], a[232:235], v[164:167], v[72:75]
  ds_read_b64_tr_b16 a[206:207], v195 offset:20480
  v_mfma_f32_16x16x32_bf16 v[104:107], a[232:235], v[180:183], v[104:107]
  v_mfma_f32_16x16x32_bf16 v[12:15], a[236:239], v[132:135], v[12:15]
  ds_read_b64_tr_b16 a[208:209], v196 offset:16384
  v_mfma_f32_16x16x32_bf16 v[44:47], a[236:239], v[148:151], v[44:47]
  ds_read_b64_tr_b16 a[210:211], v196 offset:20480
  v_mfma_f32_16x16x32_bf16 v[76:79], a[236:239], v[164:167], v[76:79]
  v_mfma_f32_16x16x32_bf16 v[108:111], a[236:239], v[180:183], v[108:111]
  ds_read_b64_tr_b16 a[212:213], v197 offset:16384
  v_mfma_f32_16x16x32_bf16 v[16:19], a[240:243], v[132:135], v[16:19]
  ds_read_b64_tr_b16 a[214:215], v197 offset:20480
  v_mfma_f32_16x16x32_bf16 v[48:51], a[240:243], v[148:151], v[48:51]
  v_mfma_f32_16x16x32_bf16 v[80:83], a[240:243], v[164:167], v[80:83]
  ds_read_b64_tr_b16 a[216:217], v198 offset:16384
  v_mfma_f32_16x16x32_bf16 v[112:115], a[240:243], v[180:183], v[112:115]
  ds_read_b64_tr_b16 a[218:219], v198 offset:20480
  v_mfma_f32_16x16x32_bf16 v[20:23], a[244:247], v[132:135], v[20:23]
  v_mfma_f32_16x16x32_bf16 v[52:55], a[244:247], v[148:151], v[52:55]
  ds_read_b64_tr_b16 a[220:221], v199 offset:16384
  v_mfma_f32_16x16x32_bf16 v[84:87], a[244:247], v[164:167], v[84:87]
  ds_read_b64_tr_b16 a[222:223], v199 offset:20480
  v_mfma_f32_16x16x32_bf16 v[116:119], a[244:247], v[180:183], v[116:119]
  v_mfma_f32_16x16x32_bf16 v[24:27], a[248:251], v[132:135], v[24:27]
  v_mfma_f32_16x16x32_bf16 v[56:59], a[248:251], v[148:151], v[56:59]
  v_mfma_f32_16x16x32_bf16 v[88:91], a[248:251], v[164:167], v[88:91]
  v_mfma_f32_16x16x32_bf16 v[120:123], a[248:251], v[180:183], v[120:123]
  v_mfma_f32_16x16x32_bf16 v[28:31], a[252:255], v[132:135], v[28:31]
  v_mfma_f32_16x16x32_bf16 v[60:63], a[252:255], v[148:151], v[60:63]
  v_mfma_f32_16x16x32_bf16 v[92:95], a[252:255], v[164:167], v[92:95]
  v_mfma_f32_16x16x32_bf16 v[124:127], a[252:255], v[180:183], v[124:127]
  s_waitcnt vmcnt(8)
  s_barrier
  s_waitcnt lgkmcnt(0)
  v_mfma_f32_16x16x32_bf16 v[0:3], a[192:195], v[136:139], v[0:3]
  ds_read_b64_tr_b16 a[224:225], v192 offset:24576
  v_mfma_f32_16x16x32_bf16 v[32:35], a[192:195], v[152:155], v[32:35]
  ds_read_b64_tr_b16 a[226:227], v192 offset:28672
  v_mfma_f32_16x16x32_bf16 v[64:67], a[192:195], v[168:171], v[64:67]
  v_mfma_f32_16x16x32_bf16 v[96:99], a[192:195], v[184:187], v[96:99]
  ds_read_b64_tr_b16 a[228:229], v193 offset:24576
  v_mfma_f32_16x16x32_bf16 v[4:7], a[196:199], v[136:139], v[4:7]
  ds_read_b64_tr_b16 a[230:231], v193 offset:28672
  v_mfma_f32_16x16x32_bf16 v[36:39], a[196:199], v[152:155], v[36:39]
  v_mfma_f32_16x16x32_bf16 v[68:71], a[196:199], v[168:171], v[68:71]
  ds_read_b64_tr_b16 a[232:233], v194 offset:24576
  v_mfma_f32_16x16x32_bf16 v[100:103], a[196:199], v[184:187], v[100:103]
  ds_read_b64_tr_b16 a[234:235], v194 offset:28672
  v_mfma_f32_16x16x32_bf16 v[8:11], a[200:203], v[136:139], v[8:11]
  v_mfma_f32_16x16x32_bf16 v[40:43], a[200:203], v[152:155], v[40:43]
  ds_read_b64_tr_b16 a[236:237], v195 offset:24576
  v_mfma_f32_16x16x32_bf16 v[72:75], a[200:203], v[168:171], v[72:75]
  ds_read_b64_tr_b16 a[238:239], v195 offset:28672
  v_mfma_f32_16x16x32_bf16 v[104:107], a[200:203], v[184:187], v[104:107]
  v_mfma_f32_16x16x32_bf16 v[12:15], a[204:207], v[136:139], v[12:15]
  ds_read_b64_tr_b16 a[240:241], v196 offset:24576
  v_mfma_f32_16x16x32_bf16 v[44:47], a[204:207], v[152:155], v[44:47]
  ds_read_b64_tr_b16 a[242:243], v196 offset:28672
  v_mfma_f32_16x16x32_bf16 v[76:79], a[204:207], v[168:171], v[76:79]
  v_mfma_f32_16x16x32_bf16 v[108:111], a[204:207], v[184:187], v[108:111]
  ds_read_b64_tr_b16 a[244:245], v197 offset:24576
  v_mfma_f32_16x16x32_bf16 v[16:19], a[208:211], v[136:139], v[16:19]
  ds_read_b64_tr_b16 a[246:247], v197 offset:28672
  v_mfma_f32_16x16x32_bf16 v[48:51], a[208:211], v[152:155], v[48:51]
  v_mfma_f32_16x16x32_bf16 v[80:83], a[208:211], v[168:171], v[80:83]
  ds_read_b64_tr_b16 a[248:249], v198 offset:24576
  v_mfma_f32_16x16x32_bf16 v[112:115], a[208:211], v[184:187], v[112:115]
  ds_read_b64_tr_b16 a[250:251], v198 offset:28672
  v_mfma_f32_16x16x32_bf16 v[20:23], a[212:215], v[136:139], v[20:23]
  v_mfma_f32_16x16x32_bf16 v[52:55], a[212:215], v[152:155], v[52:55]
  ds_read_b64_tr_b16 a[252:253], v199 offset:24576
  v_mfma_f32_16x16x32_bf16 v[84:87], a[212:215], v[168:171], v[84:87]
  ds_read_b64_tr_b16 a[254:255], v199 offset:28672
  v_mfma_f32_16x16x32_bf16 v[116:119], a[212:215], v[184:187], v[116:119]
  v_mfma_f32_16x16x32_bf16 v[24:27], a[216:219], v[136:139], v[24:27]
  v_mfma_f32_16x16x32_bf16 v[56:59], a[216:219], v[152:155], v[56:59]
  v_mfma_f32_16x16x32_bf16 v[88:91], a[216:219], v[168:171], v[88:91]
  v_mfma_f32_16x16x32_bf16 v[120:123], a[216:219], v[184:187], v[120:123]
  v_mfma_f32_16x16x32_bf16 v[28:31], a[220:223], v[136:139], v[28:31]
  v_mfma_f32_16x16x32_bf16 v[60:63], a[220:223], v[152:155], v[60:63]
  v_mfma_f32_16x16x32_bf16 v[92:95], a[220:223], v[168:171], v[92:95]
  v_mfma_f32_16x16x32_bf16 v[124:127], a[220:223], v[184:187], v[124:127]
  s_waitcnt lgkmcnt(0)
  v_mfma_f32_16x16x32_bf16 v[0:3], a[224:227], v[140:143], v[0:3]
  ds_read_b64_tr_b16 a[192:193], v192 offset:32768
  v_mfma_f32_16x16x32_bf16 v[32:35], a[224:227], v[156:159], v[32:35]
  ds_read_b64_tr_b16 a[194:195], v192 offset:36864
  v_mfma_f32_16x16x32_bf16 v[64:67], a[224:227], v[172:175], v[64:67]
  v_mfma_f32_16x16x32_bf16 v[96:99], a[224:227], v[188:191], v[96:99]
  ds_read_b64_tr_b16 a[196:197], v193 offset:32768
  v_mfma_f32_16x16x32_bf16 v[4:7], a[228:231], v[140:143], v[4:7]
  ds_read_b64_tr_b16 a[198:199], v193 offset:36864
  v_mfma_f32_16x16x32_bf16 v[36:39], a[228:231], v[156:159], v[36:39]
  v_mfma_f32_16x16x32_bf16 v[68:71], a[228:231], v[172:175], v[68:71]
  ds_read_b64_tr_b16 a[200:201], v194 offset:32768
  v_mfma_f32_16x16x32_bf16 v[100:103], a[228:231], v[188:191], v[100:103]
  ds_read_b64_tr_b16 a[202:203], v194 offset:36864
  v_mfma_f32_16x16x32_bf16 v[8:11], a[232:235], v[140:143], v[8:11]
  v_mfma_f32_16x16x32_bf16 v[40:43], a[232:235], v[156:159], v[40:43]
  ds_read_b64_tr_b16 a[204:205], v195 offset:32768
  v_mfma_f32_16x16x32_bf16 v[72:75], a[232:235], v[172:175], v[72:75]
  ds_read_b64_tr_b16 a[206:207], v195 offset:36864
  v_mfma_f32_16x16x32_bf16 v[104:107], a[232:235], v[188:191], v[104:107]
  v_mfma_f32_16x16x32_bf16 v[12:15], a[236:239], v[140:143], v[12:15]
  ds_read_b64_tr_b16 a[208:209], v196 offset:32768
  v_mfma_f32_16x16x32_bf16 v[44:47], a[236:239], v[156:159], v[44:47]
  ds_read_b64_tr_b16 a[210:211], v196 offset:36864
  v_mfma_f32_16x16x32_bf16 v[76:79], a[236:239], v[172:175], v[76:79]
  v_mfma_f32_16x16x32_bf16 v[108:111], a[236:239], v[188:191], v[108:111]
  ds_read_b64_tr_b16 a[212:213], v197 offset:32768
  v_mfma_f32_16x16x32_bf16 v[16:19], a[240:243], v[140:143], v[16:19]
  ds_read_b64_tr_b16 a[214:215], v197 offset:36864
  v_mfma_f32_16x16x32_bf16 v[48:51], a[240:243], v[156:159], v[48:51]
  v_mfma_f32_16x16x32_bf16 v[80:83], a[240:243], v[172:175], v[80:83]
  ds_read_b64_tr_b16 a[216:217], v198 offset:32768
  v_mfma_f32_16x16x32_bf16 v[112:115], a[240:243], v[188:191], v[112:115]
  ds_read_b64_tr_b16 a[218:219], v198 offset:36864
  v_mfma_f32_16x16x32_bf16 v[20:23], a[244:247], v[140:143], v[20:23]
  v_mfma_f32_16x16x32_bf16 v[52:55], a[244:247], v[156:159], v[52:55]
  ds_read_b64_tr_b16 a[220:221], v199 offset:32768
  v_mfma_f32_16x16x32_bf16 v[84:87], a[244:247], v[172:175], v[84:87]
  ds_read_b64_tr_b16 a[222:223], v199 offset:36864
  v_mfma_f32_16x16x32_bf16 v[116:119], a[244:247], v[188:191], v[116:119]
  v_mfma_f32_16x16x32_bf16 v[24:27], a[248:251], v[140:143], v[24:27]
  v_mfma_f32_16x16x32_bf16 v[56:59], a[248:251], v[156:159], v[56:59]
  v_mfma_f32_16x16x32_bf16 v[88:91], a[248:251], v[172:175], v[88:91]
  v_mfma_f32_16x16x32_bf16 v[120:123], a[248:251], v[188:191], v[120:123]
  v_mfma_f32_16x16x32_bf16 v[28:31], a[252:255], v[140:143], v[28:31]
  v_mfma_f32_16x16x32_bf16 v[60:63], a[252:255], v[156:159], v[60:63]
  v_mfma_f32_16x16x32_bf16 v[92:95], a[252:255], v[172:175], v[92:95]
  v_mfma_f32_16x16x32_bf16 v[124:127], a[252:255], v[188:191], v[124:127]
  s_waitcnt vmcnt(0)
  s_barrier
  s_barrier
  s_add_u32 s39, s78, 0
  buffer_load_dwordx4 a[0:3], v204, s[60:63], s39 offen offset:0 sc1
  buffer_load_dwordx4 a[4:7], v204, s[60:63], s39 offen offset:1024 sc1
  buffer_load_dwordx4 a[8:11], v204, s[60:63], s39 offen offset:2048 sc1
  buffer_load_dwordx4 a[12:15], v204, s[60:63], s39 offen offset:3072 sc1
  s_add_u32 s39, s78, 4096
  buffer_load_dwordx4 a[16:19], v204, s[60:63], s39 offen offset:0 sc1
  buffer_load_dwordx4 a[20:23], v204, s[60:63], s39 offen offset:1024 sc1
  buffer_load_dwordx4 a[24:27], v204, s[60:63], s39 offen offset:2048 sc1
  buffer_load_dwordx4 a[28:31], v204, s[60:63], s39 offen offset:3072 sc1
  s_add_u32 s39, s79, 0
  buffer_load_dwordx4 a[64:67], v204, s[60:63], s39 offen offset:0 sc1
  buffer_load_dwordx4 a[68:71], v204, s[60:63], s39 offen offset:1024 sc1
  buffer_load_dwordx4 a[72:75], v204, s[60:63], s39 offen offset:2048 sc1
  buffer_load_dwordx4 a[76:79], v204, s[60:63], s39 offen offset:3072 sc1
  s_add_u32 s39, s79, 4096
  buffer_load_dwordx4 a[80:83], v204, s[60:63], s39 offen offset:0 sc1
  buffer_load_dwordx4 a[84:87], v204, s[60:63], s39 offen offset:1024 sc1
  buffer_load_dwordx4 a[88:91], v204, s[60:63], s39 offen offset:2048 sc1
  buffer_load_dwordx4 a[92:95], v204, s[60:63], s39 offen offset:3072 sc1
  s_add_u32 s39, s80, 0
  buffer_load_dwordx4 a[128:131], v204, s[60:63], s39 offen offset:0 sc1
  buffer_load_dwordx4 a[132:135], v204, s[60:63], s39 offen offset:1024 sc1
  buffer_load_dwordx4 a[136:139], v204, s[60:63], s39 offen offset:2048 sc1
  buffer_load_dwordx4 a[140:143], v204, s[60:63], s39 offen offset:3072 sc1
  s_add_u32 s39, s80, 4096
  buffer_load_dwordx4 a[144:147], v204, s[60:63], s39 offen offset:0 sc1
  buffer_load_dwordx4 a[148:151], v204, s[60:63], s39 offen offset:1024 sc1
  buffer_load_dwordx4 a[152:155], v204, s[60:63], s39 offen offset:2048 sc1
  buffer_load_dwordx4 a[156:159], v204, s[60:63], s39 offen offset:3072 sc1
  s_waitcnt vmcnt(16)
  s_waitcnt lgkmcnt(0)
  v_mfma_f32_16x16x32_bf16 v[0:3], a[192:195], a[0:3], v[0:3]
  ds_read_b64_tr_b16 a[224:225], v192 offset:40960
  ds_read_b64_tr_b16 a[226:227], v192 offset:45056
  v_mfma_f32_16x16x32_bf16 v[32:35], a[192:195], a[16:19], v[32:35]
  ds_read_b64_tr_b16 a[228:229], v193 offset:40960
  v_mfma_f32_16x16x32_bf16 v[4:7], a[196:199], a[0:3], v[4:7]
  ds_read_b64_tr_b16 a[230:231], v193 offset:45056
  v_mfma_f32_16x16x32_bf16 v[36:39], a[196:199], a[16:19], v[36:39]
  ds_read_b64_tr_b16 a[232:233], v194 offset:40960
  ds_read_b64_tr_b16 a[234:235], v194 offset:45056
  v_mfma_f32_16x16x32_bf16 v[8:11], a[200:203], a[0:3], v[8:11]
  ds_read_b64_tr_b16 a[236:237], v195 offset:40960
  v_mfma_f32_16x16x32_bf16 v[40:43], a[200:203], a[16:19], v[40:43]
  ds_read_b64_tr_b16 a[238:239], v195 offset:45056
  v_mfma_f32_16x16x32_bf16 v[12:15], a[204:207], a[0:3], v[12:15]
  ds_read_b64_tr_b16 a[240:241], v196 offset:40960
  ds_read_b64_tr_b16 a[242:243], v196 offset:45056
  v_mfma_f32_16x16x32_bf16 v[44:47], a[204:207], a[16:19], v[44:47]
  ds_read_b64_tr_b16 a[244:245], v197 offset:40960
  v_mfma_f32_16x16x32_bf16 v[16:19], a[208:211], a[0:3], v[16:19]
  ds_read_b64_tr_b16 a[246:247], v197 offset:45056
  v_mfma_f32_16x16x32_bf16 v[48:51], a[208:211], a[16:19], v[48:51]
  ds_read_b64_tr_b16 a[248:249], v198 offset:40960
  ds_read_b64_tr_b16 a[250:251], v198 offset:45056
  v_mfma_f32_16x16x32_bf16 v[20:23], a[212:215], a[0:3], v[20:23]
  ds_read_b64_tr_b16 a[252:253], v199 offset:40960
  v_mfma_f32_16x16x32_bf16 v[52:55], a[212:215], a[16:19], v[52:55]
  ds_read_b64_tr_b16 a[254:255], v199 offset:45056
  v_mfma_f32_16x16x32_bf16 v[24:27], a[216:219], a[0:3], v[24:27]
  v_mfma_f32_16x16x32_bf16 v[56:59], a[216:219], a[16:19], v[56:59]
  v_mfma_f32_16x16x32_bf16 v[28:31], a[220:223], a[0:3], v[28:31]
  v_mfma_f32_16x16x32_bf16 v[60:63], a[220:223], a[16:19], v[60:63]
  s_waitcnt lgkmcnt(0)
  v_mfma_f32_16x16x32_bf16 v[0:3], a[224:227], a[4:7], v[0:3]
  ds_read_b64_tr_b16 a[192:193], v192 offset:49152
  ds_read_b64_tr_b16 a[194:195], v192 offset:53248
  v_mfma_f32_16x16x32_bf16 v[32:35], a[224:227], a[20:23], v[32:35]
  ds_read_b64_tr_b16 a[196:197], v193 offset:49152
  v_mfma_f32_16x16x32_bf16 v[4:7], a[228:231], a[4:7], v[4:7]
  ds_read_b64_tr_b16 a[198:199], v193 offset:53248
  v_mfma_f32_16x16x32_bf16 v[36:39], a[228:231], a[20:23], v[36:39]
  ds_read_b64_tr_b16 a[200:201], v194 offset:49152
  ds_read_b64_tr_b16 a[202:203], v194 offset:53248
  v_mfma_f32_16x16x32_bf16 v[8:11], a[232:235], a[4:7], v[8:11]
  ds_read_b64_tr_b16 a[204:205], v195 offset:49152
  v_mfma_f32_16x16x32_bf16 v[40:43], a[232:235], a[20:23], v[40:43]
  ds_read_b64_tr_b16 a[206:207], v195 offset:53248
  v_mfma_f32_16x16x32_bf16 v[12:15], a[236:239], a[4:7], v[12:15]
  ds_read_b64_tr_b16 a[208:209], v196 offset:49152
  ds_read_b64_tr_b16 a[210:211], v196 offset:53248
  v_mfma_f32_16x16x32_bf16 v[44:47], a[236:239], a[20:23], v[44:47]
  ds_read_b64_tr_b16 a[212:213], v197 offset:49152
  v_mfma_f32_16x16x32_bf16 v[16:19], a[240:243], a[4:7], v[16:19]
  ds_read_b64_tr_b16 a[214:215], v197 offset:53248
  v_mfma_f32_16x16x32_bf16 v[48:51], a[240:243], a[20:23], v[48:51]
  ds_read_b64_tr_b16 a[216:217], v198 offset:49152
  ds_read_b64_tr_b16 a[218:219], v198 offset:53248
  v_mfma_f32_16x16x32_bf16 v[20:23], a[244:247], a[4:7], v[20:23]
  ds_read_b64_tr_b16 a[220:221], v199 offset:49152
  v_mfma_f32_16x16x32_bf16 v[52:55], a[244:247], a[20:23], v[52:55]
  ds_read_b64_tr_b16 a[222:223], v199 offset:53248
  v_mfma_f32_16x16x32_bf16 v[24:27], a[248:251], a[4:7], v[24:27]
  v_mfma_f32_16x16x32_bf16 v[56:59], a[248:251], a[20:23], v[56:59]
  v_mfma_f32_16x16x32_bf16 v[28:31], a[252:255], a[4:7], v[28:31]
  v_mfma_f32_16x16x32_bf16 v[60:63], a[252:255], a[20:23], v[60:63]
  s_waitcnt lgkmcnt(0)
  v_mfma_f32_16x16x32_bf16 v[0:3], a[192:195], a[8:11], v[0:3]
  ds_read_b64_tr_b16 a[224:225], v192 offset:57344
  ds_read_b64_tr_b16 a[226:227], v192 offset:61440
  v_mfma_f32_16x16x32_bf16 v[32:35], a[192:195], a[24:27], v[32:35]
  ds_read_b64_tr_b16 a[228:229], v193 offset:57344
  v_mfma_f32_16x16x32_bf16 v[4:7], a[196:199], a[8:11], v[4:7]
  ds_read_b64_tr_b16 a[230:231], v193 offset:61440
  v_mfma_f32_16x16x32_bf16 v[36:39], a[196:199], a[24:27], v[36:39]
  ds_read_b64_tr_b16 a[232:233], v194 offset:57344
  ds_read_b64_tr_b16 a[234:235], v194 offset:61440
  v_mfma_f32_16x16x32_bf16 v[8:11], a[200:203], a[8:11], v[8:11]
  ds_read_b64_tr_b16 a[236:237], v195 offset:57344
  v_mfma_f32_16x16x32_bf16 v[40:43], a[200:203], a[24:27], v[40:43]
  ds_read_b64_tr_b16 a[238:239], v195 offset:61440
  v_mfma_f32_16x16x32_bf16 v[12:15], a[204:207], a[8:11], v[12:15]
  ds_read_b64_tr_b16 a[240:241], v196 offset:57344
  ds_read_b64_tr_b16 a[242:243], v196 offset:61440
  v_mfma_f32_16x16x32_bf16 v[44:47], a[204:207], a[24:27], v[44:47]
  ds_read_b64_tr_b16 a[244:245], v197 offset:57344
  v_mfma_f32_16x16x32_bf16 v[16:19], a[208:211], a[8:11], v[16:19]
  ds_read_b64_tr_b16 a[246:247], v197 offset:61440
  v_mfma_f32_16x16x32_bf16 v[48:51], a[208:211], a[24:27], v[48:51]
  ds_read_b64_tr_b16 a[248:249], v198 offset:57344
  ds_read_b64_tr_b16 a[250:251], v198 offset:61440
  v_mfma_f32_16x16x32_bf16 v[20:23], a[212:215], a[8:11], v[20:23]
  ds_read_b64_tr_b16 a[252:253], v199 offset:57344
  v_mfma_f32_16x16x32_bf16 v[52:55], a[212:215], a[24:27], v[52:55]
  ds_read_b64_tr_b16 a[254:255], v199 offset:61440
  v_mfma_f32_16x16x32_bf16 v[24:27], a[216:219], a[8:11], v[24:27]
  v_mfma_f32_16x16x32_bf16 v[56:59], a[216:219], a[24:27], v[56:59]
  v_mfma_f32_16x16x32_bf16 v[28:31], a[220:223], a[8:11], v[28:31]
  v_mfma_f32_16x16x32_bf16 v[60:63], a[220:223], a[24:27], v[60:63]
  s_waitcnt lgkmcnt(0)
  v_mfma_f32_16x16x32_bf16 v[0:3], a[224:227], a[12:15], v[0:3]
  ds_read_b64_tr_b16 a[192:193], v205 offset:0
  ds_read_b64_tr_b16 a[194:195], v205 offset:4096
  v_mfma_f32_16x16x32_bf16 v[32:35], a[224:227], a[28:31], v[32:35]
  ds_read_b64_tr_b16 a[196:197], v206 offset:0
  v_mfma_f32_16x16x32_bf16 v[4:7], a[228:231], a[12:15], v[4:7]
  ds_read_b64_tr_b16 a[198:199], v206 offset:4096
  v_mfma_f32_16x16x32_bf16 v[36:39], a[228:231], a[28:31], v[36:39]
  ds_read_b64_tr_b16 a[200:201], v207 offset:0
  ds_read_b64_tr_b16 a[202:203], v207 offset:4096
  v_mfma_f32_16x16x32_bf16 v[8:11], a[232:235], a[12:15], v[8:11]
  ds_read_b64_tr_b16 a[204:205], v208 offset:0
  v_mfma_f32_16x16x32_bf16 v[40:43], a[232:235], a[28:31], v[40:43]
  ds_read_b64_tr_b16 a[206:207], v208 offset:4096
  v_mfma_f32_16x16x32_bf16 v[12:15], a[236:239], a[12:15], v[12:15]
  ds_read_b64_tr_b16 a[208:209], v209 offset:0
  ds_read_b64_tr_b16 a[210:211], v209 offset:4096
  v_mfma_f32_16x16x32_bf16 v[44:47], a[236:239], a[28:31], v[44:47]
  ds_read_b64_tr_b16 a[212:213], v210 offset:0
  v_mfma_f32_16x16x32_bf16 v[16:19], a[240:243], a[12:15], v[16:19]
  ds_read_b64_tr_b16 a[214:215], v210 offset:4096
  v_mfma_f32_16x16x32_bf16 v[48:51], a[240:243], a[28:31], v[48:51]
  ds_read_b64_tr_b16 a[216:217], v211 offset:0
  ds_read_b64_tr_b16 a[218:219], v211 offset:4096
  v_mfma_f32_16x16x32_bf16 v[20:23], a[244:247], a[12:15], v[20:23]
  ds_read_b64_tr_b16 a[220:221], v212 offset:0
  v_mfma_f32_16x16x32_bf16 v[52:55], a[244:247], a[28:31], v[52:55]
  ds_read_b64_tr_b16 a[222:223], v212 offset:4096
  v_mfma_f32_16x16x32_bf16 v[24:27], a[248:251], a[12:15], v[24:27]
  v_mfma_f32_16x16x32_bf16 v[56:59], a[248:251], a[28:31], v[56:59]
  v_mfma_f32_16x16x32_bf16 v[28:31], a[252:255], a[12:15], v[28:31]
  v_mfma_f32_16x16x32_bf16 v[60:63], a[252:255], a[28:31], v[60:63]
  s_barrier
  s_waitcnt vmcnt(8)
  s_waitcnt lgkmcnt(0)
  v_mfma_f32_16x16x32_bf16 v[0:3], a[192:195], a[64:67], v[0:3]
  ds_read_b64_tr_b16 a[224:225], v205 offset:8192
  ds_read_b64_tr_b16 a[226:227], v205 offset:12288
  s_add_u32 s39, s78, 8192
  v_mfma_f32_16x16x32_bf16 v[32:35], a[192:195], a[80:83], v[32:35]
  ds_read_b64_tr_b16 a[228:229], v206 offset:8192
  buffer_load_dwordx4 a[32:35], v204, s[60:63], s39 offen offset:0 sc1
  v_mfma_f32_16x16x32_bf16 v[4:7], a[196:199], a[64:67], v[4:7]
  ds_read_b64_tr_b16 a[230:231], v206 offset:12288
  buffer_load_dwordx4 a[36:39], v204, s[60:63], s39 offen offset:1024 sc1
  v_mfma_f32_16x16x32_bf16 v[36:39], a[196:199], a[80:83], v[36:39]
  ds_read_b64_tr_b16 a[232:233], v207 offset:8192
  ds_read_b64_tr_b16 a[234:235], v207 offset:12288
  buffer_load_dwordx4 a[40:43], v204, s[60:63], s39 offen offset:2048 sc1
  v_mfma_f32_16x16x32_bf16 v[8:11], a[200:203], a[64:67], v[8:11]
  ds_read_b64_tr_b16 a[236:237], v208 offset:8192
  buffer_load_dwordx4 a[44:47], v204, s[60:63], s39 offen offset:3072 sc1
  v_mfma_f32_16x16x32_bf16 v[40:43], a[200:203], a[80:83], v[40:43]
  ds_read_b64_tr_b16 a[238:239], v208 offset:12288
  s_add_u32 s39, s78, 12288
  v_mfma_f32_16x16x32_bf16 v[12:15], a[204:207], a[64:67], v[12:15]
  ds_read_b64_tr_b16 a[240:241], v209 offset:8192
  ds_read_b64_tr_b16 a[242:243], v209 offset:12288
  buffer_load_dwordx4 a[48:51], v204, s[60:63], s39 offen offset:0 sc1
  v_mfma_f32_16x16x32_bf16 v[44:47], a[204:207], a[80:83], v[44:47]
  ds_read_b64_tr_b16 a[244:245], v210 offset:8192
  buffer_load_dwordx4 a[52:55], v204, s[60:63], s39 offen offset:1024 sc1
  v_mfma_f32_16x16x32_bf16 v[16:19], a[208:211], a[64:67], v[16:19]
  ds_read_b64_tr_b16 a[246:247], v210 offset:12288
  buffer_load_dwordx4 a[56:59], v204, s[60:63], s39 offen offset:2048 sc1
  v_mfma_f32_16x16x32_bf16 v[48:51], a[208:211], a[80:83], v[48:51]
  ds_read_b64_tr_b16 a[248:249], v211 offset:8192
  ds_read_b64_tr_b16 a[250:251], v211 offset:12288
  buffer_load_dwordx4 a[60:63], v204, s[60:63], s39 offen offset:3072 sc1
  v_mfma_f32_16x16x32_bf16 v[20:23], a[212:215], a[64:67], v[20:23]
  ds_read_b64_tr_b16 a[252:253], v212 offset:8192
  s_add_u32 s39, s79, 8192
  v_mfma_f32_16x16x32_bf16 v[52:55], a[212:215], a[80:83], v[52:55]
  ds_read_b64_tr_b16 a[254:255], v212 offset:12288
  buffer_load_dwordx4 a[96:99], v204, s[60:63], s39 offen offset:0 sc1
  v_mfma_f32_16x16x32_bf16 v[24:27], a[216:219], a[64:67], v[24:27]
  buffer_load_dwordx4 a[100:103], v204, s[60:63], s39 offen offset:1024 sc1
  v_mfma_f32_16x16x32_bf16 v[56:59], a[216:219], a[80:83], v[56:59]
  buffer_load_dwordx4 a[104:107], v204, s[60:63], s39 offen offset:2048 sc1
  v_mfma_f32_16x16x32_bf16 v[28:31], a[220:223], a[64:67], v[28:31]
  buffer_load_dwordx4 a[108:111], v204, s[60:63], s39 offen offset:3072 sc1
  v_mfma_f32_16x16x32_bf16 v[60:63], a[220:223], a[80:83], v[60:63]
  s_waitcnt lgkmcnt(0)
  v_mfma_f32_16x16x32_bf16 v[0:3], a[224:227], a[68:71], v[0:3]
  ds_read_b64_tr_b16 a[192:193], v205 offset:16384
  ds_read_b64_tr_b16 a[194:195], v205 offset:20480
  s_add_u32 s39, s79, 12288
  v_mfma_f32_16x16x32_bf16 v[32:35], a[224:227], a[84:87], v[32:35]
  ds_read_b64_tr_b16 a[196:197], v206 offset:16384
  buffer_load_dwordx4 a[112:115], v204, s[60:63], s39 offen offset:0 sc1
  v_mfma_f32_16x16x32_bf16 v[4:7], a[228:231], a[68:71], v[4:7]
  ds_read_b64_tr_b16 a[198:199], v206 offset:20480
  buffer_load_dwordx4 a[116:119], v204, s[60:63], s39 offen offset:1024 sc1
  v_mfma_f32_16x16x32_bf16 v[36:39], a[228:231], a[84:87], v[36:39]
  ds_read_b64_tr_b16 a[200:201], v207 offset:16384
  ds_read_b64_tr_b16 a[202:203], v207 offset:20480
  buffer_load_dwordx4 a[120:123], v204, s[60:63], s39 offen offset:2048 sc1
  v_mfma_f32_16x16x32_bf16 v[8:11], a[232:235], a[68:71], v[8:11]
  ds_read_b64_tr_b16 a[204:205], v208 offset:16384
  buffer_load_dwordx4 a[124:127], v204, s[60:63], s39 offen offset:3072 sc1
  v_mfma_f32_16x16x32_bf16 v[40:43], a[232:235], a[84:87], v[40:43]
  ds_read_b64_tr_b16 a[206:207], v208 offset:20480
  s_add_u32 s39, s80, 8192
  v_mfma_f32_16x16x32_bf16 v[12:15], a[236:239], a[68:71], v[12:15]
  ds_read_b64_tr_b16 a[208:209], v209 offset:16384
  ds_read_b64_tr_b16 a[210:211], v209 offset:20480
  buffer_load_dwordx4 a[160:163], v204, s[60:63], s39 offen offset:0 sc1
  v_mfma_f32_16x16x32_bf16 v[44:47], a[236:239], a[84:87], v[44:47]
  ds_read_b64_tr_b16 a[212:213], v210 offset:16384
  buffer_load_dwordx4 a[164:167], v204, s[60:63], s39 offen offset:1024 sc1
  v_mfma_f32_16x16x32_bf16 v[16:19], a[240:243], a[68:71], v[16:19]
  ds_read_b64_tr_b16 a[214:215], v210 offset:20480
  buffer_load_dwordx4 a[168:171], v204, s[60:63], s39 offen offset:2048 sc1
  v_mfma_f32_16x16x32_bf16 v[48:51], a[240:243], a[84:87], v[48:51]
  ds_read_b64_tr_b16 a[216:217], v211 offset:16384
  ds_read_b64_tr_b16 a[218:219], v211 offset:20480
  buffer_load_dwordx4 a[172:175], v204, s[60:63], s39 offen offset:3072 sc1
  v_mfma_f32_16x16x32_bf16 v[20:23], a[244:247], a[68:71], v[20:23]
  ds_read_b64_tr_b16 a[220:221], v212 offset:16384
  s_add_u32 s39, s80, 12288
  v_mfma_f32_16x16x32_bf16 v[52:55], a[244:247], a[84:87], v[52:55]
  ds_read_b64_tr_b16 a[222:223], v212 offset:20480
  buffer_load_dwordx4 a[176:179], v204, s[60:63], s39 offen offset:0 sc1
  v_mfma_f32_16x16x32_bf16 v[24:27], a[248:251], a[68:71], v[24:27]
  buffer_load_dwordx4 a[180:183], v204, s[60:63], s39 offen offset:1024 sc1
  v_mfma_f32_16x16x32_bf16 v[56:59], a[248:251], a[84:87], v[56:59]
  buffer_load_dwordx4 a[184:187], v204, s[60:63], s39 offen offset:2048 sc1
  v_mfma_f32_16x16x32_bf16 v[28:31], a[252:255], a[68:71], v[28:31]
  buffer_load_dwordx4 a[188:191], v204, s[60:63], s39 offen offset:3072 sc1
  v_mfma_f32_16x16x32_bf16 v[60:63], a[252:255], a[84:87], v[60:63]
  s_waitcnt lgkmcnt(0)
  v_mfma_f32_16x16x32_bf16 v[0:3], a[192:195], a[72:75], v[0:3]
  ds_read_b64_tr_b16 a[224:225], v205 offset:24576
  ds_read_b64_tr_b16 a[226:227], v205 offset:28672
  v_mfma_f32_16x16x32_bf16 v[32:35], a[192:195], a[88:91], v[32:35]
  ds_read_b64_tr_b16 a[228:229], v206 offset:24576
  v_mfma_f32_16x16x32_bf16 v[4:7], a[196:199], a[72:75], v[4:7]
  ds_read_b64_tr_b16 a[230:231], v206 offset:28672
  v_mfma_f32_16x16x32_bf16 v[36:39], a[196:199], a[88:91], v[36:39]
  ds_read_b64_tr_b16 a[232:233], v207 offset:24576
  ds_read_b64_tr_b16 a[234:235], v207 offset:28672
  v_mfma_f32_16x16x32_bf16 v[8:11], a[200:203], a[72:75], v[8:11]
  ds_read_b64_tr_b16 a[236:237], v208 offset:24576
  v_mfma_f32_16x16x32_bf16 v[40:43], a[200:203], a[88:91], v[40:43]
  ds_read_b64_tr_b16 a[238:239], v208 offset:28672
  v_mfma_f32_16x16x32_bf16 v[12:15], a[204:207], a[72:75], v[12:15]
  ds_read_b64_tr_b16 a[240:241], v209 offset:24576
  ds_read_b64_tr_b16 a[242:243], v209 offset:28672
  v_mfma_f32_16x16x32_bf16 v[44:47], a[204:207], a[88:91], v[44:47]
  ds_read_b64_tr_b16 a[244:245], v210 offset:24576
  v_mfma_f32_16x16x32_bf16 v[16:19], a[208:211], a[72:75], v[16:19]
  ds_read_b64_tr_b16 a[246:247], v210 offset:28672
  v_mfma_f32_16x16x32_bf16 v[48:51], a[208:211], a[88:91], v[48:51]
  ds_read_b64_tr_b16 a[248:249], v211 offset:24576
  ds_read_b64_tr_b16 a[250:251], v211 offset:28672
  v_mfma_f32_16x16x32_bf16 v[20:23], a[212:215], a[72:75], v[20:23]
  ds_read_b64_tr_b16 a[252:253], v212 offset:24576
  v_mfma_f32_16x16x32_bf16 v[52:55], a[212:215], a[88:91], v[52:55]
  ds_read_b64_tr_b16 a[254:255], v212 offset:28672
  v_mfma_f32_16x16x32_bf16 v[24:27], a[216:219], a[72:75], v[24:27]
  v_mfma_f32_16x16x32_bf16 v[56:59], a[216:219], a[88:91], v[56:59]
  v_mfma_f32_16x16x32_bf16 v[28:31], a[220:223], a[72:75], v[28:31]
  v_mfma_f32_16x16x32_bf16 v[60:63], a[220:223], a[88:91], v[60:63]
  s_waitcnt lgkmcnt(0)
  v_mfma_f32_16x16x32_bf16 v[0:3], a[224:227], a[76:79], v[0:3]
  ds_read_b64_tr_b16 a[192:193], v244 offset:40960
  ds_read_b64_tr_b16 a[194:195], v244 offset:45056
  v_mfma_f32_16x16x32_bf16 v[32:35], a[224:227], a[92:95], v[32:35]
  ds_read_b64_tr_b16 a[196:197], v245 offset:40960
  v_mfma_f32_16x16x32_bf16 v[4:7], a[228:231], a[76:79], v[4:7]
  ds_read_b64_tr_b16 a[198:199], v245 offset:45056
  v_mfma_f32_16x16x32_bf16 v[36:39], a[228:231], a[92:95], v[36:39]
  ds_read_b64_tr_b16 a[200:201], v246 offset:40960
  ds_read_b64_tr_b16 a[202:203], v246 offset:45056
  v_mfma_f32_16x16x32_bf16 v[8:11], a[232:235], a[76:79], v[8:11]
  ds_read_b64_tr_b16 a[204:205], v247 offset:40960
  v_mfma_f32_16x16x32_bf16 v[40:43], a[232:235], a[92:95], v[40:43]
  ds_read_b64_tr_b16 a[206:207], v247 offset:45056
  v_mfma_f32_16x16x32_bf16 v[12:15], a[236:239], a[76:79], v[12:15]
  ds_read_b64_tr_b16 a[208:209], v248 offset:40960
  ds_read_b64_tr_b16 a[210:211], v248 offset:45056
  v_mfma_f32_16x16x32_bf16 v[44:47], a[236:239], a[92:95], v[44:47]
  ds_read_b64_tr_b16 a[212:213], v249 offset:40960
  v_mfma_f32_16x16x32_bf16 v[16:19], a[240:243], a[76:79], v[16:19]
  ds_read_b64_tr_b16 a[214:215], v249 offset:45056
  v_mfma_f32_16x16x32_bf16 v[48:51], a[240:243], a[92:95], v[48:51]
  ds_read_b64_tr_b16 a[216:217], v250 offset:40960
  ds_read_b64_tr_b16 a[218:219], v250 offset:45056
  v_mfma_f32_16x16x32_bf16 v[20:23], a[244:247], a[76:79], v[20:23]
  ds_read_b64_tr_b16 a[220:221], v251 offset:40960
  v_mfma_f32_16x16x32_bf16 v[52:55], a[244:247], a[92:95], v[52:55]
  ds_read_b64_tr_b16 a[222:223], v251 offset:45056
  v_mfma_f32_16x16x32_bf16 v[24:27], a[248:251], a[76:79], v[24:27]
  v_mfma_f32_16x16x32_bf16 v[56:59], a[248:251], a[92:95], v[56:59]
  v_mfma_f32_16x16x32_bf16 v[28:31], a[252:255], a[76:79], v[28:31]
  v_mfma_f32_16x16x32_bf16 v[60:63], a[252:255], a[92:95], v[60:63]
  s_waitcnt vmcnt(24)
  s_waitcnt lgkmcnt(0)
  v_mfma_f32_16x16x32_bf16 v[0:3], a[192:195], a[128:131], v[0:3]
  ds_read_b64_tr_b16 a[224:225], v244 offset:57344
  ds_read_b64_tr_b16 a[226:227], v244 offset:61440
  v_mfma_f32_16x16x32_bf16 v[32:35], a[192:195], a[144:147], v[32:35]
  ds_read_b64_tr_b16 a[228:229], v245 offset:57344
  v_mfma_f32_16x16x32_bf16 v[4:7], a[196:199], a[128:131], v[4:7]
  ds_read_b64_tr_b16 a[230:231], v245 offset:61440
  v_mfma_f32_16x16x32_bf16 v[36:39], a[196:199], a[144:147], v[36:39]
  ds_read_b64_tr_b16 a[232:233], v246 offset:57344
  ds_read_b64_tr_b16 a[234:235], v246 offset:61440
  v_mfma_f32_16x16x32_bf16 v[8:11], a[200:203], a[128:131], v[8:11]
  ds_read_b64_tr_b16 a[236:237], v247 offset:57344
  v_mfma_f32_16x16x32_bf16 v[40:43], a[200:203], a[144:147], v[40:43]
  ds_read_b64_tr_b16 a[238:239], v247 offset:61440
  v_mfma_f32_16x16x32_bf16 v[12:15], a[204:207], a[128:131], v[12:15]
  ds_read_b64_tr_b16 a[240:241], v248 offset:57344
  ds_read_b64_tr_b16 a[242:243], v248 offset:61440
  v_mfma_f32_16x16x32_bf16 v[44:47], a[204:207], a[144:147], v[44:47]
  ds_read_b64_tr_b16 a[244:245], v249 offset:57344
  v_mfma_f32_16x16x32_bf16 v[16:19], a[208:211], a[128:131], v[16:19]
  ds_read_b64_tr_b16 a[246:247], v249 offset:61440
  v_mfma_f32_16x16x32_bf16 v[48:51], a[208:211], a[144:147], v[48:51]
  ds_read_b64_tr_b16 a[248:249], v250 offset:57344
  ds_read_b64_tr_b16 a[250:251], v250 offset:61440
  v_mfma_f32_16x16x32_bf16 v[20:23], a[212:215], a[128:131], v[20:23]
  ds_read_b64_tr_b16 a[252:253], v251 offset:57344
  v_mfma_f32_16x16x32_bf16 v[52:55], a[212:215], a[144:147], v[52:55]
  ds_read_b64_tr_b16 a[254:255], v251 offset:61440
  v_mfma_f32_16x16x32_bf16 v[24:27], a[216:219], a[128:131], v[24:27]
  v_mfma_f32_16x16x32_bf16 v[56:59], a[216:219], a[144:147], v[56:59]
  v_mfma_f32_16x16x32_bf16 v[28:31], a[220:223], a[128:131], v[28:31]
  v_mfma_f32_16x16x32_bf16 v[60:63], a[220:223], a[144:147], v[60:63]
  s_waitcnt lgkmcnt(0)
  v_mfma_f32_16x16x32_bf16 v[0:3], a[224:227], a[132:135], v[0:3]
  ds_read_b64_tr_b16 a[192:193], v244 offset:24576
  ds_read_b64_tr_b16 a[194:195], v244 offset:28672
  v_mfma_f32_16x16x32_bf16 v[32:35], a[224:227], a[148:151], v[32:35]
  ds_read_b64_tr_b16 a[196:197], v245 offset:24576
  v_mfma_f32_16x16x32_bf16 v[4:7], a[228:231], a[132:135], v[4:7]
  ds_read_b64_tr_b16 a[198:199], v245 offset:28672
  v_mfma_f32_16x16x32_bf16 v[36:39], a[228:231], a[148:151], v[36:39]
  ds_read_b64_tr_b16 a[200:201], v246 offset:24576
  ds_read_b64_tr_b16 a[202:203], v246 offset:28672
  v_mfma_f32_16x16x32_bf16 v[8:11], a[232:235], a[132:135], v[8:11]
  ds_read_b64_tr_b16 a[204:205], v247 offset:24576
  v_mfma_f32_16x16x32_bf16 v[40:43], a[232:235], a[148:151], v[40:43]
  ds_read_b64_tr_b16 a[206:207], v247 offset:28672
  v_mfma_f32_16x16x32_bf16 v[12:15], a[236:239], a[132:135], v[12:15]
  ds_read_b64_tr_b16 a[208:209], v248 offset:24576
  ds_read_b64_tr_b16 a[210:211], v248 offset:28672
  v_mfma_f32_16x16x32_bf16 v[44:47], a[236:239], a[148:151], v[44:47]
  ds_read_b64_tr_b16 a[212:213], v249 offset:24576
  v_mfma_f32_16x16x32_bf16 v[16:19], a[240:243], a[132:135], v[16:19]
  ds_read_b64_tr_b16 a[214:215], v249 offset:28672
  v_mfma_f32_16x16x32_bf16 v[48:51], a[240:243], a[148:151], v[48:51]
  ds_read_b64_tr_b16 a[216:217], v250 offset:24576
  ds_read_b64_tr_b16 a[218:219], v250 offset:28672
  v_mfma_f32_16x16x32_bf16 v[20:23], a[244:247], a[132:135], v[20:23]
  ds_read_b64_tr_b16 a[220:221], v251 offset:24576
  v_mfma_f32_16x16x32_bf16 v[52:55], a[244:247], a[148:151], v[52:55]
  ds_read_b64_tr_b16 a[222:223], v251 offset:28672
  v_mfma_f32_16x16x32_bf16 v[24:27], a[248:251], a[132:135], v[24:27]
  v_mfma_f32_16x16x32_bf16 v[56:59], a[248:251], a[148:151], v[56:59]
  v_mfma_f32_16x16x32_bf16 v[28:31], a[252:255], a[132:135], v[28:31]
  v_mfma_f32_16x16x32_bf16 v[60:63], a[252:255], a[148:151], v[60:63]
  s_waitcnt lgkmcnt(0)
  v_mfma_f32_16x16x32_bf16 v[0:3], a[192:195], a[136:139], v[0:3]
  ds_read_b64_tr_b16 a[224:225], v244 offset:32768
  ds_read_b64_tr_b16 a[226:227], v244 offset:36864
  v_mfma_f32_16x16x32_bf16 v[32:35], a[192:195], a[152:155], v[32:35]
  ds_read_b64_tr_b16 a[228:229], v245 offset:32768
  v_mfma_f32_16x16x32_bf16 v[4:7], a[196:199], a[136:139], v[4:7]
  ds_read_b64_tr_b16 a[230:231], v245 offset:36864
  v_mfma_f32_16x16x32_bf16 v[36:39], a[196:199], a[152:155], v[36:39]
  ds_read_b64_tr_b16 a[232:233], v246 offset:32768
  ds_read_b64_tr_b16 a[234:235], v246 offset:36864
  v_mfma_f32_16x16x32_bf16 v[8:11], a[200:203], a[136:139], v[8:11]
  ds_read_b64_tr_b16 a[236:237], v247 offset:32768
  v_mfma_f32_16x16x32_bf16 v[40:43], a[200:203], a[152:155], v[40:43]
  ds_read_b64_tr_b16 a[238:239], v247 offset:36864
  v_mfma_f32_16x16x32_bf16 v[12:15], a[204:207], a[136:139], v[12:15]
  ds_read_b64_tr_b16 a[240:241], v248 offset:32768
  ds_read_b64_tr_b16 a[242:243], v248 offset:36864
  v_mfma_f32_16x16x32_bf16 v[44:47], a[204:207], a[152:155], v[44:47]
  ds_read_b64_tr_b16 a[244:245], v249 offset:32768
  v_mfma_f32_16x16x32_bf16 v[16:19], a[208:211], a[136:139], v[16:19]
  ds_read_b64_tr_b16 a[246:247], v249 offset:36864
  v_mfma_f32_16x16x32_bf16 v[48:51], a[208:211], a[152:155], v[48:51]
  ds_read_b64_tr_b16 a[248:249], v250 offset:32768
  ds_read_b64_tr_b16 a[250:251], v250 offset:36864
  v_mfma_f32_16x16x32_bf16 v[20:23], a[212:215], a[136:139], v[20:23]
  ds_read_b64_tr_b16 a[252:253], v251 offset:32768
  v_mfma_f32_16x16x32_bf16 v[52:55], a[212:215], a[152:155], v[52:55]
  ds_read_b64_tr_b16 a[254:255], v251 offset:36864
  v_mfma_f32_16x16x32_bf16 v[24:27], a[216:219], a[136:139], v[24:27]
  v_mfma_f32_16x16x32_bf16 v[56:59], a[216:219], a[152:155], v[56:59]
  v_mfma_f32_16x16x32_bf16 v[28:31], a[220:223], a[136:139], v[28:31]
  v_mfma_f32_16x16x32_bf16 v[60:63], a[220:223], a[152:155], v[60:63]
  s_waitcnt lgkmcnt(0)
  v_mfma_f32_16x16x32_bf16 v[0:3], a[224:227], a[140:143], v[0:3]
  ds_read_b64_tr_b16 a[192:193], v192 offset:32768
  ds_read_b64_tr_b16 a[194:195], v192 offset:36864
  v_mfma_f32_16x16x32_bf16 v[32:35], a[224:227], a[156:159], v[32:35]
  ds_read_b64_tr_b16 a[196:197], v193 offset:32768
  v_mfma_f32_16x16x32_bf16 v[4:7], a[228:231], a[140:143], v[4:7]
  ds_read_b64_tr_b16 a[198:199], v193 offset:36864
  v_mfma_f32_16x16x32_bf16 v[36:39], a[228:231], a[156:159], v[36:39]
  ds_read_b64_tr_b16 a[200:201], v194 offset:32768
  ds_read_b64_tr_b16 a[202:203], v194 offset:36864
  v_mfma_f32_16x16x32_bf16 v[8:11], a[232:235], a[140:143], v[8:11]
  ds_read_b64_tr_b16 a[204:205], v195 offset:32768
  v_mfma_f32_16x16x32_bf16 v[40:43], a[232:235], a[156:159], v[40:43]
  ds_read_b64_tr_b16 a[206:207], v195 offset:36864
  v_mfma_f32_16x16x32_bf16 v[12:15], a[236:239], a[140:143], v[12:15]
  ds_read_b64_tr_b16 a[208:209], v196 offset:32768
  ds_read_b64_tr_b16 a[210:211], v196 offset:36864
  v_mfma_f32_16x16x32_bf16 v[44:47], a[236:239], a[156:159], v[44:47]
  ds_read_b64_tr_b16 a[212:213], v197 offset:32768
  v_mfma_f32_16x16x32_bf16 v[16:19], a[240:243], a[140:143], v[16:19]
  ds_read_b64_tr_b16 a[214:215], v197 offset:36864
  v_mfma_f32_16x16x32_bf16 v[48:51], a[240:243], a[156:159], v[48:51]
  ds_read_b64_tr_b16 a[216:217], v198 offset:32768
  ds_read_b64_tr_b16 a[218:219], v198 offset:36864
  v_mfma_f32_16x16x32_bf16 v[20:23], a[244:247], a[140:143], v[20:23]
  ds_read_b64_tr_b16 a[220:221], v199 offset:32768
  v_mfma_f32_16x16x32_bf16 v[52:55], a[244:247], a[156:159], v[52:55]
  ds_read_b64_tr_b16 a[222:223], v199 offset:36864
  v_mfma_f32_16x16x32_bf16 v[24:27], a[248:251], a[140:143], v[24:27]
  v_mfma_f32_16x16x32_bf16 v[56:59], a[248:251], a[156:159], v[56:59]
  v_mfma_f32_16x16x32_bf16 v[28:31], a[252:255], a[140:143], v[28:31]
  v_mfma_f32_16x16x32_bf16 v[60:63], a[252:255], a[156:159], v[60:63]
  s_waitcnt vmcnt(16)
  s_waitcnt lgkmcnt(0)
  v_mfma_f32_16x16x32_bf16 v[64:67], a[192:195], a[32:35], v[64:67]
  ds_read_b64_tr_b16 a[224:225], v192 offset:40960
  ds_read_b64_tr_b16 a[226:227], v192 offset:45056
  v_mfma_f32_16x16x32_bf16 v[96:99], a[192:195], a[48:51], v[96:99]
  ds_read_b64_tr_b16 a[228:229], v193 offset:40960
  v_mfma_f32_16x16x32_bf16 v[68:71], a[196:199], a[32:35], v[68:71]
  ds_read_b64_tr_b16 a[230:231], v193 offset:45056
  v_mfma_f32_16x16x32_bf16 v[100:103], a[196:199], a[48:51], v[100:103]
  ds_read_b64_tr_b16 a[232:233], v194 offset:40960
  ds_read_b64_tr_b16 a[234:235], v194 offset:45056
  v_mfma_f32_16x16x32_bf16 v[72:75], a[200:203], a[32:35], v[72:75]
  ds_read_b64_tr_b16 a[236:237], v195 offset:40960
  v_mfma_f32_16x16x32_bf16 v[104:107], a[200:203], a[48:51], v[104:107]
  ds_read_b64_tr_b16 a[238:239], v195 offset:45056
  v_mfma_f32_16x16x32_bf16 v[76:79], a[204:207], a[32:35], v[76:79]
  ds_read_b64_tr_b16 a[240:241], v196 offset:40960
  ds_read_b64_tr_b16 a[242:243], v196 offset:45056
  v_mfma_f32_16x16x32_bf16 v[108:111], a[204:207], a[48:51], v[108:111]
  ds_read_b64_tr_b16 a[244:245], v197 offset:40960
  v_mfma_f32_16x16x32_bf16 v[80:83], a[208:211], a[32:35], v[80:83]
  ds_read_b64_tr_b16 a[246:247], v197 offset:45056
  v_mfma_f32_16x16x32_bf16 v[112:115], a[208:211], a[48:51], v[112:115]
  ds_read_b64_tr_b16 a[248:249], v198 offset:40960
  ds_read_b64_tr_b16 a[250:251], v198 offset:45056
  v_mfma_f32_16x16x32_bf16 v[84:87], a[212:215], a[32:35], v[84:87]
  ds_read_b64_tr_b16 a[252:253], v199 offset:40960
  v_mfma_f32_16x16x32_bf16 v[116:119], a[212:215], a[48:51], v[116:119]
  ds_read_b64_tr_b16 a[254:255], v199 offset:45056
  v_mfma_f32_16x16x32_bf16 v[88:91], a[216:219], a[32:35], v[88:91]
  v_mfma_f32_16x16x32_bf16 v[120:123], a[216:219], a[48:51], v[120:123]
  v_mfma_f32_16x16x32_bf16 v[92:95], a[220:223], a[32:35], v[92:95]
  v_mfma_f32_16x16x32_bf16 v[124:127], a[220:223], a[48:51], v[124:127]
  s_waitcnt lgkmcnt(0)
  v_mfma_f32_16x16x32_bf16 v[64:67], a[224:227], a[36:39], v[64:67]
  ds_read_b64_tr_b16 a[192:193], v192 offset:49152
  ds_read_b64_tr_b16 a[194:195], v192 offset:53248
  v_cvt_pk_bf16_f32 v128, v0, v1
  v_mfma_f32_16x16x32_bf16 v[96:99], a[224:227], a[52:55], v[96:99]
  ds_read_b64_tr_b16 a[196:197], v193 offset:49152
  v_cvt_pk_bf16_f32 v129, v2, v3
  v_mfma_f32_16x16x32_bf16 v[68:71], a[228:231], a[36:39], v[68:71]
  ds_read_b64_tr_b16 a[198:199], v193 offset:53248
  v_cvt_pk_bf16_f32 v130, v4, v5
  v_mfma_f32_16x16x32_bf16 v[100:103], a[228:231], a[52:55], v[100:103]
  ds_read_b64_tr_b16 a[200:201], v194 offset:49152
  ds_read_b64_tr_b16 a[202:203], v194 offset:53248
  v_cvt_pk_bf16_f32 v131, v6, v7
  v_mfma_f32_16x16x32_bf16 v[72:75], a[232:235], a[36:39], v[72:75]
  ds_read_b64_tr_b16 a[204:205], v195 offset:49152
  v_cvt_pk_bf16_f32 v132, v8, v9
  v_mfma_f32_16x16x32_bf16 v[104:107], a[232:235], a[52:55], v[104:107]
  ds_read_b64_tr_b16 a[206:207], v195 offset:53248
  v_cvt_pk_bf16_f32 v133, v10, v11
  v_mfma_f32_16x16x32_bf16 v[76:79], a[236:239], a[36:39], v[76:79]
  ds_read_b64_tr_b16 a[208:209], v196 offset:49152
  ds_read_b64_tr_b16 a[210:211], v196 offset:53248
  v_cvt_pk_bf16_f32 v134, v12, v13
  v_mfma_f32_16x16x32_bf16 v[108:111], a[236:239], a[52:55], v[108:111]
  ds_read_b64_tr_b16 a[212:213], v197 offset:49152
  v_cvt_pk_bf16_f32 v135, v14, v15
  v_mfma_f32_16x16x32_bf16 v[80:83], a[240:243], a[36:39], v[80:83]
  ds_read_b64_tr_b16 a[214:215], v197 offset:53248
  v_cvt_pk_bf16_f32 v136, v16, v17
  v_mfma_f32_16x16x32_bf16 v[112:115], a[240:243], a[52:55], v[112:115]
  ds_read_b64_tr_b16 a[216:217], v198 offset:49152
  ds_read_b64_tr_b16 a[218:219], v198 offset:53248
  v_cvt_pk_bf16_f32 v137, v18, v19
  v_mfma_f32_16x16x32_bf16 v[84:87], a[244:247], a[36:39], v[84:87]
  ds_read_b64_tr_b16 a[220:221], v199 offset:49152
  v_cvt_pk_bf16_f32 v138, v20, v21
  v_mfma_f32_16x16x32_bf16 v[116:119], a[244:247], a[52:55], v[116:119]
  ds_read_b64_tr_b16 a[222:223], v199 offset:53248
  v_cvt_pk_bf16_f32 v139, v22, v23
  v_mfma_f32_16x16x32_bf16 v[88:91], a[248:251], a[36:39], v[88:91]
  v_cvt_pk_bf16_f32 v140, v24, v25
  v_mfma_f32_16x16x32_bf16 v[120:123], a[248:251], a[52:55], v[120:123]
  v_cvt_pk_bf16_f32 v141, v26, v27
  v_mfma_f32_16x16x32_bf16 v[92:95], a[252:255], a[36:39], v[92:95]
  v_cvt_pk_bf16_f32 v142, v28, v29
  v_mfma_f32_16x16x32_bf16 v[124:127], a[252:255], a[52:55], v[124:127]
  v_cvt_pk_bf16_f32 v143, v30, v31
  s_waitcnt lgkmcnt(0)
  v_mfma_f32_16x16x32_bf16 v[64:67], a[192:195], a[40:43], v[64:67]
  ds_read_b64_tr_b16 a[224:225], v192 offset:57344
  ds_read_b64_tr_b16 a[226:227], v192 offset:61440
  v_cvt_pk_bf16_f32 v144, v32, v33
  v_mfma_f32_16x16x32_bf16 v[96:99], a[192:195], a[56:59], v[96:99]
  ds_read_b64_tr_b16 a[228:229], v193 offset:57344
  v_cvt_pk_bf16_f32 v145, v34, v35
  v_mfma_f32_16x16x32_bf16 v[68:71], a[196:199], a[40:43], v[68:71]
  ds_read_b64_tr_b16 a[230:231], v193 offset:61440
  v_cvt_pk_bf16_f32 v146, v36, v37
  v_mfma_f32_16x16x32_bf16 v[100:103], a[196:199], a[56:59], v[100:103]
  ds_read_b64_tr_b16 a[232:233], v194 offset:57344
  ds_read_b64_tr_b16 a[234:235], v194 offset:61440
  v_cvt_pk_bf16_f32 v147, v38, v39
  v_mfma_f32_16x16x32_bf16 v[72:75], a[200:203], a[40:43], v[72:75]
  ds_read_b64_tr_b16 a[236:237], v195 offset:57344
  v_cvt_pk_bf16_f32 v148, v40, v41
  v_mfma_f32_16x16x32_bf16 v[104:107], a[200:203], a[56:59], v[104:107]
  ds_read_b64_tr_b16 a[238:239], v195 offset:61440
  v_cvt_pk_bf16_f32 v149, v42, v43
  v_mfma_f32_16x16x32_bf16 v[76:79], a[204:207], a[40:43], v[76:79]
  ds_read_b64_tr_b16 a[240:241], v196 offset:57344
  ds_read_b64_tr_b16 a[242:243], v196 offset:61440
  v_cvt_pk_bf16_f32 v150, v44, v45
  v_mfma_f32_16x16x32_bf16 v[108:111], a[204:207], a[56:59], v[108:111]
  ds_read_b64_tr_b16 a[244:245], v197 offset:57344
  v_cvt_pk_bf16_f32 v151, v46, v47
  v_mfma_f32_16x16x32_bf16 v[80:83], a[208:211], a[40:43], v[80:83]
  ds_read_b64_tr_b16 a[246:247], v197 offset:61440
  v_cvt_pk_bf16_f32 v152, v48, v49
  v_mfma_f32_16x16x32_bf16 v[112:115], a[208:211], a[56:59], v[112:115]
  ds_read_b64_tr_b16 a[248:249], v198 offset:57344
  ds_read_b64_tr_b16 a[250:251], v198 offset:61440
  v_cvt_pk_bf16_f32 v153, v50, v51
  v_mfma_f32_16x16x32_bf16 v[84:87], a[212:215], a[40:43], v[84:87]
  ds_read_b64_tr_b16 a[252:253], v199 offset:57344
  v_cvt_pk_bf16_f32 v154, v52, v53
  v_mfma_f32_16x16x32_bf16 v[116:119], a[212:215], a[56:59], v[116:119]
  ds_read_b64_tr_b16 a[254:255], v199 offset:61440
  v_cvt_pk_bf16_f32 v155, v54, v55
  v_mfma_f32_16x16x32_bf16 v[88:91], a[216:219], a[40:43], v[88:91]
  v_cvt_pk_bf16_f32 v156, v56, v57
  v_mfma_f32_16x16x32_bf16 v[120:123], a[216:219], a[56:59], v[120:123]
  v_cvt_pk_bf16_f32 v157, v58, v59
  v_mfma_f32_16x16x32_bf16 v[92:95], a[220:223], a[40:43], v[92:95]
  v_cvt_pk_bf16_f32 v158, v60, v61
  v_mfma_f32_16x16x32_bf16 v[124:127], a[220:223], a[56:59], v[124:127]
  v_cvt_pk_bf16_f32 v159, v62, v63
  s_waitcnt lgkmcnt(0)
  v_mfma_f32_16x16x32_bf16 v[64:67], a[224:227], a[44:47], v[64:67]
  ds_read_b64_tr_b16 a[192:193], v205 offset:0
  ds_read_b64_tr_b16 a[194:195], v205 offset:4096
  s_add_u32 s39, s77, 0
  v_mfma_f32_16x16x32_bf16 v[96:99], a[224:227], a[60:63], v[96:99]
  ds_read_b64_tr_b16 a[196:197], v206 offset:0
  buffer_store_dwordx4 v[128:131], v204, s[60:63], s39 offen offset:0 sc1
  v_mfma_f32_16x16x32_bf16 v[68:71], a[228:231], a[44:47], v[68:71]
  ds_read_b64_tr_b16 a[198:199], v206 offset:4096
  v_mfma_f32_16x16x32_bf16 v[100:103], a[228:231], a[60:63], v[100:103]
  ds_read_b64_tr_b16 a[200:201], v207 offset:0
  ds_read_b64_tr_b16 a[202:203], v207 offset:4096
  buffer_store_dwordx4 v[132:135], v204, s[60:63], s39 offen offset:1024 sc1
  v_mfma_f32_16x16x32_bf16 v[72:75], a[232:235], a[44:47], v[72:75]
  ds_read_b64_tr_b16 a[204:205], v208 offset:0
  buffer_store_dwordx4 v[136:139], v204, s[60:63], s39 offen offset:2048 sc1
  v_mfma_f32_16x16x32_bf16 v[104:107], a[232:235], a[60:63], v[104:107]
  ds_read_b64_tr_b16 a[206:207], v208 offset:4096
  v_mfma_f32_16x16x32_bf16 v[76:79], a[236:239], a[44:47], v[76:79]
  ds_read_b64_tr_b16 a[208:209], v209 offset:0
  ds_read_b64_tr_b16 a[210:211], v209 offset:4096
  buffer_store_dwordx4 v[140:143], v204, s[60:63], s39 offen offset:3072 sc1
  v_mfma_f32_16x16x32_bf16 v[108:111], a[236:239], a[60:63], v[108:111]
  ds_read_b64_tr_b16 a[212:213], v210 offset:0
  v_mfma_f32_16x16x32_bf16 v[80:83], a[240:243], a[44:47], v[80:83]
  ds_read_b64_tr_b16 a[214:215], v210 offset:4096
  s_add_u32 s39, s77, 4096
  v_mfma_f32_16x16x32_bf16 v[112:115], a[240:243], a[60:63], v[112:115]
  ds_read_b64_tr_b16 a[216:217], v211 offset:0
  ds_read_b64_tr_b16 a[218:219], v211 offset:4096
  buffer_store_dwordx4 v[144:147], v204, s[60:63], s39 offen offset:0 sc1
  v_mfma_f32_16x16x32_bf16 v[84:87], a[244:247], a[44:47], v[84:87]
  ds_read_b64_tr_b16 a[220:221], v212 offset:0
  v_mfma_f32_16x16x32_bf16 v[116:119], a[244:247], a[60:63], v[116:119]
  ds_read_b64_tr_b16 a[222:223], v212 offset:4096
  buffer_store_dwordx4 v[148:151], v204, s[60:63], s39 offen offset:1024 sc1
  v_mfma_f32_16x16x32_bf16 v[88:91], a[248:251], a[44:47], v[88:91]
  buffer_store_dwordx4 v[152:155], v204, s[60:63], s39 offen offset:2048 sc1
  v_mfma_f32_16x16x32_bf16 v[120:123], a[248:251], a[60:63], v[120:123]
  v_mfma_f32_16x16x32_bf16 v[92:95], a[252:255], a[44:47], v[92:95]
  buffer_store_dwordx4 v[156:159], v204, s[60:63], s39 offen offset:3072 sc1
  v_mfma_f32_16x16x32_bf16 v[124:127], a[252:255], a[60:63], v[124:127]
  s_waitcnt vmcnt(16)
  s_waitcnt lgkmcnt(0)
  v_mfma_f32_16x16x32_bf16 v[64:67], a[192:195], a[96:99], v[64:67]
  ds_read_b64_tr_b16 a[224:225], v205 offset:8192
  ds_read_b64_tr_b16 a[226:227], v205 offset:12288
  v_mfma_f32_16x16x32_bf16 v[96:99], a[192:195], a[112:115], v[96:99]
  ds_read_b64_tr_b16 a[228:229], v206 offset:8192
  v_mfma_f32_16x16x32_bf16 v[68:71], a[196:199], a[96:99], v[68:71]
  ds_read_b64_tr_b16 a[230:231], v206 offset:12288
  v_mfma_f32_16x16x32_bf16 v[100:103], a[196:199], a[112:115], v[100:103]
  ds_read_b64_tr_b16 a[232:233], v207 offset:8192
  ds_read_b64_tr_b16 a[234:235], v207 offset:12288
  v_mfma_f32_16x16x32_bf16 v[72:75], a[200:203], a[96:99], v[72:75]
  ds_read_b64_tr_b16 a[236:237], v208 offset:8192
  v_mfma_f32_16x16x32_bf16 v[104:107], a[200:203], a[112:115], v[104:107]
  ds_read_b64_tr_b16 a[238:239], v208 offset:12288
  v_mfma_f32_16x16x32_bf16 v[76:79], a[204:207], a[96:99], v[76:79]
  ds_read_b64_tr_b16 a[240:241], v209 offset:8192
  ds_read_b64_tr_b16 a[242:243], v209 offset:12288
  v_mfma_f32_16x16x32_bf16 v[108:111], a[204:207], a[112:115], v[108:111]
  ds_read_b64_tr_b16 a[244:245], v210 offset:8192
  v_mfma_f32_16x16x32_bf16 v[80:83], a[208:211], a[96:99], v[80:83]
  ds_read_b64_tr_b16 a[246:247], v210 offset:12288
  v_mfma_f32_16x16x32_bf16 v[112:115], a[208:211], a[112:115], v[112:115]
  ds_read_b64_tr_b16 a[248:249], v211 offset:8192
  ds_read_b64_tr_b16 a[250:251], v211 offset:12288
  v_mfma_f32_16x16x32_bf16 v[84:87], a[212:215], a[96:99], v[84:87]
  ds_read_b64_tr_b16 a[252:253], v212 offset:8192
  v_mfma_f32_16x16x32_bf16 v[116:119], a[212:215], a[112:115], v[116:119]
  ds_read_b64_tr_b16 a[254:255], v212 offset:12288
  v_mfma_f32_16x16x32_bf16 v[88:91], a[216:219], a[96:99], v[88:91]
  v_mfma_f32_16x16x32_bf16 v[120:123], a[216:219], a[112:115], v[120:123]
  v_mfma_f32_16x16x32_bf16 v[92:95], a[220:223], a[96:99], v[92:95]
  v_mfma_f32_16x16x32_bf16 v[124:127], a[220:223], a[112:115], v[124:127]
  s_waitcnt lgkmcnt(0)
  v_mfma_f32_16x16x32_bf16 v[64:67], a[224:227], a[100:103], v[64:67]
  ds_read_b64_tr_b16 a[192:193], v205 offset:16384
  ds_read_b64_tr_b16 a[194:195], v205 offset:20480
  v_mfma_f32_16x16x32_bf16 v[96:99], a[224:227], a[116:119], v[96:99]
  ds_read_b64_tr_b16 a[196:197], v206 offset:16384
  v_mfma_f32_16x16x32_bf16 v[68:71], a[228:231], a[100:103], v[68:71]
  ds_read_b64_tr_b16 a[198:199], v206 offset:20480
  v_mfma_f32_16x16x32_bf16 v[100:103], a[228:231], a[116:119], v[100:103]
  ds_read_b64_tr_b16 a[200:201], v207 offset:16384
  ds_read_b64_tr_b16 a[202:203], v207 offset:20480
  v_mfma_f32_16x16x32_bf16 v[72:75], a[232:235], a[100:103], v[72:75]
  ds_read_b64_tr_b16 a[204:205], v208 offset:16384
  v_mfma_f32_16x16x32_bf16 v[104:107], a[232:235], a[116:119], v[104:107]
  ds_read_b64_tr_b16 a[206:207], v208 offset:20480
  v_mfma_f32_16x16x32_bf16 v[76:79], a[236:239], a[100:103], v[76:79]
  ds_read_b64_tr_b16 a[208:209], v209 offset:16384
  ds_read_b64_tr_b16 a[210:211], v209 offset:20480
  v_mfma_f32_16x16x32_bf16 v[108:111], a[236:239], a[116:119], v[108:111]
  ds_read_b64_tr_b16 a[212:213], v210 offset:16384
  v_mfma_f32_16x16x32_bf16 v[80:83], a[240:243], a[100:103], v[80:83]
  ds_read_b64_tr_b16 a[214:215], v210 offset:20480
  v_mfma_f32_16x16x32_bf16 v[112:115], a[240:243], a[116:119], v[112:115]
  ds_read_b64_tr_b16 a[216:217], v211 offset:16384
  ds_read_b64_tr_b16 a[218:219], v211 offset:20480
  v_mfma_f32_16x16x32_bf16 v[84:87], a[244:247], a[100:103], v[84:87]
  ds_read_b64_tr_b16 a[220:221], v212 offset:16384
  v_mfma_f32_16x16x32_bf16 v[116:119], a[244:247], a[116:119], v[116:119]
  ds_read_b64_tr_b16 a[222:223], v212 offset:20480
  v_mfma_f32_16x16x32_bf16 v[88:91], a[248:251], a[100:103], v[88:91]
  v_mfma_f32_16x16x32_bf16 v[120:123], a[248:251], a[116:119], v[120:123]
  v_mfma_f32_16x16x32_bf16 v[92:95], a[252:255], a[100:103], v[92:95]
  v_mfma_f32_16x16x32_bf16 v[124:127], a[252:255], a[116:119], v[124:127]
  s_waitcnt lgkmcnt(0)
  v_mfma_f32_16x16x32_bf16 v[64:67], a[192:195], a[104:107], v[64:67]
  ds_read_b64_tr_b16 a[224:225], v205 offset:24576
  ds_read_b64_tr_b16 a[226:227], v205 offset:28672
  v_mfma_f32_16x16x32_bf16 v[96:99], a[192:195], a[120:123], v[96:99]
  ds_read_b64_tr_b16 a[228:229], v206 offset:24576
  v_mfma_f32_16x16x32_bf16 v[68:71], a[196:199], a[104:107], v[68:71]
  ds_read_b64_tr_b16 a[230:231], v206 offset:28672
  v_mfma_f32_16x16x32_bf16 v[100:103], a[196:199], a[120:123], v[100:103]
  ds_read_b64_tr_b16 a[232:233], v207 offset:24576
  ds_read_b64_tr_b16 a[234:235], v207 offset:28672
  v_mfma_f32_16x16x32_bf16 v[72:75], a[200:203], a[104:107], v[72:75]
  ds_read_b64_tr_b16 a[236:237], v208 offset:24576
  v_mfma_f32_16x16x32_bf16 v[104:107], a[200:203], a[120:123], v[104:107]
  ds_read_b64_tr_b16 a[238:239], v208 offset:28672
  v_mfma_f32_16x16x32_bf16 v[76:79], a[204:207], a[104:107], v[76:79]
  ds_read_b64_tr_b16 a[240:241], v209 offset:24576
  ds_read_b64_tr_b16 a[242:243], v209 offset:28672
  v_mfma_f32_16x16x32_bf16 v[108:111], a[204:207], a[120:123], v[108:111]
  ds_read_b64_tr_b16 a[244:245], v210 offset:24576
  v_mfma_f32_16x16x32_bf16 v[80:83], a[208:211], a[104:107], v[80:83]
  ds_read_b64_tr_b16 a[246:247], v210 offset:28672
  v_mfma_f32_16x16x32_bf16 v[112:115], a[208:211], a[120:123], v[112:115]
  ds_read_b64_tr_b16 a[248:249], v211 offset:24576
  ds_read_b64_tr_b16 a[250:251], v211 offset:28672
  v_mfma_f32_16x16x32_bf16 v[84:87], a[212:215], a[104:107], v[84:87]
  ds_read_b64_tr_b16 a[252:253], v212 offset:24576
  v_mfma_f32_16x16x32_bf16 v[116:119], a[212:215], a[120:123], v[116:119]
  ds_read_b64_tr_b16 a[254:255], v212 offset:28672
  v_mfma_f32_16x16x32_bf16 v[88:91], a[216:219], a[104:107], v[88:91]
  v_mfma_f32_16x16x32_bf16 v[120:123], a[216:219], a[120:123], v[120:123]
  v_mfma_f32_16x16x32_bf16 v[92:95], a[220:223], a[104:107], v[92:95]
  v_mfma_f32_16x16x32_bf16 v[124:127], a[220:223], a[120:123], v[124:127]
  s_waitcnt lgkmcnt(0)
  v_mfma_f32_16x16x32_bf16 v[64:67], a[224:227], a[108:111], v[64:67]
  ds_read_b64_tr_b16 a[192:193], v244 offset:40960
  ds_read_b64_tr_b16 a[194:195], v244 offset:45056
  v_mfma_f32_16x16x32_bf16 v[96:99], a[224:227], a[124:127], v[96:99]
  ds_read_b64_tr_b16 a[196:197], v245 offset:40960
  v_mfma_f32_16x16x32_bf16 v[68:71], a[228:231], a[108:111], v[68:71]
  ds_read_b64_tr_b16 a[198:199], v245 offset:45056
  v_mfma_f32_16x16x32_bf16 v[100:103], a[228:231], a[124:127], v[100:103]
  ds_read_b64_tr_b16 a[200:201], v246 offset:40960
  ds_read_b64_tr_b16 a[202:203], v246 offset:45056
  v_mfma_f32_16x16x32_bf16 v[72:75], a[232:235], a[108:111], v[72:75]
  ds_read_b64_tr_b16 a[204:205], v247 offset:40960
  v_mfma_f32_16x16x32_bf16 v[104:107], a[232:235], a[124:127], v[104:107]
  ds_read_b64_tr_b16 a[206:207], v247 offset:45056
  v_mfma_f32_16x16x32_bf16 v[76:79], a[236:239], a[108:111], v[76:79]
  ds_read_b64_tr_b16 a[208:209], v248 offset:40960
  ds_read_b64_tr_b16 a[210:211], v248 offset:45056
  v_mfma_f32_16x16x32_bf16 v[108:111], a[236:239], a[124:127], v[108:111]
  ds_read_b64_tr_b16 a[212:213], v249 offset:40960
  v_mfma_f32_16x16x32_bf16 v[80:83], a[240:243], a[108:111], v[80:83]
  ds_read_b64_tr_b16 a[214:215], v249 offset:45056
  v_mfma_f32_16x16x32_bf16 v[112:115], a[240:243], a[124:127], v[112:115]
  ds_read_b64_tr_b16 a[216:217], v250 offset:40960
  ds_read_b64_tr_b16 a[218:219], v250 offset:45056
  v_mfma_f32_16x16x32_bf16 v[84:87], a[244:247], a[108:111], v[84:87]
  ds_read_b64_tr_b16 a[220:221], v251 offset:40960
  v_mfma_f32_16x16x32_bf16 v[116:119], a[244:247], a[124:127], v[116:119]
  ds_read_b64_tr_b16 a[222:223], v251 offset:45056
  v_mfma_f32_16x16x32_bf16 v[88:91], a[248:251], a[108:111], v[88:91]
  v_mfma_f32_16x16x32_bf16 v[120:123], a[248:251], a[124:127], v[120:123]
  v_mfma_f32_16x16x32_bf16 v[92:95], a[252:255], a[108:111], v[92:95]
  v_mfma_f32_16x16x32_bf16 v[124:127], a[252:255], a[124:127], v[124:127]
  s_waitcnt vmcnt(8)
  s_waitcnt lgkmcnt(0)
  v_mfma_f32_16x16x32_bf16 v[64:67], a[192:195], a[160:163], v[64:67]
  ds_read_b64_tr_b16 a[224:225], v244 offset:57344
  ds_read_b64_tr_b16 a[226:227], v244 offset:61440
  v_mfma_f32_16x16x32_bf16 v[96:99], a[192:195], a[176:179], v[96:99]
  ds_read_b64_tr_b16 a[228:229], v245 offset:57344
  v_mfma_f32_16x16x32_bf16 v[68:71], a[196:199], a[160:163], v[68:71]
  ds_read_b64_tr_b16 a[230:231], v245 offset:61440
  v_mfma_f32_16x16x32_bf16 v[100:103], a[196:199], a[176:179], v[100:103]
  ds_read_b64_tr_b16 a[232:233], v246 offset:57344
  ds_read_b64_tr_b16 a[234:235], v246 offset:61440
  v_mfma_f32_16x16x32_bf16 v[72:75], a[200:203], a[160:163], v[72:75]
  ds_read_b64_tr_b16 a[236:237], v247 offset:57344
  v_mfma_f32_16x16x32_bf16 v[104:107], a[200:203], a[176:179], v[104:107]
  ds_read_b64_tr_b16 a[238:239], v247 offset:61440
  v_mfma_f32_16x16x32_bf16 v[76:79], a[204:207], a[160:163], v[76:79]
  ds_read_b64_tr_b16 a[240:241], v248 offset:57344
  ds_read_b64_tr_b16 a[242:243], v248 offset:61440
  v_mfma_f32_16x16x32_bf16 v[108:111], a[204:207], a[176:179], v[108:111]
  ds_read_b64_tr_b16 a[244:245], v249 offset:57344
  v_mfma_f32_16x16x32_bf16 v[80:83], a[208:211], a[160:163], v[80:83]
  ds_read_b64_tr_b16 a[246:247], v249 offset:61440
  v_mfma_f32_16x16x32_bf16 v[112:115], a[208:211], a[176:179], v[112:115]
  ds_read_b64_tr_b16 a[248:249], v250 offset:57344
  ds_read_b64_tr_b16 a[250:251], v250 offset:61440
  v_mfma_f32_16x16x32_bf16 v[84:87], a[212:215], a[160:163], v[84:87]
  ds_read_b64_tr_b16 a[252:253], v251 offset:57344
  v_mfma_f32_16x16x32_bf16 v[116:119], a[212:215], a[176:179], v[116:119]
  ds_read_b64_tr_b16 a[254:255], v251 offset:61440
  v_mfma_f32_16x16x32_bf16 v[88:91], a[216:219], a[160:163], v[88:91]
  v_mfma_f32_16x16x32_bf16 v[120:123], a[216:219], a[176:179], v[120:123]
  v_mfma_f32_16x16x32_bf16 v[92:95], a[220:223], a[160:163], v[92:95]
  v_mfma_f32_16x16x32_bf16 v[124:127], a[220:223], a[176:179], v[124:127]
  s_waitcnt lgkmcnt(0)
  v_mfma_f32_16x16x32_bf16 v[64:67], a[224:227], a[164:167], v[64:67]
  ds_read_b64_tr_b16 a[192:193], v244 offset:24576
  ds_read_b64_tr_b16 a[194:195], v244 offset:28672
  v_mfma_f32_16x16x32_bf16 v[96:99], a[224:227], a[180:183], v[96:99]
  ds_read_b64_tr_b16 a[196:197], v245 offset:24576
  v_mfma_f32_16x16x32_bf16 v[68:71], a[228:231], a[164:167], v[68:71]
  ds_read_b64_tr_b16 a[198:199], v245 offset:28672
  v_mfma_f32_16x16x32_bf16 v[100:103], a[228:231], a[180:183], v[100:103]
  ds_read_b64_tr_b16 a[200:201], v246 offset:24576
  ds_read_b64_tr_b16 a[202:203], v246 offset:28672
  v_mfma_f32_16x16x32_bf16 v[72:75], a[232:235], a[164:167], v[72:75]
  ds_read_b64_tr_b16 a[204:205], v247 offset:24576
  v_mfma_f32_16x16x32_bf16 v[104:107], a[232:235], a[180:183], v[104:107]
  ds_read_b64_tr_b16 a[206:207], v247 offset:28672
  v_mfma_f32_16x16x32_bf16 v[76:79], a[236:239], a[164:167], v[76:79]
  ds_read_b64_tr_b16 a[208:209], v248 offset:24576
  ds_read_b64_tr_b16 a[210:211], v248 offset:28672
  v_mfma_f32_16x16x32_bf16 v[108:111], a[236:239], a[180:183], v[108:111]
  ds_read_b64_tr_b16 a[212:213], v249 offset:24576
  v_mfma_f32_16x16x32_bf16 v[80:83], a[240:243], a[164:167], v[80:83]
  ds_read_b64_tr_b16 a[214:215], v249 offset:28672
  v_mfma_f32_16x16x32_bf16 v[112:115], a[240:243], a[180:183], v[112:115]
  ds_read_b64_tr_b16 a[216:217], v250 offset:24576
  ds_read_b64_tr_b16 a[218:219], v250 offset:28672
  v_mfma_f32_16x16x32_bf16 v[84:87], a[244:247], a[164:167], v[84:87]
  ds_read_b64_tr_b16 a[220:221], v251 offset:24576
  v_mfma_f32_16x16x32_bf16 v[116:119], a[244:247], a[180:183], v[116:119]
  ds_read_b64_tr_b16 a[222:223], v251 offset:28672
  v_mfma_f32_16x16x32_bf16 v[88:91], a[248:251], a[164:167], v[88:91]
  v_mfma_f32_16x16x32_bf16 v[120:123], a[248:251], a[180:183], v[120:123]
  v_mfma_f32_16x16x32_bf16 v[92:95], a[252:255], a[164:167], v[92:95]
  v_mfma_f32_16x16x32_bf16 v[124:127], a[252:255], a[180:183], v[124:127]
  s_waitcnt vmcnt(0)
  s_barrier
  s_waitcnt lgkmcnt(0)
  v_mfma_f32_16x16x32_bf16 v[64:67], a[192:195], a[168:171], v[64:67]
  ds_read_b64_tr_b16 a[224:225], v244 offset:32768
  ds_read_b64_tr_b16 a[226:227], v244 offset:36864
  v_mfma_f32_16x16x32_bf16 v[96:99], a[192:195], a[184:187], v[96:99]
  ds_read_b64_tr_b16 a[228:229], v245 offset:32768
  v_mfma_f32_16x16x32_bf16 v[68:71], a[196:199], a[168:171], v[68:71]
  ds_read_b64_tr_b16 a[230:231], v245 offset:36864
  v_mfma_f32_16x16x32_bf16 v[100:103], a[196:199], a[184:187], v[100:103]
  ds_read_b64_tr_b16 a[232:233], v246 offset:32768
  ds_read_b64_tr_b16 a[234:235], v246 offset:36864
  v_mfma_f32_16x16x32_bf16 v[72:75], a[200:203], a[168:171], v[72:75]
  ds_read_b64_tr_b16 a[236:237], v247 offset:32768
  v_mfma_f32_16x16x32_bf16 v[104:107], a[200:203], a[184:187], v[104:107]
  ds_read_b64_tr_b16 a[238:239], v247 offset:36864
  v_mfma_f32_16x16x32_bf16 v[76:79], a[204:207], a[168:171], v[76:79]
  ds_read_b64_tr_b16 a[240:241], v248 offset:32768
  ds_read_b64_tr_b16 a[242:243], v248 offset:36864
  v_mfma_f32_16x16x32_bf16 v[108:111], a[204:207], a[184:187], v[108:111]
  ds_read_b64_tr_b16 a[244:245], v249 offset:32768
  v_mfma_f32_16x16x32_bf16 v[80:83], a[208:211], a[168:171], v[80:83]
  ds_read_b64_tr_b16 a[246:247], v249 offset:36864
  v_mfma_f32_16x16x32_bf16 v[112:115], a[208:211], a[184:187], v[112:115]
  ds_read_b64_tr_b16 a[248:249], v250 offset:32768
  ds_read_b64_tr_b16 a[250:251], v250 offset:36864
  v_mfma_f32_16x16x32_bf16 v[84:87], a[212:215], a[168:171], v[84:87]
  ds_read_b64_tr_b16 a[252:253], v251 offset:32768
  v_mfma_f32_16x16x32_bf16 v[116:119], a[212:215], a[184:187], v[116:119]
  ds_read_b64_tr_b16 a[254:255], v251 offset:36864
  v_mfma_f32_16x16x32_bf16 v[88:91], a[216:219], a[168:171], v[88:91]
  v_mfma_f32_16x16x32_bf16 v[120:123], a[216:219], a[184:187], v[120:123]
  v_mfma_f32_16x16x32_bf16 v[92:95], a[220:223], a[168:171], v[92:95]
  v_mfma_f32_16x16x32_bf16 v[124:127], a[220:223], a[184:187], v[124:127]
  s_waitcnt lgkmcnt(0)
  v_mfma_f32_16x16x32_bf16 v[64:67], a[224:227], a[172:175], v[64:67]
  v_mfma_f32_16x16x32_bf16 v[96:99], a[224:227], a[188:191], v[96:99]
  v_mfma_f32_16x16x32_bf16 v[68:71], a[228:231], a[172:175], v[68:71]
  v_mfma_f32_16x16x32_bf16 v[100:103], a[228:231], a[188:191], v[100:103]
  v_mfma_f32_16x16x32_bf16 v[72:75], a[232:235], a[172:175], v[72:75]
  v_mfma_f32_16x16x32_bf16 v[104:107], a[232:235], a[188:191], v[104:107]
  v_mfma_f32_16x16x32_bf16 v[76:79], a[236:239], a[172:175], v[76:79]
  v_mfma_f32_16x16x32_bf16 v[108:111], a[236:239], a[188:191], v[108:111]
  v_mfma_f32_16x16x32_bf16 v[80:83], a[240:243], a[172:175], v[80:83]
  v_mfma_f32_16x16x32_bf16 v[112:115], a[240:243], a[188:191], v[112:115]
  v_mfma_f32_16x16x32_bf16 v[84:87], a[244:247], a[172:175], v[84:87]
  v_mfma_f32_16x16x32_bf16 v[116:119], a[244:247], a[188:191], v[116:119]
  v_mfma_f32_16x16x32_bf16 v[88:91], a[248:251], a[172:175], v[88:91]
  v_mfma_f32_16x16x32_bf16 v[120:123], a[248:251], a[188:191], v[120:123]
  v_mfma_f32_16x16x32_bf16 v[92:95], a[252:255], a[172:175], v[92:95]
  v_mfma_f32_16x16x32_bf16 v[124:127], a[252:255], a[188:191], v[124:127]
  s_nop 7
  s_nop 7
  v_cvt_pk_bf16_f32 v160, v64, v65
  v_cvt_pk_bf16_f32 v161, v66, v67
  v_cvt_pk_bf16_f32 v162, v68, v69
  v_cvt_pk_bf16_f32 v163, v70, v71
  v_cvt_pk_bf16_f32 v164, v72, v73
  v_cvt_pk_bf16_f32 v165, v74, v75
  v_cvt_pk_bf16_f32 v166, v76, v77
  v_cvt_pk_bf16_f32 v167, v78, v79
  v_cvt_pk_bf16_f32 v168, v80, v81
  v_cvt_pk_bf16_f32 v169, v82, v83
  v_cvt_pk_bf16_f32 v170, v84, v85
  v_cvt_pk_bf16_f32 v171, v86, v87
  v_cvt_pk_bf16_f32 v172, v88, v89
  v_cvt_pk_bf16_f32 v173, v90, v91
  v_cvt_pk_bf16_f32 v174, v92, v93
  v_cvt_pk_bf16_f32 v175, v94, v95
  v_cvt_pk_bf16_f32 v176, v96, v97
  v_cvt_pk_bf16_f32 v177, v98, v99
  v_cvt_pk_bf16_f32 v178, v100, v101
  v_cvt_pk_bf16_f32 v179, v102, v103
  v_cvt_pk_bf16_f32 v180, v104, v105
  v_cvt_pk_bf16_f32 v181, v106, v107
  v_cvt_pk_bf16_f32 v182, v108, v109
  v_cvt_pk_bf16_f32 v183, v110, v111
  v_cvt_pk_bf16_f32 v184, v112, v113
  v_cvt_pk_bf16_f32 v185, v114, v115
  v_cvt_pk_bf16_f32 v186, v116, v117
  v_cvt_pk_bf16_f32 v187, v118, v119
  v_cvt_pk_bf16_f32 v188, v120, v121
  v_cvt_pk_bf16_f32 v189, v122, v123
  v_cvt_pk_bf16_f32 v190, v124, v125
  v_cvt_pk_bf16_f32 v191, v126, v127
  s_add_u32 s39, s77, 8192
  buffer_store_dwordx4 v[160:163], v204, s[60:63], s39 offen offset:0 sc1
  buffer_store_dwordx4 v[164:167], v204, s[60:63], s39 offen offset:1024 sc1
  buffer_store_dwordx4 v[168:171], v204, s[60:63], s39 offen offset:2048 sc1
  buffer_store_dwordx4 v[172:175], v204, s[60:63], s39 offen offset:3072 sc1
  s_add_u32 s39, s77, 12288
  buffer_store_dwordx4 v[176:179], v204, s[60:63], s39 offen offset:0 sc1
  buffer_store_dwordx4 v[180:183], v204, s[60:63], s39 offen offset:1024 sc1
  buffer_store_dwordx4 v[184:187], v204, s[60:63], s39 offen offset:2048 sc1
  buffer_store_dwordx4 v[188:191], v204, s[60:63], s39 offen offset:3072 sc1
  s_waitcnt vmcnt(0)
  s_barrier
  s_add_u32 s39, s81, 0
  buffer_load_dwordx4 v[0:3], v226, s[60:63], s39 offen sc1
  s_add_u32 s39, s81, 65536
  buffer_load_dwordx4 v[4:7], v226, s[60:63], s39 offen sc1
  s_add_u32 s39, s81, 131072
  buffer_load_dwordx4 v[8:11], v226, s[60:63], s39 offen sc1
  s_add_u32 s39, s81, 196608
  buffer_load_dwordx4 v[12:15], v226, s[60:63], s39 offen sc1
  s_add_u32 s39, s81, 262144
  buffer_load_dwordx4 v[16:19], v226, s[60:63], s39 offen sc1
  s_add_u32 s39, s81, 327680
  buffer_load_dwordx4 v[20:23], v226, s[60:63], s39 offen sc1
  s_add_u32 s39, s81, 393216
  buffer_load_dwordx4 v[24:27], v226, s[60:63], s39 offen sc1
  s_add_u32 s39, s81, 458752
  buffer_load_dwordx4 v[28:31], v226, s[60:63], s39 offen sc1
  s_waitcnt vmcnt(4)
  v_dot2_f32_bf16 v176, v0, s83, 0
  v_dot2_f32_bf16 v180, v0, s84, 0
  v_dot2_f32_bf16 v177, v1, s83, 0
  v_dot2_f32_bf16 v181, v1, s84, 0
  v_dot2_f32_bf16 v178, v2, s83, 0
  v_dot2_f32_bf16 v182, v2, s84, 0
  v_dot2_f32_bf16 v179, v3, s83, 0
  v_dot2_f32_bf16 v183, v3, s84, 0
  v_dot2_f32_bf16 v176, v4, s83, v176
  v_dot2_f32_bf16 v180, v4, s84, v180
  v_dot2_f32_bf16 v177, v5, s83, v177
  v_dot2_f32_bf16 v181, v5, s84, v181
  v_dot2_f32_bf16 v178, v6, s83, v178
  v_dot2_f32_bf16 v182, v6, s84, v182
  v_dot2_f32_bf16 v179, v7, s83, v179
  v_dot2_f32_bf16 v183, v7, s84, v183
  v_dot2_f32_bf16 v176, v8, s83, v176
  v_dot2_f32_bf16 v180, v8, s84, v180
  v_dot2_f32_bf16 v177, v9, s83, v177
  v_dot2_f32_bf16 v181, v9, s84, v181
  v_dot2_f32_bf16 v178, v10, s83, v178
  v_dot2_f32_bf16 v182, v10, s84, v182
  v_dot2_f32_bf16 v179, v11, s83, v179
  v_dot2_f32_bf16 v183, v11, s84, v183
  v_dot2_f32_bf16 v176, v12, s83, v176
  v_dot2_f32_bf16 v180, v12, s84, v180
  v_dot2_f32_bf16 v177, v13, s83, v177
  v_dot2_f32_bf16 v181, v13, s84, v181
  v_dot2_f32_bf16 v178, v14, s83, v178
  v_dot2_f32_bf16 v182, v14, s84, v182
  v_dot2_f32_bf16 v179, v15, s83, v179
  v_dot2_f32_bf16 v183, v15, s84, v183
  s_waitcnt vmcnt(0)
  v_dot2_f32_bf16 v176, v16, s83, v176
  v_dot2_f32_bf16 v180, v16, s84, v180
  v_dot2_f32_bf16 v177, v17, s83, v177
  v_dot2_f32_bf16 v181, v17, s84, v181
  v_dot2_f32_bf16 v178, v18, s83, v178
  v_dot2_f32_bf16 v182, v18, s84, v182
  v_dot2_f32_bf16 v179, v19, s83, v179
  v_dot2_f32_bf16 v183, v19, s84, v183
  v_dot2_f32_bf16 v176, v20, s83, v176
  v_dot2_f32_bf16 v180, v20, s84, v180
  v_dot2_f32_bf16 v177, v21, s83, v177
  v_dot2_f32_bf16 v181, v21, s84, v181
  v_dot2_f32_bf16 v178, v22, s83, v178
  v_dot2_f32_bf16 v182, v22, s84, v182
  v_dot2_f32_bf16 v179, v23, s83, v179
  v_dot2_f32_bf16 v183, v23, s84, v183
  v_dot2_f32_bf16 v176, v24, s83, v176
  v_dot2_f32_bf16 v180, v24, s84, v180
  v_dot2_f32_bf16 v177, v25, s83, v177
  v_dot2_f32_bf16 v181, v25, s84, v181
  v_dot2_f32_bf16 v178, v26, s83, v178
  v_dot2_f32_bf16 v182, v26, s84, v182
  v_dot2_f32_bf16 v179, v27, s83, v179
  v_dot2_f32_bf16 v183, v27, s84, v183
  v_dot2_f32_bf16 v176, v28, s83, v176
  v_dot2_f32_bf16 v180, v28, s84, v180
  v_dot2_f32_bf16 v177, v29, s83, v177
  v_dot2_f32_bf16 v181, v29, s84, v181
  v_dot2_f32_bf16 v178, v30, s83, v178
  v_dot2_f32_bf16 v182, v30, s84, v182
  v_dot2_f32_bf16 v179, v31, s83, v179
  v_dot2_f32_bf16 v183, v31, s84, v183
  s_nop 1
  v_cvt_pk_bf16_f32 v228, v176, v180
  v_cvt_pk_bf16_f32 v229, v177, v181
  v_cvt_pk_bf16_f32 v230, v178, v182
  v_cvt_pk_bf16_f32 v231, v179, v183
  s_nop 1
  v_permlane16_swap_b32 v228, v230
  v_permlane16_swap_b32 v229, v231
  s_add_u32 s39, s82, 0
  buffer_store_dwordx4 v[228:231], v225, s[64:67], s39 offen
  s_barrier
  s_cmp_ge_u32 s34, 6
  s_cbranch_scc1 L_fin_CW
  s_add_u32 s39, s81, 8192
  buffer_load_dwordx4 v[32:35], v226, s[60:63], s39 offen sc1
  s_add_u32 s39, s81, 73728
  buffer_load_dwordx4 v[36:39], v226, s[60:63], s39 offen sc1
  s_add_u32 s39, s81, 139264
  buffer_load_dwordx4 v[40:43], v226, s[60:63], s39 offen sc1
  s_add_u32 s39, s81, 204800
  buffer_load_dwordx4 v[44:47], v226, s[60:63], s39 offen sc1
  s_add_u32 s39, s81, 270336
  buffer_load_dwordx4 v[48:51], v226, s[60:63], s39 offen sc1
  s_add_u32 s39, s81, 335872
  buffer_load_dwordx4 v[52:55], v226, s[60:63], s39 offen sc1
  s_add_u32 s39, s81, 401408
  buffer_load_dwordx4 v[56:59], v226, s[60:63], s39 offen sc1
  s_add_u32 s39, s81, 466944
  buffer_load_dwordx4 v[60:63], v226, s[60:63], s39 offen sc1
  s_waitcnt vmcnt(4)
  v_dot2_f32_bf16 v184, v32, s83, 0
  v_dot2_f32_bf16 v188, v32, s84, 0
  v_dot2_f32_bf16 v185, v33, s83, 0
  v_dot2_f32_bf16 v189, v33, s84, 0
  v_dot2_f32_bf16 v186, v34, s83, 0
  v_dot2_f32_bf16 v190, v34, s84, 0
  v_dot2_f32_bf16 v187, v35, s83, 0
  v_dot2_f32_bf16 v191, v35, s84, 0
  v_dot2_f32_bf16 v184, v36, s83, v184
  v_dot2_f32_bf16 v188, v36, s84, v188
  v_dot2_f32_bf16 v185, v37, s83, v185
  v_dot2_f32_bf16 v189, v37, s84, v189
  v_dot2_f32_bf16 v186, v38, s83, v186
  v_dot2_f32_bf16 v190, v38, s84, v190
  v_dot2_f32_bf16 v187, v39, s83, v187
  v_dot2_f32_bf16 v191, v39, s84, v191
  v_dot2_f32_bf16 v184, v40, s83, v184
  v_dot2_f32_bf16 v188, v40, s84, v188
  v_dot2_f32_bf16 v185, v41, s83, v185
  v_dot2_f32_bf16 v189, v41, s84, v189
  v_dot2_f32_bf16 v186, v42, s83, v186
  v_dot2_f32_bf16 v190, v42, s84, v190
  v_dot2_f32_bf16 v187, v43, s83, v187
  v_dot2_f32_bf16 v191, v43, s84, v191
  v_dot2_f32_bf16 v184, v44, s83, v184
  v_dot2_f32_bf16 v188, v44, s84, v188
  v_dot2_f32_bf16 v185, v45, s83, v185
  v_dot2_f32_bf16 v189, v45, s84, v189
  v_dot2_f32_bf16 v186, v46, s83, v186
  v_dot2_f32_bf16 v190, v46, s84, v190
  v_dot2_f32_bf16 v187, v47, s83, v187
  v_dot2_f32_bf16 v191, v47, s84, v191
  s_waitcnt vmcnt(0)
  v_dot2_f32_bf16 v184, v48, s83, v184
  v_dot2_f32_bf16 v188, v48, s84, v188
  v_dot2_f32_bf16 v185, v49, s83, v185
  v_dot2_f32_bf16 v189, v49, s84, v189
  v_dot2_f32_bf16 v186, v50, s83, v186
  v_dot2_f32_bf16 v190, v50, s84, v190
  v_dot2_f32_bf16 v187, v51, s83, v187
  v_dot2_f32_bf16 v191, v51, s84, v191
  v_dot2_f32_bf16 v184, v52, s83, v184
  v_dot2_f32_bf16 v188, v52, s84, v188
  v_dot2_f32_bf16 v185, v53, s83, v185
  v_dot2_f32_bf16 v189, v53, s84, v189
  v_dot2_f32_bf16 v186, v54, s83, v186
  v_dot2_f32_bf16 v190, v54, s84, v190
  v_dot2_f32_bf16 v187, v55, s83, v187
  v_dot2_f32_bf16 v191, v55, s84, v191
  v_dot2_f32_bf16 v184, v56, s83, v184
  v_dot2_f32_bf16 v188, v56, s84, v188
  v_dot2_f32_bf16 v185, v57, s83, v185
  v_dot2_f32_bf16 v189, v57, s84, v189
  v_dot2_f32_bf16 v186, v58, s83, v186
  v_dot2_f32_bf16 v190, v58, s84, v190
  v_dot2_f32_bf16 v187, v59, s83, v187
  v_dot2_f32_bf16 v191, v59, s84, v191
  v_dot2_f32_bf16 v184, v60, s83, v184
  v_dot2_f32_bf16 v188, v60, s84, v188
  v_dot2_f32_bf16 v185, v61, s83, v185
  v_dot2_f32_bf16 v189, v61, s84, v189
  v_dot2_f32_bf16 v186, v62, s83, v186
  v_dot2_f32_bf16 v190, v62, s84, v190
  v_dot2_f32_bf16 v187, v63, s83, v187
  v_dot2_f32_bf16 v191, v63, s84, v191
  s_nop 1
  v_cvt_pk_bf16_f32 v232, v184, v188
  v_cvt_pk_bf16_f32 v233, v185, v189
  v_cvt_pk_bf16_f32 v234, v186, v190
  v_cvt_pk_bf16_f32 v235, v187, v191
  s_nop 1
  v_permlane16_swap_b32 v232, v234
  v_permlane16_swap_b32 v233, v235
  s_add_u32 s39, s82, 32768
  buffer_store_dwordx4 v[232:235], v225, s[64:67], s39 offen
L_fin_CW:
  s_branch L_end
L_LW:
  s_add_u32 s36, s35, 4
  s_and_b32 s36, s36, 7
  s_lshl_b32 s38, s31, 5
  s_add_u32 s38, s38, s32
  s_lshl_b32 s38, s38, 18
  s_add_u32 s12, s46, s38
  s_addc_u32 s13, s47, 0
  s_mov_b32 s14, 0x40000
  s_mov_b32 s15, 0x20000
  s_add_u32 s16, s48, s38
  s_addc_u32 s17, s49, 0
  s_mov_b32 s18, 0x40000
  s_mov_b32 s19, 0x20000
  s_lshl_b32 s38, s34, 19
  s_lshl_b32 s39, s33, 8
  s_add_u32 s38, s38, s39
  s_add_u32 s20, s52, s38
  s_addc_u32 s21, s53, 0
  s_sub_u32 s22, 0x400000, s38
  s_mov_b32 s23, 0x20000
  s_mov_b64 s[24:25], s[54:55]
  s_mov_b64 s[26:27], s[56:57]
  s_mov_b64 s[28:29], s[58:59]
  s_cmp_lg_u32 s2, 0
  s_cbranch_scc1 L_noep3
  s_memrealtime s[100:101]
  s_waitcnt lgkmcnt(0)
  s_or_b32 s100, s100, 1
  v_mov_b32 v120, s100
  v_mov_b32 v121, s101
  v_mov_b32 v126, 0
  s_mov_b64 s[42:43], exec
  s_mov_b64 exec, 1
  global_store_dwordx2 v126, v[120:121], s[26:27] sc1
  s_mov_b64 exec, s[42:43]
L_noep3:
  v_xor_b32 v9, v3, v2
  v_lshlrev_b32 v9, 4, v9
  v_lshl_add_u32 v228, v2, 8, v9
  v_xor_b32 v229, 64, v228
  v_xor_b32 v230, 128, v228
  v_xor_b32 v231, 192, v228
  v_lshlrev_b32 v9, 1, v2
  v_xor_b32 v9, v9, v3
  v_lshlrev_b32 v9, 4, v9
  v_lshl_add_u32 v232, v2, 8, v9
  v_xor_b32 v233, 128, v232
  v_lshl_add_u32 v234, v2, 10, v9
  v_xor_b32 v235, 128, v234
  v_add_u32 v236, 6144, v234
  v_add_u32 v235, 3072, v235
  v_add_u32 v237, 6144, v235
  v_xor_b32 v9, v3, v2
  v_lshlrev_b32 v9, 4, v9
  v_lshl_add_u32 v9, v3, 8, v9
  v_add_u32 v240, 98304, v9
  v_xor_b32 v241, 64, v240
  v_xor_b32 v242, 128, v240
  v_xor_b32 v243, 192, v240
  v_lshl_add_u32 v10, v2, 2, v6
  v_and_b32 v11, 7, v10
  v_lshlrev_b32 v11, 1, v11
  v_lshrrev_b32 v12, 1, v7
  v_or_b32 v11, v11, v12
  v_lshlrev_b32 v11, 4, v11
  v_and_b32 v12, 1, v7
  v_lshl_add_u32 v11, v12, 3, v11
  v_lshl_add_u32 v11, v10, 8, v11
  v_add_u32 v244, 98304, v11
  v_xor_b32 v245, 32, v244
  v_xor_b32 v246, 64, v244
  v_xor_b32 v247, 96, v244
  v_xor_b32 v248, 128, v244
  v_xor_b32 v249, 160, v244
  v_xor_b32 v250, 192, v244
  v_xor_b32 v251, 224, v244
  v_lshl_add_u32 v10, v2, 3, v6
  v_lshlrev_b32 v11, 2, v6
  v_or_b32 v11, v11, v7
  v_lshlrev_b32 v11, 4, v11
  v_lshl_add_u32 v11, v10, 8, v11
  v_add_u32 v128, 28672, v11
  v_xor_b32 v129, 64, v128
  v_xor_b32 v130, 128, v128
  v_xor_b32 v131, 192, v128
  v_lshrrev_b32 v11, 1, v3
  v_xor_b32 v11, v11, v2
  v_lshlrev_b32 v11, 4, v11
  v_lshl_add_u32 v11, v3, 7, v11
  s_lshl_b32 s38, s30, 13
  s_add_u32 s38, s38, 0
  v_add_u32 v132, s38, v11
  v_xor_b32 v133, 64, v132
  v_add_u32 v134, 90112, v132
  v_add_u32 v135, 90112, v133
  v_add_u32 v160, 90112, v128
  v_add_u32 v161, 90112, v129
  v_add_u32 v162, 90112, v130
  v_add_u32 v163, 90112, v131
  v_mov_b32 v192, 0
  v_mov_b32 v193, 0
  v_mov_b32 v194, 0
  v_mov_b32 v195, 0
  v_mov_b32 v238, 0
  v_mov_b32 v239, 0
  v_mov_b32 v222, 0
  v_mov_b32 v223, 0
  s_add_u32 s38, s33, s30
  s_and_b32 s38, s38, 3
  s_lshl_b32 s90, s38, 17
  s_lshl_b32 s91, s30, 15
  s_mov_b32 s87, 0
  s_mov_b32 s88, 32768
  s_mov_b32 s89, 24576
  s_barrier
  ds_read_b128 a[128:131], v132 offset:0
  ds_read_b128 a[136:139], v132 offset:2048
  ds_read_b64_tr_b16 a[0:1], v128 offset:0
  ds_read_b64_tr_b16 a[2:3], v128 offset:1024
  ds_read_b64_tr_b16 a[4:5], v128 offset:8
  ds_read_b64_tr_b16 a[6:7], v128 offset:1032
  ds_read_b64_tr_b16 a[8:9], v129 offset:0
  ds_read_b64_tr_b16 a[10:11], v129 offset:1024
  ds_read_b64_tr_b16 a[12:13], v129 offset:8
  ds_read_b64_tr_b16 a[14:15], v129 offset:1032
  ds_read_b64_tr_b16 a[16:17], v130 offset:0
  ds_read_b64_tr_b16 a[18:19], v130 offset:1024
  ds_read_b64_tr_b16 a[20:21], v130 offset:8
  ds_read_b64_tr_b16 a[22:23], v130 offset:1032
  ds_read_b64_tr_b16 a[24:25], v131 offset:0
  ds_read_b64_tr_b16 a[26:27], v131 offset:1024
  ds_read_b64_tr_b16 a[28:29], v131 offset:8
  ds_read_b64_tr_b16 a[30:31], v131 offset:1032
  ds_read_b128 a[132:135], v133 offset:0
  ds_read_b128 a[140:143], v133 offset:2048
  ds_read_b64_tr_b16 a[32:33], v128 offset:8192
  ds_read_b64_tr_b16 a[34:35], v128 offset:9216
  ds_read_b64_tr_b16 a[36:37], v128 offset:8200
  ds_read_b64_tr_b16 a[38:39], v128 offset:9224
  ds_read_b64_tr_b16 a[40:41], v129 offset:8192
  ds_read_b64_tr_b16 a[42:43], v129 offset:9216
  ds_read_b64_tr_b16 a[44:45], v129 offset:8200
  ds_read_b64_tr_b16 a[46:47], v129 offset:9224
  ds_read_b64_tr_b16 a[48:49], v130 offset:8192
  ds_read_b64_tr_b16 a[50:51], v130 offset:9216
  ds_read_b64_tr_b16 a[52:53], v130 offset:8200
  ds_read_b64_tr_b16 a[54:55], v130 offset:9224
  ds_read_b64_tr_b16 a[56:57], v131 offset:8192
  ds_read_b64_tr_b16 a[58:59], v131 offset:9216
  ds_read_b64_tr_b16 a[60:61], v131 offset:8200
  ds_read_b64_tr_b16 a[62:63], v131 offset:9224
  s_waitcnt lgkmcnt(0)
  v_mfma_f32_16x16x32_bf16 v[0:3], a[0:3], a[128:131], 0
  s_barrier
  v_mfma_f32_16x16x32_bf16 v[32:35], a[0:3], a[136:139], 0
  s_lshl_b32 s86, s36, 7
  s_lshl_b32 s87, s36, 19
  s_mov_b32 m0, 90112
  s_add_u32 s38, s86, 0
  buffer_load_dwordx4 v152, s[4:7], s38 offen offset:0 lds
  v_mfma_f32_16x16x32_bf16 v[4:7], a[4:7], a[128:131], 0
  ds_read_b128 a[160:163], v132 offset:45056
  ds_read_b128 a[168:171], v132 offset:47104
  buffer_load_dwordx4 v153, s[4:7], s38 offen offset:1024 lds
  buffer_load_dwordx4 v154, s[4:7], s38 offen offset:2048 lds
  buffer_load_dwordx4 v155, s[4:7], s38 offen offset:3072 lds
  s_mov_b32 m0, 94208
  s_add_u32 s38, s86, 32768
  v_mfma_f32_16x16x32_bf16 v[36:39], a[4:7], a[136:139], 0
  ds_read_b64_tr_b16 a[64:65], v128 offset:45056
  buffer_load_dwordx4 v152, s[4:7], s38 offen offset:0 lds
  buffer_load_dwordx4 v153, s[4:7], s38 offen offset:1024 lds
  buffer_load_dwordx4 v154, s[4:7], s38 offen offset:2048 lds
  buffer_load_dwordx4 v155, s[4:7], s38 offen offset:3072 lds
  v_mfma_f32_16x16x32_bf16 v[8:11], a[8:11], a[128:131], 0
  ds_read_b64_tr_b16 a[66:67], v128 offset:46080
  s_mov_b32 m0, 98304
  s_add_u32 s38, s86, 65536
  buffer_load_dwordx4 v152, s[4:7], s38 offen offset:0 lds
  buffer_load_dwordx4 v153, s[4:7], s38 offen offset:1024 lds
  buffer_load_dwordx4 v154, s[4:7], s38 offen offset:2048 lds
  v_mfma_f32_16x16x32_bf16 v[40:43], a[8:11], a[136:139], 0
  ds_read_b64_tr_b16 a[68:69], v128 offset:45064
  ds_read_b64_tr_b16 a[70:71], v128 offset:46088
  buffer_load_dwordx4 v155, s[4:7], s38 offen offset:3072 lds
  s_mov_b32 m0, 102400
  s_add_u32 s38, s86, 98304
  buffer_load_dwordx4 v152, s[4:7], s38 offen offset:0 lds
  buffer_load_dwordx4 v153, s[4:7], s38 offen offset:1024 lds
  v_mfma_f32_16x16x32_bf16 v[12:15], a[12:15], a[128:131], 0
  ds_read_b64_tr_b16 a[72:73], v129 offset:45056
  buffer_load_dwordx4 v154, s[4:7], s38 offen offset:2048 lds
  buffer_load_dwordx4 v155, s[4:7], s38 offen offset:3072 lds
  s_mov_b32 m0, 106496
  s_add_u32 s38, s86, 131072
  v_mfma_f32_16x16x32_bf16 v[44:47], a[12:15], a[136:139], 0
  ds_read_b64_tr_b16 a[74:75], v129 offset:46080
  buffer_load_dwordx4 v152, s[4:7], s38 offen offset:0 lds
  buffer_load_dwordx4 v153, s[4:7], s38 offen offset:1024 lds
  buffer_load_dwordx4 v154, s[4:7], s38 offen offset:2048 lds
  buffer_load_dwordx4 v155, s[4:7], s38 offen offset:3072 lds
  s_mov_b32 m0, 110592
  v_mfma_f32_16x16x32_bf16 v[16:19], a[16:19], a[128:131], 0
  ds_read_b64_tr_b16 a[76:77], v129 offset:45064
  s_add_u32 s38, s86, 163840
  buffer_load_dwordx4 v152, s[4:7], s38 offen offset:0 lds
  buffer_load_dwordx4 v153, s[4:7], s38 offen offset:1024 lds
  buffer_load_dwordx4 v154, s[4:7], s38 offen offset:2048 lds
  buffer_load_dwordx4 v155, s[4:7], s38 offen offset:3072 lds
  v_mfma_f32_16x16x32_bf16 v[48:51], a[16:19], a[136:139], 0
  ds_read_b64_tr_b16 a[78:79], v129 offset:46088
  ds_read_b64_tr_b16 a[80:81], v130 offset:45056
  s_mov_b32 m0, 114688
  s_add_u32 s38, s86, 196608
  buffer_load_dwordx4 v152, s[4:7], s38 offen offset:0 lds
  buffer_load_dwordx4 v153, s[4:7], s38 offen offset:1024 lds
  v_mfma_f32_16x16x32_bf16 v[20:23], a[20:23], a[128:131], 0
  ds_read_b64_tr_b16 a[82:83], v130 offset:46080
  buffer_load_dwordx4 v154, s[4:7], s38 offen offset:2048 lds
  buffer_load_dwordx4 v155, s[4:7], s38 offen offset:3072 lds
  s_mov_b32 m0, 118784
  s_add_u32 s38, s87, 0
  buffer_load_dwordx4 v156, s[8:11], s38 offen offset:0 lds
  v_mfma_f32_16x16x32_bf16 v[52:55], a[20:23], a[136:139], 0
  ds_read_b64_tr_b16 a[84:85], v130 offset:45064
  buffer_load_dwordx4 v157, s[8:11], s38 offen offset:1024 lds
  buffer_load_dwordx4 v158, s[8:11], s38 offen offset:2048 lds
  buffer_load_dwordx4 v159, s[8:11], s38 offen offset:3072 lds
  s_mov_b32 m0, 122880
  s_add_u32 s38, s87, 131072
  v_mfma_f32_16x16x32_bf16 v[24:27], a[24:27], a[128:131], 0
  ds_read_b64_tr_b16 a[86:87], v130 offset:46088
  ds_read_b64_tr_b16 a[88:89], v131 offset:45056
  buffer_load_dwordx4 v156, s[8:11], s38 offen offset:0 lds
  buffer_load_dwordx4 v157, s[8:11], s38 offen offset:1024 lds
  buffer_load_dwordx4 v158, s[8:11], s38 offen offset:2048 lds
  buffer_load_dwordx4 v159, s[8:11], s38 offen offset:3072 lds
  v_mfma_f32_16x16x32_bf16 v[56:59], a[24:27], a[136:139], 0
  ds_read_b64_tr_b16 a[90:91], v131 offset:46080
  s_mov_b32 m0, 126976
  s_add_u32 s38, s87, 262144
  buffer_load_dwordx4 v156, s[8:11], s38 offen offset:0 lds
  buffer_load_dwordx4 v157, s[8:11], s38 offen offset:1024 lds
  buffer_load_dwordx4 v158, s[8:11], s38 offen offset:2048 lds
  v_mfma_f32_16x16x32_bf16 v[28:31], a[28:31], a[128:131], 0
  ds_read_b64_tr_b16 a[92:93], v131 offset:45064
  buffer_load_dwordx4 v159, s[8:11], s38 offen offset:3072 lds
  s_mov_b32 m0, 131072
  s_add_u32 s38, s87, 393216
  buffer_load_dwordx4 v156, s[8:11], s38 offen offset:0 lds
  buffer_load_dwordx4 v157, s[8:11], s38 offen offset:1024 lds
  v_mfma_f32_16x16x32_bf16 v[60:63], a[28:31], a[136:139], 0
  ds_read_b64_tr_b16 a[94:95], v131 offset:46088
  buffer_load_dwordx4 v158, s[8:11], s38 offen offset:2048 lds
  buffer_load_dwordx4 v159, s[8:11], s38 offen offset:3072 lds
  s_add_u32 s36, s36, 2
  s_and_b32 s36, s36, 7
  v_mfma_f32_16x16x32_bf16 v[0:3], a[32:35], a[132:135], v[0:3]
  ds_read_b128 a[164:167], v133 offset:45056
  ds_read_b128 a[172:175], v133 offset:47104
  s_lshl_b32 s86, s36, 7
  s_lshl_b32 s87, s36, 19
  s_mov_b32 m0, 0
  s_add_u32 s38, s86, 0
  buffer_load_dwordx4 v152, s[4:7], s38 offen offset:0 lds
  v_mfma_f32_16x16x32_bf16 v[32:35], a[32:35], a[140:143], v[32:35]
  ds_read_b64_tr_b16 a[96:97], v128 offset:53248
  buffer_load_dwordx4 v153, s[4:7], s38 offen offset:1024 lds
  buffer_load_dwordx4 v154, s[4:7], s38 offen offset:2048 lds
  buffer_load_dwordx4 v155, s[4:7], s38 offen offset:3072 lds
  s_mov_b32 m0, 4096
  s_add_u32 s38, s86, 32768
  v_mfma_f32_16x16x32_bf16 v[4:7], a[36:39], a[132:135], v[4:7]
  ds_read_b64_tr_b16 a[98:99], v128 offset:54272
  buffer_load_dwordx4 v152, s[4:7], s38 offen offset:0 lds
  buffer_load_dwordx4 v153, s[4:7], s38 offen offset:1024 lds
  buffer_load_dwordx4 v154, s[4:7], s38 offen offset:2048 lds
  buffer_load_dwordx4 v155, s[4:7], s38 offen offset:3072 lds
  v_mfma_f32_16x16x32_bf16 v[36:39], a[36:39], a[140:143], v[36:39]
  ds_read_b64_tr_b16 a[100:101], v128 offset:53256
  ds_read_b64_tr_b16 a[102:103], v128 offset:54280
  s_mov_b32 m0, 8192
  s_add_u32 s38, s86, 65536
  buffer_load_dwordx4 v152, s[4:7], s38 offen offset:0 lds
  buffer_load_dwordx4 v153, s[4:7], s38 offen offset:1024 lds
  buffer_load_dwordx4 v154, s[4:7], s38 offen offset:2048 lds
  v_mfma_f32_16x16x32_bf16 v[8:11], a[40:43], a[132:135], v[8:11]
  ds_read_b64_tr_b16 a[104:105], v129 offset:53248
  buffer_load_dwordx4 v155, s[4:7], s38 offen offset:3072 lds
  s_mov_b32 m0, 12288
  s_add_u32 s38, s86, 98304
  buffer_load_dwordx4 v152, s[4:7], s38 offen offset:0 lds
  buffer_load_dwordx4 v153, s[4:7], s38 offen offset:1024 lds
  v_mfma_f32_16x16x32_bf16 v[40:43], a[40:43], a[140:143], v[40:43]
  ds_read_b64_tr_b16 a[106:107], v129 offset:54272
  buffer_load_dwordx4 v154, s[4:7], s38 offen offset:2048 lds
  buffer_load_dwordx4 v155, s[4:7], s38 offen offset:3072 lds
  s_mov_b32 m0, 16384
  s_add_u32 s38, s86, 131072
  v_mfma_f32_16x16x32_bf16 v[12:15], a[44:47], a[132:135], v[12:15]
  ds_read_b64_tr_b16 a[108:109], v129 offset:53256
  buffer_load_dwordx4 v152, s[4:7], s38 offen offset:0 lds
  buffer_load_dwordx4 v153, s[4:7], s38 offen offset:1024 lds
  buffer_load_dwordx4 v154, s[4:7], s38 offen offset:2048 lds
  buffer_load_dwordx4 v155, s[4:7], s38 offen offset:3072 lds
  s_mov_b32 m0, 20480
  v_mfma_f32_16x16x32_bf16 v[44:47], a[44:47], a[140:143], v[44:47]
  ds_read_b64_tr_b16 a[110:111], v129 offset:54280
  ds_read_b64_tr_b16 a[112:113], v130 offset:53248
  s_add_u32 s38, s86, 163840
  buffer_load_dwordx4 v152, s[4:7], s38 offen offset:0 lds
  buffer_load_dwordx4 v153, s[4:7], s38 offen offset:1024 lds
  buffer_load_dwordx4 v154, s[4:7], s38 offen offset:2048 lds
  buffer_load_dwordx4 v155, s[4:7], s38 offen offset:3072 lds
  v_mfma_f32_16x16x32_bf16 v[16:19], a[48:51], a[132:135], v[16:19]
  ds_read_b64_tr_b16 a[114:115], v130 offset:54272
  s_mov_b32 m0, 24576
  s_add_u32 s38, s86, 196608
  buffer_load_dwordx4 v152, s[4:7], s38 offen offset:0 lds
  buffer_load_dwordx4 v153, s[4:7], s38 offen offset:1024 lds
  v_mfma_f32_16x16x32_bf16 v[48:51], a[48:51], a[140:143], v[48:51]
  ds_read_b64_tr_b16 a[116:117], v130 offset:53256
  buffer_load_dwordx4 v154, s[4:7], s38 offen offset:2048 lds
  buffer_load_dwordx4 v155, s[4:7], s38 offen offset:3072 lds
  s_mov_b32 m0, 28672
  s_add_u32 s38, s87, 0
  buffer_load_dwordx4 v156, s[8:11], s38 offen offset:0 lds
  v_mfma_f32_16x16x32_bf16 v[20:23], a[52:55], a[132:135], v[20:23]
  ds_read_b64_tr_b16 a[118:119], v130 offset:54280
  ds_read_b64_tr_b16 a[120:121], v131 offset:53248
  buffer_load_dwordx4 v157, s[8:11], s38 offen offset:1024 lds
  buffer_load_dwordx4 v158, s[8:11], s38 offen offset:2048 lds
  buffer_load_dwordx4 v159, s[8:11], s38 offen offset:3072 lds
  s_mov_b32 m0, 32768
  s_add_u32 s38, s87, 131072
  v_mfma_f32_16x16x32_bf16 v[52:55], a[52:55], a[140:143], v[52:55]
  ds_read_b64_tr_b16 a[122:123], v131 offset:54272
  buffer_load_dwordx4 v156, s[8:11], s38 offen offset:0 lds
  buffer_load_dwordx4 v157, s[8:11], s38 offen offset:1024 lds
  buffer_load_dwordx4 v158, s[8:11], s38 offen offset:2048 lds
  buffer_load_dwordx4 v159, s[8:11], s38 offen offset:3072 lds
  v_mfma_f32_16x16x32_bf16 v[24:27], a[56:59], a[132:135], v[24:27]
  ds_read_b64_tr_b16 a[124:125], v131 offset:53256
  s_mov_b32 m0, 36864
  s_add_u32 s38, s87, 262144
  buffer_load_dwordx4 v156, s[8:11], s38 offen offset:0 lds
  buffer_load_dwordx4 v157, s[8:11], s38 offen offset:1024 lds
  buffer_load_dwordx4 v158, s[8:11], s38 offen offset:2048 lds
  v_mfma_f32_16x16x32_bf16 v[56:59], a[56:59], a[140:143], v[56:59]
  ds_read_b64_tr_b16 a[126:127], v131 offset:54280
  buffer_load_dwordx4 v159, s[8:11], s38 offen offset:3072 lds
  s_mov_b32 m0, 40960
  s_add_u32 s38, s87, 393216
  buffer_load_dwordx4 v156, s[8:11], s38 offen offset:0 lds
  buffer_load_dwordx4 v157, s[8:11], s38 offen offset:1024 lds
  v_mfma_f32_16x16x32_bf16 v[28:31], a[60:63], a[132:135], v[28:31]
  buffer_load_dwordx4 v158, s[8:11], s38 offen offset:2048 lds
  buffer_load_dwordx4 v159, s[8:11], s38 offen offset:3072 lds
  s_add_u32 s36, s36, 3
  s_and_b32 s36, s36, 7
  v_mfma_f32_16x16x32_bf16 v[60:63], a[60:63], a[140:143], v[60:63]
  s_waitcnt lgkmcnt(0)
  v_mfma_f32_16x16x32_bf16 v[0:3], a[64:67], a[160:163], v[0:3]
  s_waitcnt vmcnt(44)
  s_barrier
  v_mfma_f32_16x16x32_bf16 v[32:35], a[64:67], a[168:171], v[32:35]
  s_lshl_b32 s86, s36, 7
  s_lshl_b32 s87, s36, 19
  s_mov_b32 m0, 45056
  v_mfma_f32_16x16x32_bf16 v[4:7], a[68:71], a[160:163], v[4:7]
  ds_read_b128 a[128:131], v134 offset:0
  ds_read_b128 a[136:139], v134 offset:2048
  s_add_u32 s38, s86, 0
  buffer_load_dwordx4 v152, s[4:7], s38 offen offset:0 lds
  v_mfma_f32_16x16x32_bf16 v[36:39], a[68:71], a[168:171], v[36:39]
  ds_read_b64_tr_b16 a[0:1], v160 offset:0
  buffer_load_dwordx4 v153, s[4:7], s38 offen offset:1024 lds
  buffer_load_dwordx4 v154, s[4:7], s38 offen offset:2048 lds
  v_mfma_f32_16x16x32_bf16 v[8:11], a[72:75], a[160:163], v[8:11]
  ds_read_b64_tr_b16 a[2:3], v160 offset:1024
  buffer_load_dwordx4 v155, s[4:7], s38 offen offset:3072 lds
  s_mov_b32 m0, 49152
  s_add_u32 s38, s86, 32768
  v_mfma_f32_16x16x32_bf16 v[40:43], a[72:75], a[168:171], v[40:43]
  ds_read_b64_tr_b16 a[4:5], v160 offset:8
  ds_read_b64_tr_b16 a[6:7], v160 offset:1032
  buffer_load_dwordx4 v152, s[4:7], s38 offen offset:0 lds
  buffer_load_dwordx4 v153, s[4:7], s38 offen offset:1024 lds
  v_mfma_f32_16x16x32_bf16 v[12:15], a[76:79], a[160:163], v[12:15]
  ds_read_b64_tr_b16 a[8:9], v161 offset:0
  buffer_load_dwordx4 v154, s[4:7], s38 offen offset:2048 lds
  buffer_load_dwordx4 v155, s[4:7], s38 offen offset:3072 lds
  v_mfma_f32_16x16x32_bf16 v[44:47], a[76:79], a[168:171], v[44:47]
  ds_read_b64_tr_b16 a[10:11], v161 offset:1024
  s_mov_b32 m0, 53248
  s_add_u32 s38, s86, 65536
  buffer_load_dwordx4 v152, s[4:7], s38 offen offset:0 lds
  v_mfma_f32_16x16x32_bf16 v[16:19], a[80:83], a[160:163], v[16:19]
  ds_read_b64_tr_b16 a[12:13], v161 offset:8
  buffer_load_dwordx4 v153, s[4:7], s38 offen offset:1024 lds
  buffer_load_dwordx4 v154, s[4:7], s38 offen offset:2048 lds
  v_mfma_f32_16x16x32_bf16 v[48:51], a[80:83], a[168:171], v[48:51]
  ds_read_b64_tr_b16 a[14:15], v161 offset:1032
  ds_read_b64_tr_b16 a[16:17], v162 offset:0
  buffer_load_dwordx4 v155, s[4:7], s38 offen offset:3072 lds
  s_mov_b32 m0, 57344
  v_mfma_f32_16x16x32_bf16 v[20:23], a[84:87], a[160:163], v[20:23]
  ds_read_b64_tr_b16 a[18:19], v162 offset:1024
  s_add_u32 s38, s86, 98304
  buffer_load_dwordx4 v152, s[4:7], s38 offen offset:0 lds
  buffer_load_dwordx4 v153, s[4:7], s38 offen offset:1024 lds
  v_mfma_f32_16x16x32_bf16 v[52:55], a[84:87], a[168:171], v[52:55]
  ds_read_b64_tr_b16 a[20:21], v162 offset:8
  buffer_load_dwordx4 v154, s[4:7], s38 offen offset:2048 lds
  buffer_load_dwordx4 v155, s[4:7], s38 offen offset:3072 lds
  v_mfma_f32_16x16x32_bf16 v[24:27], a[88:91], a[160:163], v[24:27]
  ds_read_b64_tr_b16 a[22:23], v162 offset:1032
  ds_read_b64_tr_b16 a[24:25], v163 offset:0
  s_mov_b32 m0, 61440
  s_add_u32 s38, s86, 131072
  v_mfma_f32_16x16x32_bf16 v[56:59], a[88:91], a[168:171], v[56:59]
  ds_read_b64_tr_b16 a[26:27], v163 offset:1024
  buffer_load_dwordx4 v152, s[4:7], s38 offen offset:0 lds
  buffer_load_dwordx4 v153, s[4:7], s38 offen offset:1024 lds
  buffer_load_dwordx4 v154, s[4:7], s38 offen offset:2048 lds
  v_mfma_f32_16x16x32_bf16 v[28:31], a[92:95], a[160:163], v[28:31]
  ds_read_b64_tr_b16 a[28:29], v163 offset:8
  buffer_load_dwordx4 v155, s[4:7], s38 offen offset:3072 lds
  s_mov_b32 m0, 65536
  v_mfma_f32_16x16x32_bf16 v[60:63], a[92:95], a[168:171], v[60:63]
  ds_read_b64_tr_b16 a[30:31], v163 offset:1032
  s_add_u32 s38, s86, 163840
  buffer_load_dwordx4 v152, s[4:7], s38 offen offset:0 lds
  v_mfma_f32_16x16x32_bf16 v[0:3], a[96:99], a[164:167], v[0:3]
  ds_read_b128 a[132:135], v135 offset:0
  ds_read_b128 a[140:143], v135 offset:2048
  buffer_load_dwordx4 v153, s[4:7], s38 offen offset:1024 lds
  buffer_load_dwordx4 v154, s[4:7], s38 offen offset:2048 lds
  buffer_load_dwordx4 v155, s[4:7], s38 offen offset:3072 lds
  v_mfma_f32_16x16x32_bf16 v[32:35], a[96:99], a[172:175], v[32:35]
  ds_read_b64_tr_b16 a[32:33], v160 offset:8192
  s_mov_b32 m0, 69632
  s_add_u32 s38, s86, 196608
  v_mfma_f32_16x16x32_bf16 v[4:7], a[100:103], a[164:167], v[4:7]
  ds_read_b64_tr_b16 a[34:35], v160 offset:9216
  buffer_load_dwordx4 v152, s[4:7], s38 offen offset:0 lds
  buffer_load_dwordx4 v153, s[4:7], s38 offen offset:1024 lds
  v_mfma_f32_16x16x32_bf16 v[36:39], a[100:103], a[172:175], v[36:39]
  ds_read_b64_tr_b16 a[36:37], v160 offset:8200
  ds_read_b64_tr_b16 a[38:39], v160 offset:9224
  buffer_load_dwordx4 v154, s[4:7], s38 offen offset:2048 lds
  buffer_load_dwordx4 v155, s[4:7], s38 offen offset:3072 lds
  s_mov_b32 m0, 73728
  v_mfma_f32_16x16x32_bf16 v[8:11], a[104:107], a[164:167], v[8:11]
  ds_read_b64_tr_b16 a[40:41], v161 offset:8192
  s_add_u32 s38, s87, 0
  buffer_load_dwordx4 v156, s[8:11], s38 offen offset:0 lds
  v_mfma_f32_16x16x32_bf16 v[40:43], a[104:107], a[172:175], v[40:43]
  ds_read_b64_tr_b16 a[42:43], v161 offset:9216
  buffer_load_dwordx4 v157, s[8:11], s38 offen offset:1024 lds
  buffer_load_dwordx4 v158, s[8:11], s38 offen offset:2048 lds
  v_mfma_f32_16x16x32_bf16 v[12:15], a[108:111], a[164:167], v[12:15]
  ds_read_b64_tr_b16 a[44:45], v161 offset:8200
  buffer_load_dwordx4 v159, s[8:11], s38 offen offset:3072 lds
  s_mov_b32 m0, 77824
  s_add_u32 s38, s87, 131072
  v_mfma_f32_16x16x32_bf16 v[44:47], a[108:111], a[172:175], v[44:47]
  ds_read_b64_tr_b16 a[46:47], v161 offset:9224
  ds_read_b64_tr_b16 a[48:49], v162 offset:8192
  buffer_load_dwordx4 v156, s[8:11], s38 offen offset:0 lds
  buffer_load_dwordx4 v157, s[8:11], s38 offen offset:1024 lds
  v_mfma_f32_16x16x32_bf16 v[16:19], a[112:115], a[164:167], v[16:19]
  ds_read_b64_tr_b16 a[50:51], v162 offset:9216
  buffer_load_dwordx4 v158, s[8:11], s38 offen offset:2048 lds
  buffer_load_dwordx4 v159, s[8:11], s38 offen offset:3072 lds
  v_mfma_f32_16x16x32_bf16 v[48:51], a[112:115], a[172:175], v[48:51]
  ds_read_b64_tr_b16 a[52:53], v162 offset:8200
  s_mov_b32 m0, 81920
  s_add_u32 s38, s87, 262144
  buffer_load_dwordx4 v156, s[8:11], s38 offen offset:0 lds
  v_mfma_f32_16x16x32_bf16 v[20:23], a[116:119], a[164:167], v[20:23]
  ds_read_b64_tr_b16 a[54:55], v162 offset:9224
  ds_read_b64_tr_b16 a[56:57], v163 offset:8192
  buffer_load_dwordx4 v157, s[8:11], s38 offen offset:1024 lds
  buffer_load_dwordx4 v158, s[8:11], s38 offen offset:2048 lds
  v_mfma_f32_16x16x32_bf16 v[52:55], a[116:119], a[172:175], v[52:55]
  ds_read_b64_tr_b16 a[58:59], v163 offset:9216
  buffer_load_dwordx4 v159, s[8:11], s38 offen offset:3072 lds
  s_mov_b32 m0, 86016
  v_mfma_f32_16x16x32_bf16 v[24:27], a[120:123], a[164:167], v[24:27]
  ds_read_b64_tr_b16 a[60:61], v163 offset:8200
  s_add_u32 s38, s87, 393216
  buffer_load_dwordx4 v156, s[8:11], s38 offen offset:0 lds
  buffer_load_dwordx4 v157, s[8:11], s38 offen offset:1024 lds
  v_mfma_f32_16x16x32_bf16 v[56:59], a[120:123], a[172:175], v[56:59]
  ds_read_b64_tr_b16 a[62:63], v163 offset:9224
  buffer_load_dwordx4 v158, s[8:11], s38 offen offset:2048 lds
  buffer_load_dwordx4 v159, s[8:11], s38 offen offset:3072 lds
  v_mfma_f32_16x16x32_bf16 v[28:31], a[124:127], a[164:167], v[28:31]
  s_add_u32 s36, s36, 2
  s_and_b32 s36, s36, 7
  v_mfma_f32_16x16x32_bf16 v[60:63], a[124:127], a[172:175], v[60:63]
  s_waitcnt lgkmcnt(0)
  v_mfma_f32_16x16x32_bf16 v[0:3], a[0:3], a[128:131], v[0:3]
  s_waitcnt vmcnt(44)
  s_barrier
  v_mfma_f32_16x16x32_bf16 v[32:35], a[0:3], a[136:139], v[32:35]
  s_lshl_b32 s86, s36, 7
  s_lshl_b32 s87, s36, 19
  s_mov_b32 m0, 90112
  v_mfma_f32_16x16x32_bf16 v[4:7], a[4:7], a[128:131], v[4:7]
  ds_read_b128 a[160:163], v132 offset:0
  ds_read_b128 a[168:171], v132 offset:2048
  s_add_u32 s38, s86, 0
  buffer_load_dwordx4 v152, s[4:7], s38 offen offset:0 lds
  v_mfma_f32_16x16x32_bf16 v[36:39], a[4:7], a[136:139], v[36:39]
  ds_read_b64_tr_b16 a[64:65], v128 offset:0
  buffer_load_dwordx4 v153, s[4:7], s38 offen offset:1024 lds
  buffer_load_dwordx4 v154, s[4:7], s38 offen offset:2048 lds
  v_mfma_f32_16x16x32_bf16 v[8:11], a[8:11], a[128:131], v[8:11]
  ds_read_b64_tr_b16 a[66:67], v128 offset:1024
  buffer_load_dwordx4 v155, s[4:7], s38 offen offset:3072 lds
  s_mov_b32 m0, 94208
  s_add_u32 s38, s86, 32768
  v_mfma_f32_16x16x32_bf16 v[40:43], a[8:11], a[136:139], v[40:43]
  ds_read_b64_tr_b16 a[68:69], v128 offset:8
  ds_read_b64_tr_b16 a[70:71], v128 offset:1032
  buffer_load_dwordx4 v152, s[4:7], s38 offen offset:0 lds
  buffer_load_dwordx4 v153, s[4:7], s38 offen offset:1024 lds
  v_mfma_f32_16x16x32_bf16 v[12:15], a[12:15], a[128:131], v[12:15]
  ds_read_b64_tr_b16 a[72:73], v129 offset:0
  buffer_load_dwordx4 v154, s[4:7], s38 offen offset:2048 lds
  buffer_load_dwordx4 v155, s[4:7], s38 offen offset:3072 lds
  v_mfma_f32_16x16x32_bf16 v[44:47], a[12:15], a[136:139], v[44:47]
  ds_read_b64_tr_b16 a[74:75], v129 offset:1024
  s_mov_b32 m0, 98304
  s_add_u32 s38, s86, 65536
  buffer_load_dwordx4 v152, s[4:7], s38 offen offset:0 lds
  v_mfma_f32_16x16x32_bf16 v[16:19], a[16:19], a[128:131], v[16:19]
  ds_read_b64_tr_b16 a[76:77], v129 offset:8
  buffer_load_dwordx4 v153, s[4:7], s38 offen offset:1024 lds
  buffer_load_dwordx4 v154, s[4:7], s38 offen offset:2048 lds
  v_mfma_f32_16x16x32_bf16 v[48:51], a[16:19], a[136:139], v[48:51]
  ds_read_b64_tr_b16 a[78:79], v129 offset:1032
  ds_read_b64_tr_b16 a[80:81], v130 offset:0
  buffer_load_dwordx4 v155, s[4:7], s38 offen offset:3072 lds
  s_mov_b32 m0, 102400
  v_mfma_f32_16x16x32_bf16 v[20:23], a[20:23], a[128:131], v[20:23]
  ds_read_b64_tr_b16 a[82:83], v130 offset:1024
  s_add_u32 s38, s86, 98304
  buffer_load_dwordx4 v152, s[4:7], s38 offen offset:0 lds
  buffer_load_dwordx4 v153, s[4:7], s38 offen offset:1024 lds
  v_mfma_f32_16x16x32_bf16 v[52:55], a[20:23], a[136:139], v[52:55]
  ds_read_b64_tr_b16 a[84:85], v130 offset:8
  buffer_load_dwordx4 v154, s[4:7], s38 offen offset:2048 lds
  buffer_load_dwordx4 v155, s[4:7], s38 offen offset:3072 lds
  v_mfma_f32_16x16x32_bf16 v[24:27], a[24:27], a[128:131], v[24:27]
  ds_read_b64_tr_b16 a[86:87], v130 offset:1032
  ds_read_b64_tr_b16 a[88:89], v131 offset:0
  s_mov_b32 m0, 106496
  s_add_u32 s38, s86, 131072
  v_mfma_f32_16x16x32_bf16 v[56:59], a[24:27], a[136:139], v[56:59]
  ds_read_b64_tr_b16 a[90:91], v131 offset:1024
  buffer_load_dwordx4 v152, s[4:7], s38 offen offset:0 lds
  buffer_load_dwordx4 v153, s[4:7], s38 offen offset:1024 lds
  buffer_load_dwordx4 v154, s[4:7], s38 offen offset:2048 lds
  v_mfma_f32_16x16x32_bf16 v[28:31], a[28:31], a[128:131], v[28:31]
  ds_read_b64_tr_b16 a[92:93], v131 offset:8
  buffer_load_dwordx4 v155, s[4:7], s38 offen offset:3072 lds
  s_mov_b32 m0, 110592
  v_mfma_f32_16x16x32_bf16 v[60:63], a[28:31], a[136:139], v[60:63]
  ds_read_b64_tr_b16 a[94:95], v131 offset:1032
  s_add_u32 s38, s86, 163840
  buffer_load_dwordx4 v152, s[4:7], s38 offen offset:0 lds
  v_mfma_f32_16x16x32_bf16 v[0:3], a[32:35], a[132:135], v[0:3]
  ds_read_b128 a[164:167], v133 offset:0
  ds_read_b128 a[172:175], v133 offset:2048
  buffer_load_dwordx4 v153, s[4:7], s38 offen offset:1024 lds
  buffer_load_dwordx4 v154, s[4:7], s38 offen offset:2048 lds
  buffer_load_dwordx4 v155, s[4:7], s38 offen offset:3072 lds
  v_mfma_f32_16x16x32_bf16 v[32:35], a[32:35], a[140:143], v[32:35]
  ds_read_b64_tr_b16 a[96:97], v128 offset:8192
  s_mov_b32 m0, 114688
  s_add_u32 s38, s86, 196608
  v_mfma_f32_16x16x32_bf16 v[4:7], a[36:39], a[132:135], v[4:7]
  ds_read_b64_tr_b16 a[98:99], v128 offset:9216
  buffer_load_dwordx4 v152, s[4:7], s38 offen offset:0 lds
  buffer_load_dwordx4 v153, s[4:7], s38 offen offset:1024 lds
  v_mfma_f32_16x16x32_bf16 v[36:39], a[36:39], a[140:143], v[36:39]
  ds_read_b64_tr_b16 a[100:101], v128 offset:8200
  ds_read_b64_tr_b16 a[102:103], v128 offset:9224
  buffer_load_dwordx4 v154, s[4:7], s38 offen offset:2048 lds
  buffer_load_dwordx4 v155, s[4:7], s38 offen offset:3072 lds
  s_mov_b32 m0, 118784
  v_mfma_f32_16x16x32_bf16 v[8:11], a[40:43], a[132:135], v[8:11]
  ds_read_b64_tr_b16 a[104:105], v129 offset:8192
  s_add_u32 s38, s87, 0
  buffer_load_dwordx4 v156, s[8:11], s38 offen offset:0 lds
  v_mfma_f32_16x16x32_bf16 v[40:43], a[40:43], a[140:143], v[40:43]
  ds_read_b64_tr_b16 a[106:107], v129 offset:9216
  buffer_load_dwordx4 v157, s[8:11], s38 offen offset:1024 lds
  buffer_load_dwordx4 v158, s[8:11], s38 offen offset:2048 lds
  v_mfma_f32_16x16x32_bf16 v[12:15], a[44:47], a[132:135], v[12:15]
  ds_read_b64_tr_b16 a[108:109], v129 offset:8200
  buffer_load_dwordx4 v159, s[8:11], s38 offen offset:3072 lds
  s_mov_b32 m0, 122880
  s_add_u32 s38, s87, 131072
  v_mfma_f32_16x16x32_bf16 v[44:47], a[44:47], a[140:143], v[44:47]
  ds_read_b64_tr_b16 a[110:111], v129 offset:9224
  ds_read_b64_tr_b16 a[112:113], v130 offset:8192
  buffer_load_dwordx4 v156, s[8:11], s38 offen offset:0 lds
  buffer_load_dwordx4 v157, s[8:11], s38 offen offset:1024 lds
  v_mfma_f32_16x16x32_bf16 v[16:19], a[48:51], a[132:135], v[16:19]
  ds_read_b64_tr_b16 a[114:115], v130 offset:9216
  buffer_load_dwordx4 v158, s[8:11], s38 offen offset:2048 lds
  buffer_load_dwordx4 v159, s[8:11], s38 offen offset:3072 lds
  v_mfma_f32_16x16x32_bf16 v[48:51], a[48:51], a[140:143], v[48:51]
  ds_read_b64_tr_b16 a[116:117], v130 offset:8200
  s_mov_b32 m0, 126976
  s_add_u32 s38, s87, 262144
  buffer_load_dwordx4 v156, s[8:11], s38 offen offset:0 lds
  v_mfma_f32_16x16x32_bf16 v[20:23], a[52:55], a[132:135], v[20:23]
  ds_read_b64_tr_b16 a[118:119], v130 offset:9224
  ds_read_b64_tr_b16 a[120:121], v131 offset:8192
  buffer_load_dwordx4 v157, s[8:11], s38 offen offset:1024 lds
  buffer_load_dwordx4 v158, s[8:11], s38 offen offset:2048 lds
  v_mfma_f32_16x16x32_bf16 v[52:55], a[52:55], a[140:143], v[52:55]
  ds_read_b64_tr_b16 a[122:123], v131 offset:9216
  buffer_load_dwordx4 v159, s[8:11], s38 offen offset:3072 lds
  s_mov_b32 m0, 131072
  v_mfma_f32_16x16x32_bf16 v[24:27], a[56:59], a[132:135], v[24:27]
  ds_read_b64_tr_b16 a[124:125], v131 offset:8200
  s_add_u32 s38, s87, 393216
  buffer_load_dwordx4 v156, s[8:11], s38 offen offset:0 lds
  buffer_load_dwordx4 v157, s[8:11], s38 offen offset:1024 lds
  v_mfma_f32_16x16x32_bf16 v[56:59], a[56:59], a[140:143], v[56:59]
  ds_read_b64_tr_b16 a[126:127], v131 offset:9224
  buffer_load_dwordx4 v158, s[8:11], s38 offen offset:2048 lds
  buffer_load_dwordx4 v159, s[8:11], s38 offen offset:3072 lds
  v_mfma_f32_16x16x32_bf16 v[28:31], a[60:63], a[132:135], v[28:31]
  s_add_u32 s36, s36, 2
  s_and_b32 s36, s36, 7
  v_mfma_f32_16x16x32_bf16 v[60:63], a[60:63], a[140:143], v[60:63]
  s_waitcnt lgkmcnt(0)
  v_mfma_f32_16x16x32_bf16 v[0:3], a[64:67], a[160:163], v[0:3]
  s_waitcnt vmcnt(44)
  s_barrier
  v_mfma_f32_16x16x32_bf16 v[32:35], a[64:67], a[168:171], v[32:35]
  s_lshl_b32 s86, s36, 7
  s_lshl_b32 s87, s36, 19
  s_mov_b32 m0, 0
  v_mfma_f32_16x16x32_bf16 v[4:7], a[68:71], a[160:163], v[4:7]
  ds_read_b128 a[128:131], v132 offset:45056
  ds_read_b128 a[136:139], v132 offset:47104
  s_add_u32 s38, s86, 0
  buffer_load_dwordx4 v152, s[4:7], s38 offen offset:0 lds
  v_mfma_f32_16x16x32_bf16 v[36:39], a[68:71], a[168:171], v[36:39]
  ds_read_b64_tr_b16 a[0:1], v128 offset:45056
  buffer_load_dwordx4 v153, s[4:7], s38 offen offset:1024 lds
  buffer_load_dwordx4 v154, s[4:7], s38 offen offset:2048 lds
  v_mfma_f32_16x16x32_bf16 v[8:11], a[72:75], a[160:163], v[8:11]
  ds_read_b64_tr_b16 a[2:3], v128 offset:46080
  buffer_load_dwordx4 v155, s[4:7], s38 offen offset:3072 lds
  s_mov_b32 m0, 4096
  s_add_u32 s38, s86, 32768
  v_mfma_f32_16x16x32_bf16 v[40:43], a[72:75], a[168:171], v[40:43]
  ds_read_b64_tr_b16 a[4:5], v128 offset:45064
  ds_read_b64_tr_b16 a[6:7], v128 offset:46088
  buffer_load_dwordx4 v152, s[4:7], s38 offen offset:0 lds
  buffer_load_dwordx4 v153, s[4:7], s38 offen offset:1024 lds
  v_mfma_f32_16x16x32_bf16 v[12:15], a[76:79], a[160:163], v[12:15]
  ds_read_b64_tr_b16 a[8:9], v129 offset:45056
  buffer_load_dwordx4 v154, s[4:7], s38 offen offset:2048 lds
  buffer_load_dwordx4 v155, s[4:7], s38 offen offset:3072 lds
  v_mfma_f32_16x16x32_bf16 v[44:47], a[76:79], a[168:171], v[44:47]
  ds_read_b64_tr_b16 a[10:11], v129 offset:46080
  s_mov_b32 m0, 8192
  s_add_u32 s38, s86, 65536
  buffer_load_dwordx4 v152, s[4:7], s38 offen offset:0 lds
  v_mfma_f32_16x16x32_bf16 v[16:19], a[80:83], a[160:163], v[16:19]
  ds_read_b64_tr_b16 a[12:13], v129 offset:45064
  buffer_load_dwordx4 v153, s[4:7], s38 offen offset:1024 lds
  buffer_load_dwordx4 v154, s[4:7], s38 offen offset:2048 lds
  v_mfma_f32_16x16x32_bf16 v[48:51], a[80:83], a[168:171], v[48:51]
  ds_read_b64_tr_b16 a[14:15], v129 offset:46088
  ds_read_b64_tr_b16 a[16:17], v130 offset:45056
  buffer_load_dwordx4 v155, s[4:7], s38 offen offset:3072 lds
  s_mov_b32 m0, 12288
  v_mfma_f32_16x16x32_bf16 v[20:23], a[84:87], a[160:163], v[20:23]
  ds_read_b64_tr_b16 a[18:19], v130 offset:46080
  s_add_u32 s38, s86, 98304
  buffer_load_dwordx4 v152, s[4:7], s38 offen offset:0 lds
  buffer_load_dwordx4 v153, s[4:7], s38 offen offset:1024 lds
  v_mfma_f32_16x16x32_bf16 v[52:55], a[84:87], a[168:171], v[52:55]
  ds_read_b64_tr_b16 a[20:21], v130 offset:45064
  buffer_load_dwordx4 v154, s[4:7], s38 offen offset:2048 lds
  buffer_load_dwordx4 v155, s[4:7], s38 offen offset:3072 lds
  v_mfma_f32_16x16x32_bf16 v[24:27], a[88:91], a[160:163], v[24:27]
  ds_read_b64_tr_b16 a[22:23], v130 offset:46088
  ds_read_b64_tr_b16 a[24:25], v131 offset:45056
  s_mov_b32 m0, 16384
  s_add_u32 s38, s86, 131072
  v_mfma_f32_16x16x32_bf16 v[56:59], a[88:91], a[168:171], v[56:59]
  ds_read_b64_tr_b16 a[26:27], v131 offset:46080
  buffer_load_dwordx4 v152, s[4:7], s38 offen offset:0 lds
  buffer_load_dwordx4 v153, s[4:7], s38 offen offset:1024 lds
  buffer_load_dwordx4 v154, s[4:7], s38 offen offset:2048 lds
  v_mfma_f32_16x16x32_bf16 v[28:31], a[92:95], a[160:163], v[28:31]
  ds_read_b64_tr_b16 a[28:29], v131 offset:45064
  buffer_load_dwordx4 v155, s[4:7], s38 offen offset:3072 lds
  s_mov_b32 m0, 20480
  v_mfma_f32_16x16x32_bf16 v[60:63], a[92:95], a[168:171], v[60:63]
  ds_read_b64_tr_b16 a[30:31], v131 offset:46088
  s_add_u32 s38, s86, 163840
  buffer_load_dwordx4 v152, s[4:7], s38 offen offset:0 lds
  v_mfma_f32_16x16x32_bf16 v[0:3], a[96:99], a[164:167], v[0:3]
  ds_read_b128 a[132:135], v133 offset:45056
  ds_read_b128 a[140:143], v133 offset:47104
  buffer_load_dwordx4 v153, s[4:7], s38 offen offset:1024 lds
  buffer_load_dwordx4 v154, s[4:7], s38 offen offset:2048 lds
  buffer_load_dwordx4 v155, s[4:7], s38 offen offset:3072 lds
  v_mfma_f32_16x16x32_bf16 v[32:35], a[96:99], a[172:175], v[32:35]
  ds_read_b64_tr_b16 a[32:33], v128 offset:53248
  s_mov_b32 m0, 24576
  s_add_u32 s38, s86, 196608
  v_mfma_f32_16x16x32_bf16 v[4:7], a[100:103], a[164:167], v[4:7]
  ds_read_b64_tr_b16 a[34:35], v128 offset:54272
  buffer_load_dwordx4 v152, s[4:7], s38 offen offset:0 lds
  buffer_load_dwordx4 v153, s[4:7], s38 offen offset:1024 lds
  v_mfma_f32_16x16x32_bf16 v[36:39], a[100:103], a[172:175], v[36:39]
  ds_read_b64_tr_b16 a[36:37], v128 offset:53256
  ds_read_b64_tr_b16 a[38:39], v128 offset:54280
  buffer_load_dwordx4 v154, s[4:7], s38 offen offset:2048 lds
  buffer_load_dwordx4 v155, s[4:7], s38 offen offset:3072 lds
  s_mov_b32 m0, 28672
  v_mfma_f32_16x16x32_bf16 v[8:11], a[104:107], a[164:167], v[8:11]
  ds_read_b64_tr_b16 a[40:41], v129 offset:53248
  s_add_u32 s38, s87, 0
  buffer_load_dwordx4 v156, s[8:11], s38 offen offset:0 lds
  v_mfma_f32_16x16x32_bf16 v[40:43], a[104:107], a[172:175], v[40:43]
  ds_read_b64_tr_b16 a[42:43], v129 offset:54272
  buffer_load_dwordx4 v157, s[8:11], s38 offen offset:1024 lds
  buffer_load_dwordx4 v158, s[8:11], s38 offen offset:2048 lds
  v_mfma_f32_16x16x32_bf16 v[12:15], a[108:111], a[164:167], v[12:15]
  ds_read_b64_tr_b16 a[44:45], v129 offset:53256
  buffer_load_dwordx4 v159, s[8:11], s38 offen offset:3072 lds
  s_mov_b32 m0, 32768
  s_add_u32 s38, s87, 131072
  v_mfma_f32_16x16x32_bf16 v[44:47], a[108:111], a[172:175], v[44:47]
  ds_read_b64_tr_b16 a[46:47], v129 offset:54280
  ds_read_b64_tr_b16 a[48:49], v130 offset:53248
  buffer_load_dwordx4 v156, s[8:11], s38 offen offset:0 lds
  buffer_load_dwordx4 v157, s[8:11], s38 offen offset:1024 lds
  v_mfma_f32_16x16x32_bf16 v[16:19], a[112:115], a[164:167], v[16:19]
  ds_read_b64_tr_b16 a[50:51], v130 offset:54272
  buffer_load_dwordx4 v158, s[8:11], s38 offen offset:2048 lds
  buffer_load_dwordx4 v159, s[8:11], s38 offen offset:3072 lds
  v_mfma_f32_16x16x32_bf16 v[48:51], a[112:115], a[172:175], v[48:51]
  ds_read_b64_tr_b16 a[52:53], v130 offset:53256
  s_mov_b32 m0, 36864
  s_add_u32 s38, s87, 262144
  buffer_load_dwordx4 v156, s[8:11], s38 offen offset:0 lds
  v_mfma_f32_16x16x32_bf16 v[20:23], a[116:119], a[164:167], v[20:23]
  ds_read_b64_tr_b16 a[54:55], v130 offset:54280
  ds_read_b64_tr_b16 a[56:57], v131 offset:53248
  buffer_load_dwordx4 v157, s[8:11], s38 offen offset:1024 lds
  buffer_load_dwordx4 v158, s[8:11], s38 offen offset:2048 lds
  v_mfma_f32_16x16x32_bf16 v[52:55], a[116:119], a[172:175], v[52:55]
  ds_read_b64_tr_b16 a[58:59], v131 offset:54272
  buffer_load_dwordx4 v159, s[8:11], s38 offen offset:3072 lds
  s_mov_b32 m0, 40960
  v_mfma_f32_16x16x32_bf16 v[24:27], a[120:123], a[164:167], v[24:27]
  ds_read_b64_tr_b16 a[60:61], v131 offset:53256
  s_add_u32 s38, s87, 393216
  buffer_load_dwordx4 v156, s[8:11], s38 offen offset:0 lds
  buffer_load_dwordx4 v157, s[8:11], s38 offen offset:1024 lds
  v_mfma_f32_16x16x32_bf16 v[56:59], a[120:123], a[172:175], v[56:59]
  ds_read_b64_tr_b16 a[62:63], v131 offset:54280
  buffer_load_dwordx4 v158, s[8:11], s38 offen offset:2048 lds
  buffer_load_dwordx4 v159, s[8:11], s38 offen offset:3072 lds
  v_mfma_f32_16x16x32_bf16 v[28:31], a[124:127], a[164:167], v[28:31]
  s_add_u32 s36, s36, 2
  s_and_b32 s36, s36, 7
  v_mfma_f32_16x16x32_bf16 v[60:63], a[124:127], a[172:175], v[60:63]
  s_waitcnt lgkmcnt(0)
  v_mfma_f32_16x16x32_bf16 v[0:3], a[0:3], a[128:131], v[0:3]
  s_waitcnt vmcnt(44)
  s_barrier
  v_mfma_f32_16x16x32_bf16 v[32:35], a[0:3], a[136:139], v[32:35]
  s_lshl_b32 s86, s36, 7
  s_lshl_b32 s87, s36, 19
  s_mov_b32 m0, 45056
  v_mfma_f32_16x16x32_bf16 v[4:7], a[4:7], a[128:131], v[4:7]
  ds_read_b128 a[160:163], v134 offset:0
  ds_read_b128 a[168:171], v134 offset:2048
  s_add_u32 s38, s86, 0
  buffer_load_dwordx4 v152, s[4:7], s38 offen offset:0 lds
  buffer_load_dwordx4 v153, s[4:7], s38 offen offset:1024 lds
  v_mfma_f32_16x16x32_bf16 v[36:39], a[4:7], a[136:139], v[36:39]
  ds_read_b64_tr_b16 a[64:65], v160 offset:0
  buffer_load_dwordx4 v154, s[4:7], s38 offen offset:2048 lds
  buffer_load_dwordx4 v155, s[4:7], s38 offen offset:3072 lds
  s_mov_b32 m0, 49152
  v_mfma_f32_16x16x32_bf16 v[8:11], a[8:11], a[128:131], v[8:11]
  ds_read_b64_tr_b16 a[66:67], v160 offset:1024
  s_add_u32 s38, s86, 32768
  buffer_load_dwordx4 v152, s[4:7], s38 offen offset:0 lds
  v_mfma_f32_16x16x32_bf16 v[40:43], a[8:11], a[136:139], v[40:43]
  ds_read_b64_tr_b16 a[68:69], v160 offset:8
  ds_read_b64_tr_b16 a[70:71], v160 offset:1032
  buffer_load_dwordx4 v153, s[4:7], s38 offen offset:1024 lds
  buffer_load_dwordx4 v154, s[4:7], s38 offen offset:2048 lds
  buffer_load_dwordx4 v155, s[4:7], s38 offen offset:3072 lds
  v_mfma_f32_16x16x32_bf16 v[12:15], a[12:15], a[128:131], v[12:15]
  ds_read_b64_tr_b16 a[72:73], v161 offset:0
  s_mov_b32 m0, 53248
  s_add_u32 s38, s86, 65536
  buffer_load_dwordx4 v152, s[4:7], s38 offen offset:0 lds
  v_mfma_f32_16x16x32_bf16 v[44:47], a[12:15], a[136:139], v[44:47]
  ds_read_b64_tr_b16 a[74:75], v161 offset:1024
  buffer_load_dwordx4 v153, s[4:7], s38 offen offset:1024 lds
  buffer_load_dwordx4 v154, s[4:7], s38 offen offset:2048 lds
  buffer_load_dwordx4 v155, s[4:7], s38 offen offset:3072 lds
  v_mfma_f32_16x16x32_bf16 v[16:19], a[16:19], a[128:131], v[16:19]
  ds_read_b64_tr_b16 a[76:77], v161 offset:8
  s_mov_b32 m0, 57344
  s_add_u32 s38, s86, 98304
  v_mfma_f32_16x16x32_bf16 v[48:51], a[16:19], a[136:139], v[48:51]
  ds_read_b64_tr_b16 a[78:79], v161 offset:1032
  ds_read_b64_tr_b16 a[80:81], v162 offset:0
  buffer_load_dwordx4 v152, s[4:7], s38 offen offset:0 lds
  buffer_load_dwordx4 v153, s[4:7], s38 offen offset:1024 lds
  buffer_load_dwordx4 v154, s[4:7], s38 offen offset:2048 lds
  v_mfma_f32_16x16x32_bf16 v[20:23], a[20:23], a[128:131], v[20:23]
  ds_read_b64_tr_b16 a[82:83], v162 offset:1024
  buffer_load_dwordx4 v155, s[4:7], s38 offen offset:3072 lds
  s_mov_b32 m0, 61440
  s_add_u32 s38, s86, 131072
  v_mfma_f32_16x16x32_bf16 v[52:55], a[20:23], a[136:139], v[52:55]
  ds_read_b64_tr_b16 a[84:85], v162 offset:8
  buffer_load_dwordx4 v152, s[4:7], s38 offen offset:0 lds
  buffer_load_dwordx4 v153, s[4:7], s38 offen offset:1024 lds
  buffer_load_dwordx4 v154, s[4:7], s38 offen offset:2048 lds
  v_mfma_f32_16x16x32_bf16 v[24:27], a[24:27], a[128:131], v[24:27]
  ds_read_b64_tr_b16 a[86:87], v162 offset:1032
  ds_read_b64_tr_b16 a[88:89], v163 offset:0
  buffer_load_dwordx4 v155, s[4:7], s38 offen offset:3072 lds
  s_mov_b32 m0, 65536
  v_mfma_f32_16x16x32_bf16 v[56:59], a[24:27], a[136:139], v[56:59]
  ds_read_b64_tr_b16 a[90:91], v163 offset:1024
  s_add_u32 s38, s86, 163840
  buffer_load_dwordx4 v152, s[4:7], s38 offen offset:0 lds
  buffer_load_dwordx4 v153, s[4:7], s38 offen offset:1024 lds
  v_mfma_f32_16x16x32_bf16 v[28:31], a[28:31], a[128:131], v[28:31]
  ds_read_b64_tr_b16 a[92:93], v163 offset:8
  buffer_load_dwordx4 v154, s[4:7], s38 offen offset:2048 lds
  buffer_load_dwordx4 v155, s[4:7], s38 offen offset:3072 lds
  s_mov_b32 m0, 69632
  v_mfma_f32_16x16x32_bf16 v[60:63], a[28:31], a[136:139], v[60:63]
  ds_read_b64_tr_b16 a[94:95], v163 offset:1032
  s_add_u32 s38, s86, 196608
  buffer_load_dwordx4 v152, s[4:7], s38 offen offset:0 lds
  v_mfma_f32_16x16x32_bf16 v[0:3], a[32:35], a[132:135], v[0:3]
  ds_read_b128 a[164:167], v135 offset:0
  ds_read_b128 a[172:175], v135 offset:2048
  buffer_load_dwordx4 v153, s[4:7], s38 offen offset:1024 lds
  buffer_load_dwordx4 v154, s[4:7], s38 offen offset:2048 lds
  buffer_load_dwordx4 v155, s[4:7], s38 offen offset:3072 lds
  v_mfma_f32_16x16x32_bf16 v[32:35], a[32:35], a[140:143], v[32:35]
  ds_read_b64_tr_b16 a[96:97], v160 offset:8192
  s_mov_b32 m0, 73728
  s_add_u32 s38, s87, 0
  buffer_load_dwordx4 v156, s[8:11], s38 offen offset:0 lds
  v_mfma_f32_16x16x32_bf16 v[4:7], a[36:39], a[132:135], v[4:7]
  ds_read_b64_tr_b16 a[98:99], v160 offset:9216
  buffer_load_dwordx4 v157, s[8:11], s38 offen offset:1024 lds
  buffer_load_dwordx4 v158, s[8:11], s38 offen offset:2048 lds
  buffer_load_dwordx4 v159, s[8:11], s38 offen offset:3072 lds
  v_mfma_f32_16x16x32_bf16 v[36:39], a[36:39], a[140:143], v[36:39]
  ds_read_b64_tr_b16 a[100:101], v160 offset:8200
  ds_read_b64_tr_b16 a[102:103], v160 offset:9224
  s_mov_b32 m0, 77824
  s_add_u32 s38, s87, 131072
  v_mfma_f32_16x16x32_bf16 v[8:11], a[40:43], a[132:135], v[8:11]
  ds_read_b64_tr_b16 a[104:105], v161 offset:8192
  buffer_load_dwordx4 v156, s[8:11], s38 offen offset:0 lds
  buffer_load_dwordx4 v157, s[8:11], s38 offen offset:1024 lds
  buffer_load_dwordx4 v158, s[8:11], s38 offen offset:2048 lds
  v_mfma_f32_16x16x32_bf16 v[40:43], a[40:43], a[140:143], v[40:43]
  ds_read_b64_tr_b16 a[106:107], v161 offset:9216
  buffer_load_dwordx4 v159, s[8:11], s38 offen offset:3072 lds
  s_mov_b32 m0, 81920
  s_add_u32 s38, s87, 262144
  v_mfma_f32_16x16x32_bf16 v[12:15], a[44:47], a[132:135], v[12:15]
  ds_read_b64_tr_b16 a[108:109], v161 offset:8200
  buffer_load_dwordx4 v156, s[8:11], s38 offen offset:0 lds
  buffer_load_dwordx4 v157, s[8:11], s38 offen offset:1024 lds
  buffer_load_dwordx4 v158, s[8:11], s38 offen offset:2048 lds
  v_mfma_f32_16x16x32_bf16 v[44:47], a[44:47], a[140:143], v[44:47]
  ds_read_b64_tr_b16 a[110:111], v161 offset:9224
  ds_read_b64_tr_b16 a[112:113], v162 offset:8192
  buffer_load_dwordx4 v159, s[8:11], s38 offen offset:3072 lds
  s_mov_b32 m0, 86016
  v_mfma_f32_16x16x32_bf16 v[16:19], a[48:51], a[132:135], v[16:19]
  ds_read_b64_tr_b16 a[114:115], v162 offset:9216
  s_add_u32 s38, s87, 393216
  buffer_load_dwordx4 v156, s[8:11], s38 offen offset:0 lds
  buffer_load_dwordx4 v157, s[8:11], s38 offen offset:1024 lds
  v_mfma_f32_16x16x32_bf16 v[48:51], a[48:51], a[140:143], v[48:51]
  ds_read_b64_tr_b16 a[116:117], v162 offset:8200
  buffer_load_dwordx4 v158, s[8:11], s38 offen offset:2048 lds
  buffer_load_dwordx4 v159, s[8:11], s38 offen offset:3072 lds
  s_add_u32 s36, s36, 2
  v_mfma_f32_16x16x32_bf16 v[20:23], a[52:55], a[132:135], v[20:23]
  ds_read_b64_tr_b16 a[118:119], v162 offset:9224
  ds_read_b64_tr_b16 a[120:121], v163 offset:8192
  s_and_b32 s36, s36, 7
  s_mov_b32 m0, 139264
  s_mov_b32 s39, 0
  v_mfma_f32_16x16x32_bf16 v[52:55], a[52:55], a[140:143], v[52:55]
  ds_read_b64_tr_b16 a[122:123], v163 offset:9216
  buffer_load_dwordx4 v228, s[12:15], s39 offen offset:0 nt lds
  buffer_load_dwordx4 v229, s[12:15], s39 offen offset:1024 nt lds
  v_mfma_f32_16x16x32_bf16 v[24:27], a[56:59], a[132:135], v[24:27]
  ds_read_b64_tr_b16 a[124:125], v163 offset:8200
  buffer_load_dwordx4 v230, s[12:15], s39 offen offset:2048 nt lds
  buffer_load_dwordx4 v231, s[12:15], s39 offen offset:3072 nt lds
  s_mov_b32 m0, 143360
  v_mfma_f32_16x16x32_bf16 v[56:59], a[56:59], a[140:143], v[56:59]
  ds_read_b64_tr_b16 a[126:127], v163 offset:9224
  s_mov_b32 s39, 4096
  buffer_load_dwordx4 v228, s[12:15], s39 offen offset:0 nt lds
  buffer_load_dwordx4 v229, s[12:15], s39 offen offset:1024 nt lds
  v_mfma_f32_16x16x32_bf16 v[28:31], a[60:63], a[132:135], v[28:31]
  buffer_load_dwordx4 v230, s[12:15], s39 offen offset:2048 nt lds
  buffer_load_dwordx4 v231, s[12:15], s39 offen offset:3072 nt lds
  v_mfma_f32_16x16x32_bf16 v[60:63], a[60:63], a[140:143], v[60:63]
  s_waitcnt lgkmcnt(0)
  v_mfma_f32_16x16x32_bf16 v[0:3], a[64:67], a[160:163], v[0:3]
  s_waitcnt vmcnt(52)
  s_barrier
  v_mfma_f32_16x16x32_bf16 v[32:35], a[64:67], a[168:171], v[32:35]
  s_mov_b32 m0, 147456
  v_mfma_f32_16x16x32_bf16 v[4:7], a[68:71], a[160:163], v[4:7]
  ds_read_b128 a[128:131], v132 offset:0
  ds_read_b128 a[136:139], v132 offset:2048
  s_mov_b32 s39, 0
  v_mfma_f32_16x16x32_bf16 v[36:39], a[68:71], a[168:171], v[36:39]
  ds_read_b64_tr_b16 a[0:1], v128 offset:0
  buffer_load_dwordx4 v232, s[16:19], s39 offen offset:0 nt lds
  v_mfma_f32_16x16x32_bf16 v[8:11], a[72:75], a[160:163], v[8:11]
  ds_read_b64_tr_b16 a[2:3], v128 offset:1024
  buffer_load_dwordx4 v233, s[16:19], s39 offen offset:1024 nt lds
  v_mfma_f32_16x16x32_bf16 v[40:43], a[72:75], a[168:171], v[40:43]
  ds_read_b64_tr_b16 a[4:5], v128 offset:8
  ds_read_b64_tr_b16 a[6:7], v128 offset:1032
  v_mfma_f32_16x16x32_bf16 v[12:15], a[76:79], a[160:163], v[12:15]
  ds_read_b64_tr_b16 a[8:9], v129 offset:0
  buffer_load_dwordx4 v232, s[16:19], s39 offen offset:2048 nt lds
  v_mfma_f32_16x16x32_bf16 v[44:47], a[76:79], a[168:171], v[44:47]
  ds_read_b64_tr_b16 a[10:11], v129 offset:1024
  buffer_load_dwordx4 v233, s[16:19], s39 offen offset:3072 nt lds
  v_mfma_f32_16x16x32_bf16 v[16:19], a[80:83], a[160:163], v[16:19]
  ds_read_b64_tr_b16 a[12:13], v129 offset:8
  s_mov_b32 m0, 151552
  v_mfma_f32_16x16x32_bf16 v[48:51], a[80:83], a[168:171], v[48:51]
  ds_read_b64_tr_b16 a[14:15], v129 offset:1032
  ds_read_b64_tr_b16 a[16:17], v130 offset:0
  s_mov_b32 s39, 4096
  v_mfma_f32_16x16x32_bf16 v[20:23], a[84:87], a[160:163], v[20:23]
  ds_read_b64_tr_b16 a[18:19], v130 offset:1024
  v_mfma_f32_16x16x32_bf16 v[52:55], a[84:87], a[168:171], v[52:55]
  ds_read_b64_tr_b16 a[20:21], v130 offset:8
  buffer_load_dwordx4 v232, s[16:19], s39 offen offset:0 nt lds
  v_mfma_f32_16x16x32_bf16 v[24:27], a[88:91], a[160:163], v[24:27]
  ds_read_b64_tr_b16 a[22:23], v130 offset:1032
  ds_read_b64_tr_b16 a[24:25], v131 offset:0
  buffer_load_dwordx4 v233, s[16:19], s39 offen offset:1024 nt lds
  v_mfma_f32_16x16x32_bf16 v[56:59], a[88:91], a[168:171], v[56:59]
  ds_read_b64_tr_b16 a[26:27], v131 offset:1024
  buffer_load_dwordx4 v232, s[16:19], s39 offen offset:2048 nt lds
  v_mfma_f32_16x16x32_bf16 v[28:31], a[92:95], a[160:163], v[28:31]
  ds_read_b64_tr_b16 a[28:29], v131 offset:8
  buffer_load_dwordx4 v233, s[16:19], s39 offen offset:3072 nt lds
  v_mfma_f32_16x16x32_bf16 v[60:63], a[92:95], a[168:171], v[60:63]
  ds_read_b64_tr_b16 a[30:31], v131 offset:1032
  v_mfma_f32_16x16x32_bf16 v[0:3], a[96:99], a[164:167], v[0:3]
  ds_read_b128 a[132:135], v133 offset:0
  ds_read_b128 a[140:143], v133 offset:2048
  s_mov_b32 m0, 155648
  v_mfma_f32_16x16x32_bf16 v[32:35], a[96:99], a[172:175], v[32:35]
  ds_read_b64_tr_b16 a[32:33], v128 offset:8192
  s_mov_b32 s39, 8192
  v_mfma_f32_16x16x32_bf16 v[4:7], a[100:103], a[164:167], v[4:7]
  ds_read_b64_tr_b16 a[34:35], v128 offset:9216
  buffer_load_dwordx4 v228, s[12:15], s39 offen offset:0 nt lds
  v_mfma_f32_16x16x32_bf16 v[36:39], a[100:103], a[172:175], v[36:39]
  ds_read_b64_tr_b16 a[36:37], v128 offset:8200
  ds_read_b64_tr_b16 a[38:39], v128 offset:9224
  buffer_load_dwordx4 v229, s[12:15], s39 offen offset:1024 nt lds
  v_mfma_f32_16x16x32_bf16 v[8:11], a[104:107], a[164:167], v[8:11]
  ds_read_b64_tr_b16 a[40:41], v129 offset:8192
  v_mfma_f32_16x16x32_bf16 v[40:43], a[104:107], a[172:175], v[40:43]
  ds_read_b64_tr_b16 a[42:43], v129 offset:9216
  buffer_load_dwordx4 v230, s[12:15], s39 offen offset:2048 nt lds
  v_mfma_f32_16x16x32_bf16 v[12:15], a[108:111], a[164:167], v[12:15]
  ds_read_b64_tr_b16 a[44:45], v129 offset:8200
  buffer_load_dwordx4 v231, s[12:15], s39 offen offset:3072 nt lds
  v_mfma_f32_16x16x32_bf16 v[44:47], a[108:111], a[172:175], v[44:47]
  ds_read_b64_tr_b16 a[46:47], v129 offset:9224
  ds_read_b64_tr_b16 a[48:49], v130 offset:8192
  s_mov_b32 m0, 159744
  v_mfma_f32_16x16x32_bf16 v[16:19], a[112:115], a[164:167], v[16:19]
  ds_read_b64_tr_b16 a[50:51], v130 offset:9216
  s_mov_b32 s39, 12288
  v_mfma_f32_16x16x32_bf16 v[48:51], a[112:115], a[172:175], v[48:51]
  ds_read_b64_tr_b16 a[52:53], v130 offset:8200
  v_mfma_f32_16x16x32_bf16 v[20:23], a[116:119], a[164:167], v[20:23]
  ds_read_b64_tr_b16 a[54:55], v130 offset:9224
  ds_read_b64_tr_b16 a[56:57], v131 offset:8192
  buffer_load_dwordx4 v228, s[12:15], s39 offen offset:0 nt lds
  v_mfma_f32_16x16x32_bf16 v[52:55], a[116:119], a[172:175], v[52:55]
  ds_read_b64_tr_b16 a[58:59], v131 offset:9216
  buffer_load_dwordx4 v229, s[12:15], s39 offen offset:1024 nt lds
  v_mfma_f32_16x16x32_bf16 v[24:27], a[120:123], a[164:167], v[24:27]
  ds_read_b64_tr_b16 a[60:61], v131 offset:8200
  buffer_load_dwordx4 v230, s[12:15], s39 offen offset:2048 nt lds
  v_mfma_f32_16x16x32_bf16 v[56:59], a[120:123], a[172:175], v[56:59]
  ds_read_b64_tr_b16 a[62:63], v131 offset:9224
  buffer_load_dwordx4 v231, s[12:15], s39 offen offset:3072 nt lds
  v_mfma_f32_16x16x32_bf16 v[28:31], a[124:127], a[164:167], v[28:31]
  v_mfma_f32_16x16x32_bf16 v[60:63], a[124:127], a[172:175], v[60:63]
  s_waitcnt lgkmcnt(0)
  v_mfma_f32_16x16x32_bf16 v[0:3], a[0:3], a[128:131], v[0:3]
  s_waitcnt vmcnt(24)
  s_barrier
  v_mfma_f32_16x16x32_bf16 v[32:35], a[0:3], a[136:139], v[32:35]
  s_mov_b32 m0, 98304
  v_mfma_f32_16x16x32_bf16 v[4:7], a[4:7], a[128:131], v[4:7]
  ds_read_b128 a[160:163], v132 offset:45056
  ds_read_b128 a[168:171], v132 offset:47104
  s_mov_b32 s39, 8192
  v_mfma_f32_16x16x32_bf16 v[36:39], a[4:7], a[136:139], v[36:39]
  ds_read_b64_tr_b16 a[64:65], v128 offset:45056
  buffer_load_dwordx4 v232, s[16:19], s39 offen offset:0 nt lds
  v_mfma_f32_16x16x32_bf16 v[8:11], a[8:11], a[128:131], v[8:11]
  ds_read_b64_tr_b16 a[66:67], v128 offset:46080
  buffer_load_dwordx4 v233, s[16:19], s39 offen offset:1024 nt lds
  v_mfma_f32_16x16x32_bf16 v[40:43], a[8:11], a[136:139], v[40:43]
  ds_read_b64_tr_b16 a[68:69], v128 offset:45064
  ds_read_b64_tr_b16 a[70:71], v128 offset:46088
  v_mfma_f32_16x16x32_bf16 v[12:15], a[12:15], a[128:131], v[12:15]
  ds_read_b64_tr_b16 a[72:73], v129 offset:45056
  buffer_load_dwordx4 v232, s[16:19], s39 offen offset:2048 nt lds
  v_mfma_f32_16x16x32_bf16 v[44:47], a[12:15], a[136:139], v[44:47]
  ds_read_b64_tr_b16 a[74:75], v129 offset:46080
  buffer_load_dwordx4 v233, s[16:19], s39 offen offset:3072 nt lds
  v_mfma_f32_16x16x32_bf16 v[16:19], a[16:19], a[128:131], v[16:19]
  ds_read_b64_tr_b16 a[76:77], v129 offset:45064
  s_mov_b32 m0, 102400
  v_mfma_f32_16x16x32_bf16 v[48:51], a[16:19], a[136:139], v[48:51]
  ds_read_b64_tr_b16 a[78:79], v129 offset:46088
  ds_read_b64_tr_b16 a[80:81], v130 offset:45056
  s_mov_b32 s39, 12288
  v_mfma_f32_16x16x32_bf16 v[20:23], a[20:23], a[128:131], v[20:23]
  ds_read_b64_tr_b16 a[82:83], v130 offset:46080
  v_mfma_f32_16x16x32_bf16 v[52:55], a[20:23], a[136:139], v[52:55]
  ds_read_b64_tr_b16 a[84:85], v130 offset:45064
  buffer_load_dwordx4 v232, s[16:19], s39 offen offset:0 nt lds
  v_mfma_f32_16x16x32_bf16 v[24:27], a[24:27], a[128:131], v[24:27]
  ds_read_b64_tr_b16 a[86:87], v130 offset:46088
  ds_read_b64_tr_b16 a[88:89], v131 offset:45056
  buffer_load_dwordx4 v233, s[16:19], s39 offen offset:1024 nt lds
  v_mfma_f32_16x16x32_bf16 v[56:59], a[24:27], a[136:139], v[56:59]
  ds_read_b64_tr_b16 a[90:91], v131 offset:46080
  buffer_load_dwordx4 v232, s[16:19], s39 offen offset:2048 nt lds
  v_mfma_f32_16x16x32_bf16 v[28:31], a[28:31], a[128:131], v[28:31]
  ds_read_b64_tr_b16 a[92:93], v131 offset:45064
  buffer_load_dwordx4 v233, s[16:19], s39 offen offset:3072 nt lds
  v_mfma_f32_16x16x32_bf16 v[60:63], a[28:31], a[136:139], v[60:63]
  ds_read_b64_tr_b16 a[94:95], v131 offset:46088
  v_mfma_f32_16x16x32_bf16 v[0:3], a[32:35], a[132:135], v[0:3]
  ds_read_b128 a[164:167], v133 offset:45056
  ds_read_b128 a[172:175], v133 offset:47104
  s_mov_b32 m0, 122880
  v_mfma_f32_16x16x32_bf16 v[32:35], a[32:35], a[140:143], v[32:35]
  ds_read_b64_tr_b16 a[96:97], v128 offset:53248
  s_mov_b32 s39, 16384
  v_mfma_f32_16x16x32_bf16 v[4:7], a[36:39], a[132:135], v[4:7]
  ds_read_b64_tr_b16 a[98:99], v128 offset:54272
  buffer_load_dwordx4 v228, s[12:15], s39 offen offset:0 nt lds
  v_mfma_f32_16x16x32_bf16 v[36:39], a[36:39], a[140:143], v[36:39]
  ds_read_b64_tr_b16 a[100:101], v128 offset:53256
  ds_read_b64_tr_b16 a[102:103], v128 offset:54280
  buffer_load_dwordx4 v229, s[12:15], s39 offen offset:1024 nt lds
  v_mfma_f32_16x16x32_bf16 v[8:11], a[40:43], a[132:135], v[8:11]
  ds_read_b64_tr_b16 a[104:105], v129 offset:53248
  v_mfma_f32_16x16x32_bf16 v[40:43], a[40:43], a[140:143], v[40:43]
  ds_read_b64_tr_b16 a[106:107], v129 offset:54272
  buffer_load_dwordx4 v230, s[12:15], s39 offen offset:2048 nt lds
  v_mfma_f32_16x16x32_bf16 v[12:15], a[44:47], a[132:135], v[12:15]
  ds_read_b64_tr_b16 a[108:109], v129 offset:53256
  buffer_load_dwordx4 v231, s[12:15], s39 offen offset:3072 nt lds
  v_mfma_f32_16x16x32_bf16 v[44:47], a[44:47], a[140:143], v[44:47]
  ds_read_b64_tr_b16 a[110:111], v129 offset:54280
  ds_read_b64_tr_b16 a[112:113], v130 offset:53248
  s_mov_b32 m0, 126976
  v_mfma_f32_16x16x32_bf16 v[16:19], a[48:51], a[132:135], v[16:19]
  ds_read_b64_tr_b16 a[114:115], v130 offset:54272
  s_mov_b32 s39, 20480
  v_mfma_f32_16x16x32_bf16 v[48:51], a[48:51], a[140:143], v[48:51]
  ds_read_b64_tr_b16 a[116:117], v130 offset:53256
  v_mfma_f32_16x16x32_bf16 v[20:23], a[52:55], a[132:135], v[20:23]
  ds_read_b64_tr_b16 a[118:119], v130 offset:54280
  ds_read_b64_tr_b16 a[120:121], v131 offset:53248
  buffer_load_dwordx4 v228, s[12:15], s39 offen offset:0 nt lds
  v_mfma_f32_16x16x32_bf16 v[52:55], a[52:55], a[140:143], v[52:55]
  ds_read_b64_tr_b16 a[122:123], v131 offset:54272
  buffer_load_dwordx4 v229, s[12:15], s39 offen offset:1024 nt lds
  v_mfma_f32_16x16x32_bf16 v[24:27], a[56:59], a[132:135], v[24:27]
  ds_read_b64_tr_b16 a[124:125], v131 offset:53256
  buffer_load_dwordx4 v230, s[12:15], s39 offen offset:2048 nt lds
  v_mfma_f32_16x16x32_bf16 v[56:59], a[56:59], a[140:143], v[56:59]
  ds_read_b64_tr_b16 a[126:127], v131 offset:54280
  buffer_load_dwordx4 v231, s[12:15], s39 offen offset:3072 nt lds
  v_mfma_f32_16x16x32_bf16 v[28:31], a[60:63], a[132:135], v[28:31]
  v_mfma_f32_16x16x32_bf16 v[60:63], a[60:63], a[140:143], v[60:63]
  s_mov_b32 s42, 0x3e0293ee
  s_waitcnt lgkmcnt(0)
  v_mfma_f32_16x16x32_bf16 v[0:3], a[64:67], a[160:163], v[0:3]
  s_mov_b32 m0, 106496
  v_mfma_f32_16x16x32_bf16 v[0:3], a[96:99], a[164:167], v[0:3]
  s_mov_b32 s39, 16384
  v_mfma_f32_16x16x32_bf16 v[4:7], a[68:71], a[160:163], v[4:7]
  buffer_load_dwordx4 v232, s[16:19], s39 offen offset:0 nt lds
  v_mfma_f32_16x16x32_bf16 v[4:7], a[100:103], a[164:167], v[4:7]
  buffer_load_dwordx4 v233, s[16:19], s39 offen offset:1024 nt lds
  v_mfma_f32_16x16x32_bf16 v[8:11], a[72:75], a[160:163], v[8:11]
  buffer_load_dwordx4 v232, s[16:19], s39 offen offset:2048 nt lds
  v_mfma_f32_16x16x32_bf16 v[8:11], a[104:107], a[164:167], v[8:11]
  buffer_load_dwordx4 v233, s[16:19], s39 offen offset:3072 nt lds
  v_mfma_f32_16x16x32_bf16 v[12:15], a[76:79], a[160:163], v[12:15]
  s_mov_b32 m0, 110592
  v_mfma_f32_16x16x32_bf16 v[12:15], a[108:111], a[164:167], v[12:15]
  s_mov_b32 s39, 20480
  v_mfma_f32_16x16x32_bf16 v[16:19], a[80:83], a[160:163], v[16:19]
  buffer_load_dwordx4 v232, s[16:19], s39 offen offset:0 nt lds
  v_mul_f32 v0, s42, v0
  v_mul_f32 v1, s42, v1
  v_mfma_f32_16x16x32_bf16 v[16:19], a[112:115], a[164:167], v[16:19]
  buffer_load_dwordx4 v233, s[16:19], s39 offen offset:1024 nt lds
  v_mul_f32 v2, s42, v2
  v_mul_f32 v3, s42, v3
  v_mfma_f32_16x16x32_bf16 v[20:23], a[84:87], a[160:163], v[20:23]
  buffer_load_dwordx4 v232, s[16:19], s39 offen offset:2048 nt lds
  v_mul_f32 v4, s42, v4
  v_mul_f32 v5, s42, v5
  v_mfma_f32_16x16x32_bf16 v[20:23], a[116:119], a[164:167], v[20:23]
  buffer_load_dwordx4 v233, s[16:19], s39 offen offset:3072 nt lds
  v_mul_f32 v6, s42, v6
  v_mul_f32 v7, s42, v7
  v_mfma_f32_16x16x32_bf16 v[24:27], a[88:91], a[160:163], v[24:27]
  s_mov_b32 m0, 131072
  v_cvt_pk_bf16_f32 v0, v0, v1
  v_cvt_pk_bf16_f32 v2, v2, v3
  v_mfma_f32_16x16x32_bf16 v[24:27], a[120:123], a[164:167], v[24:27]
  s_mov_b32 s39, 24576
  v_cvt_pk_bf16_f32 v4, v4, v5
  v_cvt_pk_bf16_f32 v6, v6, v7
  v_mfma_f32_16x16x32_bf16 v[28:31], a[92:95], a[160:163], v[28:31]
  buffer_load_dwordx4 v228, s[12:15], s39 offen offset:0 nt lds
  v_accvgpr_write_b32 a128, v0
  v_accvgpr_write_b32 a129, v2
  v_mfma_f32_16x16x32_bf16 v[28:31], a[124:127], a[164:167], v[28:31]
  buffer_load_dwordx4 v229, s[12:15], s39 offen offset:1024 nt lds
  v_accvgpr_write_b32 a130, v4
  v_accvgpr_write_b32 a131, v6
  v_mfma_f32_16x16x32_bf16 v[32:35], a[64:67], a[168:171], v[32:35]
  buffer_load_dwordx4 v230, s[12:15], s39 offen offset:2048 nt lds
  v_mul_f32 v8, s42, v8
  v_mul_f32 v9, s42, v9
  v_mfma_f32_16x16x32_bf16 v[32:35], a[96:99], a[172:175], v[32:35]
  buffer_load_dwordx4 v231, s[12:15], s39 offen offset:3072 nt lds
  v_mul_f32 v10, s42, v10
  v_mul_f32 v11, s42, v11
  v_mfma_f32_16x16x32_bf16 v[36:39], a[68:71], a[168:171], v[36:39]
  s_mov_b32 m0, 135168
  v_mul_f32 v12, s42, v12
  v_mul_f32 v13, s42, v13
  v_mfma_f32_16x16x32_bf16 v[36:39], a[100:103], a[172:175], v[36:39]
  s_mov_b32 s39, 28672
  v_mul_f32 v14, s42, v14
  v_mul_f32 v15, s42, v15
  v_mfma_f32_16x16x32_bf16 v[40:43], a[72:75], a[168:171], v[40:43]
  buffer_load_dwordx4 v228, s[12:15], s39 offen offset:0 nt lds
  v_cvt_pk_bf16_f32 v8, v8, v9
  v_cvt_pk_bf16_f32 v10, v10, v11
  v_mfma_f32_16x16x32_bf16 v[40:43], a[104:107], a[172:175], v[40:43]
  buffer_load_dwordx4 v229, s[12:15], s39 offen offset:1024 nt lds
  v_cvt_pk_bf16_f32 v12, v12, v13
  v_cvt_pk_bf16_f32 v14, v14, v15
  v_mfma_f32_16x16x32_bf16 v[44:47], a[76:79], a[168:171], v[44:47]
  buffer_load_dwordx4 v230, s[12:15], s39 offen offset:2048 nt lds
  v_accvgpr_write_b32 a132, v8
  v_accvgpr_write_b32 a133, v10
  v_mfma_f32_16x16x32_bf16 v[44:47], a[108:111], a[172:175], v[44:47]
  buffer_load_dwordx4 v231, s[12:15], s39 offen offset:3072 nt lds
  v_accvgpr_write_b32 a134, v12
  v_accvgpr_write_b32 a135, v14
  v_mfma_f32_16x16x32_bf16 v[48:51], a[80:83], a[168:171], v[48:51]
  v_mul_f32 v16, s42, v16
  v_mul_f32 v17, s42, v17
  v_mfma_f32_16x16x32_bf16 v[48:51], a[112:115], a[172:175], v[48:51]
  v_mul_f32 v18, s42, v18
  v_mul_f32 v19, s42, v19
  s_waitcnt vmcnt(48)
  s_barrier
  v_mfma_f32_16x16x32_bf16 v[52:55], a[84:87], a[168:171], v[52:55]
  ds_read_b128 a[192:195], v240 offset:40960
  ds_read_b128 a[196:199], v241 offset:40960
  v_mul_f32 v20, s42, v20
  v_mul_f32 v21, s42, v21
  v_mfma_f32_16x16x32_bf16 v[52:55], a[116:119], a[172:175], v[52:55]
  ds_read_b128 a[200:203], v242 offset:40960
  ds_read_b128 a[204:207], v243 offset:40960
  v_mul_f32 v22, s42, v22
  v_mul_f32 v23, s42, v23
  v_mfma_f32_16x16x32_bf16 v[56:59], a[88:91], a[168:171], v[56:59]
  ds_read_b128 a[208:211], v240 offset:45056
  ds_read_b128 a[212:215], v241 offset:45056
  v_cvt_pk_bf16_f32 v16, v16, v17
  v_cvt_pk_bf16_f32 v18, v18, v19
  v_mfma_f32_16x16x32_bf16 v[56:59], a[120:123], a[172:175], v[56:59]
  ds_read_b128 a[216:219], v242 offset:45056
  ds_read_b128 a[220:223], v243 offset:45056
  v_cvt_pk_bf16_f32 v20, v20, v21
  v_cvt_pk_bf16_f32 v22, v22, v23
  v_mfma_f32_16x16x32_bf16 v[60:63], a[92:95], a[168:171], v[60:63]
  v_accvgpr_write_b32 a136, v16
  v_accvgpr_write_b32 a137, v18
  v_mfma_f32_16x16x32_bf16 v[60:63], a[124:127], a[172:175], v[60:63]
  v_accvgpr_write_b32 a138, v20
  v_accvgpr_write_b32 a139, v22
  v_mfma_f32_32x32x16_bf16 v[0:15], v[192:195], v[192:195], 0
  v_mul_f32 v24, s42, v24
  v_mul_f32 v25, s42, v25
  v_mul_f32 v26, s42, v26
  v_mul_f32 v27, s42, v27
  v_mul_f32 v28, s42, v28
  v_mul_f32 v29, s42, v29
  v_mul_f32 v30, s42, v30
  v_mul_f32 v31, s42, v31
  v_cvt_pk_bf16_f32 v24, v24, v25
  v_cvt_pk_bf16_f32 v26, v26, v27
  v_cvt_pk_bf16_f32 v28, v28, v29
  v_cvt_pk_bf16_f32 v30, v30, v31
  v_accvgpr_write_b32 a140, v24
  v_accvgpr_write_b32 a141, v26
  v_accvgpr_write_b32 a142, v28
  v_accvgpr_write_b32 a143, v30
  v_mfma_f32_32x32x16_bf16 v[16:31], v[192:195], v[192:195], 0
  v_mul_f32 v32, s42, v32
  v_mul_f32 v33, s42, v33
  v_mul_f32 v34, s42, v34
  v_mul_f32 v35, s42, v35
  v_mul_f32 v36, s42, v36
  v_mul_f32 v37, s42, v37
  v_mul_f32 v38, s42, v38
  v_mul_f32 v39, s42, v39
  v_cvt_pk_bf16_f32 v32, v32, v33
  v_cvt_pk_bf16_f32 v34, v34, v35
  v_cvt_pk_bf16_f32 v36, v36, v37
  v_cvt_pk_bf16_f32 v38, v38, v39
  v_accvgpr_write_b32 a144, v32
  v_accvgpr_write_b32 a145, v34
  v_accvgpr_write_b32 a146, v36
  v_accvgpr_write_b32 a147, v38
  v_mul_f32 v40, s42, v40
  v_mul_f32 v41, s42, v41
  v_mul_f32 v42, s42, v42
  v_mul_f32 v43, s42, v43
  v_mul_f32 v44, s42, v44
  v_mul_f32 v45, s42, v45
  v_mul_f32 v46, s42, v46
  v_mul_f32 v47, s42, v47
  v_cvt_pk_bf16_f32 v40, v40, v41
  v_cvt_pk_bf16_f32 v42, v42, v43
  v_cvt_pk_bf16_f32 v44, v44, v45
  v_cvt_pk_bf16_f32 v46, v46, v47
  v_accvgpr_write_b32 a148, v40
  v_accvgpr_write_b32 a149, v42
  v_accvgpr_write_b32 a150, v44
  v_accvgpr_write_b32 a151, v46
  v_mfma_f32_32x32x16_bf16 v[32:47], v[192:195], v[192:195], 0
  v_mul_f32 v48, s42, v48
  v_mul_f32 v49, s42, v49
  v_mul_f32 v50, s42, v50
  v_mul_f32 v51, s42, v51
  v_mul_f32 v52, s42, v52
  v_mul_f32 v53, s42, v53
  v_mul_f32 v54, s42, v54
  v_mul_f32 v55, s42, v55
  v_cvt_pk_bf16_f32 v48, v48, v49
  v_cvt_pk_bf16_f32 v50, v50, v51
  v_cvt_pk_bf16_f32 v52, v52, v53
  v_cvt_pk_bf16_f32 v54, v54, v55
  v_accvgpr_write_b32 a152, v48
  v_accvgpr_write_b32 a153, v50
  v_accvgpr_write_b32 a154, v52
  v_accvgpr_write_b32 a155, v54
  v_mul_f32 v56, s42, v56
  v_mul_f32 v57, s42, v57
  v_mul_f32 v58, s42, v58
  v_mul_f32 v59, s42, v59
  v_mul_f32 v60, s42, v60
  v_mul_f32 v61, s42, v61
  v_mul_f32 v62, s42, v62
  v_mul_f32 v63, s42, v63
  v_cvt_pk_bf16_f32 v56, v56, v57
  v_cvt_pk_bf16_f32 v58, v58, v59
  v_cvt_pk_bf16_f32 v60, v60, v61
  v_cvt_pk_bf16_f32 v62, v62, v63
  v_accvgpr_write_b32 a156, v56
  v_accvgpr_write_b32 a157, v58
  v_accvgpr_write_b32 a158, v60
  v_accvgpr_write_b32 a159, v62
  v_mfma_f32_32x32x16_bf16 v[48:63], v[192:195], v[192:195], 0
  s_waitcnt lgkmcnt(0)
  v_mfma_f32_16x16x32_bf16 v[128:131], a[192:195], a[128:131], 0
  v_mfma_f32_16x16x32_bf16 v[136:139], a[192:195], a[144:147], 0
  v_mfma_f32_16x16x32_bf16 v[128:131], a[196:199], a[132:135], v[128:131]
  v_mfma_f32_16x16x32_bf16 v[136:139], a[196:199], a[148:151], v[136:139]
  v_mfma_f32_16x16x32_bf16 v[128:131], a[200:203], a[136:139], v[128:131]
  v_mfma_f32_16x16x32_bf16 v[136:139], a[200:203], a[152:155], v[136:139]
  v_mfma_f32_16x16x32_bf16 v[128:131], a[204:207], a[140:143], v[128:131]
  v_mfma_f32_16x16x32_bf16 v[136:139], a[204:207], a[156:159], v[136:139]
  v_mfma_f32_16x16x32_bf16 v[132:135], a[208:211], a[128:131], 0
  v_mfma_f32_16x16x32_bf16 v[140:143], a[208:211], a[144:147], 0
  v_mfma_f32_16x16x32_bf16 v[132:135], a[212:215], a[132:135], v[132:135]
  v_mfma_f32_16x16x32_bf16 v[140:143], a[212:215], a[148:151], v[140:143]
  v_mfma_f32_16x16x32_bf16 v[132:135], a[216:219], a[136:139], v[132:135]
  v_mfma_f32_16x16x32_bf16 v[140:143], a[216:219], a[152:155], v[140:143]
  v_mfma_f32_16x16x32_bf16 v[132:135], a[220:223], a[140:143], v[132:135]
  v_mfma_f32_16x16x32_bf16 v[140:143], a[220:223], a[156:159], v[140:143]
  s_mov_b32 s60, s28
  s_mov_b32 s61, s29
  s_mov_b32 s62, 0x10000000
  s_mov_b32 s63, 0x20000
  s_mov_b32 s64, s24
  s_mov_b32 s65, s25
  s_mov_b32 s66, 1835008
  s_mov_b32 s67, 0x20000
  v_lshlrev_b32 v204, 4, v255
  s_lshl_b32 s38, s30, 14
  v_add_u32 v204, s38, v204
  v_subrev_u32 v192, 98304, v244
  v_add_u32 v205, 65536, v192
  v_subrev_u32 v193, 98304, v245
  v_add_u32 v206, 65536, v193
  v_subrev_u32 v194, 98304, v246
  v_add_u32 v207, 65536, v194
  v_subrev_u32 v195, 98304, v247
  v_add_u32 v208, 65536, v195
  v_subrev_u32 v196, 98304, v248
  v_add_u32 v209, 65536, v196
  v_subrev_u32 v197, 98304, v249
  v_add_u32 v210, 65536, v197
  v_subrev_u32 v198, 98304, v250
  v_add_u32 v211, 65536, v198
  v_subrev_u32 v199, 98304, v251
  v_add_u32 v212, 65536, v199
  s_lshl_b32 s76, s2, 16
  s_add_u32 s77, s76, 0x1200000
  s_add_u32 s76, s76, 0x100000
  s_add_u32 s38, s33, 1
  s_and_b32 s38, s38, 3
  s_lshl_b32 s38, s38, 3
  s_andn2_b32 s39, s2, 24
  s_or_b32 s38, s38, s39
  s_lshl_b32 s38, s38, 16
  s_add_u32 s78, s38, 0x100000
  s_add_u32 s38, s33, 2
  s_and_b32 s38, s38, 3
  s_lshl_b32 s38, s38, 3
  s_andn2_b32 s39, s2, 24
  s_or_b32 s38, s38, s39
  s_lshl_b32 s38, s38, 16
  s_add_u32 s79, s38, 0x100000
  s_add_u32 s38, s33, 3
  s_and_b32 s38, s38, 3
  s_lshl_b32 s38, s38, 3
  s_andn2_b32 s39, s2, 24
  s_or_b32 s38, s38, s39
  s_lshl_b32 s38, s38, 16
  s_add_u32 s80, s38, 0x100000
  s_andn2_b32 s38, s2, 7
  v_add_u32 v224, s38, v255
  v_lshlrev_b32 v224, 7, v224
  s_lshl_b32 s38, s38, 16
  s_lshr_b32 s39, s34, 1
  s_lshl_b32 s39, s39, 14
  s_add_u32 s38, s38, s39
  s_and_b32 s39, s34, 1
  s_lshl_b32 s39, s39, 11
  s_add_u32 s38, s38, s39
  s_lshr_b32 s39, s30, 1
  s_lshl_b32 s39, s39, 12
  s_add_u32 s38, s38, s39
  s_and_b32 s39, s30, 1
  s_lshl_b32 s39, s39, 10
  s_add_u32 s38, s38, s39
  s_add_u32 s81, s38, 0x1200000
  s_mul_i32 s82, s31, 229376
  s_lshr_b32 s39, s34, 1
  s_lshl_b32 s39, s39, 16
  s_add_u32 s82, s82, s39
  s_lshr_b32 s39, s30, 1
  s_lshl_b32 s39, s39, 14
  s_add_u32 s82, s82, s39
  s_lshl_b32 s39, s33, 8
  s_add_u32 s82, s82, s39
  s_and_b32 s39, s34, 1
  s_lshl_b32 s39, s39, 7
  s_add_u32 s82, s82, s39
  s_and_b32 s39, s30, 1
  s_lshl_b32 s39, s39, 6
  s_add_u32 s82, s82, s39
  v_and_b32 v225, 15, v255
  v_lshlrev_b32 v225, 10, v225
  v_bfe_u32 v226, v255, 4, 1
  v_lshl_add_u32 v225, v226, 5, v225
  v_lshrrev_b32 v226, 5, v255
  v_lshl_add_u32 v225, v226, 4, v225
  v_lshlrev_b32 v226, 4, v255
  s_mov_b32 s83, 0x3f80
  s_mov_b32 s84, 0x3f800000
  v_exp_f32 v128, v128
  v_exp_f32 v129, v129
  v_add_f32 v238, v128, v238
  v_exp_f32 v130, v130
  v_add_f32 v238, v129, v238
  v_exp_f32 v131, v131
  v_add_f32 v238, v130, v238
  v_exp_f32 v132, v132
  v_add_f32 v238, v131, v238
  v_exp_f32 v133, v133
  v_add_f32 v238, v132, v238
  v_exp_f32 v134, v134
  s_waitcnt vmcnt(32)
  s_barrier
  s_mov_b32 m0, 139264
  s_add_u32 s39, s88, 0
  buffer_load_dwordx4 v228, s[12:15], s39 offen offset:0 nt lds
  buffer_load_dwordx4 v229, s[12:15], s39 offen offset:1024 nt lds
  buffer_load_dwordx4 v230, s[12:15], s39 offen offset:2048 nt lds
  buffer_load_dwordx4 v231, s[12:15], s39 offen offset:3072 nt lds
  s_mov_b32 m0, 143360
  s_add_u32 s39, s88, 4096
  buffer_load_dwordx4 v228, s[12:15], s39 offen offset:0 nt lds
  buffer_load_dwordx4 v229, s[12:15], s39 offen offset:1024 nt lds
  buffer_load_dwordx4 v230, s[12:15], s39 offen offset:2048 nt lds
  buffer_load_dwordx4 v231, s[12:15], s39 offen offset:3072 nt lds
  s_add_u32 s88, s88, 8192
  s_mov_b32 m0, 114688
  s_add_u32 s39, s89, 0
  buffer_load_dwordx4 v232, s[16:19], s39 offen offset:0 nt lds
  buffer_load_dwordx4 v233, s[16:19], s39 offen offset:1024 nt lds
  buffer_load_dwordx4 v232, s[16:19], s39 offen offset:2048 nt lds
  buffer_load_dwordx4 v233, s[16:19], s39 offen offset:3072 nt lds
  s_mov_b32 m0, 118784
  s_add_u32 s39, s89, 4096
  buffer_load_dwordx4 v232, s[16:19], s39 offen offset:0 nt lds
  buffer_load_dwordx4 v233, s[16:19], s39 offen offset:1024 nt lds
  buffer_load_dwordx4 v232, s[16:19], s39 offen offset:2048 nt lds
  buffer_load_dwordx4 v233, s[16:19], s39 offen offset:3072 nt lds
  s_add_u32 s89, s89, 8192
  ds_read_b128 a[192:195], v240 offset:57344
  ds_read_b128 a[196:199], v241 offset:57344
  v_exp_f32 v135, v135
  ds_read_b128 a[200:203], v242 offset:57344
  ds_read_b128 a[204:207], v243 offset:57344
  v_add_f32 v238, v133, v238
  v_add_f32 v238, v134, v238
  v_cvt_pk_bf16_f32 v160, v128, v129
  ds_read_b128 a[208:211], v240 offset:61440
  ds_read_b128 a[212:215], v241 offset:61440
  v_exp_f32 v136, v136
  ds_read_b128 a[216:219], v242 offset:61440
  ds_read_b128 a[220:223], v243 offset:61440
  v_add_f32 v238, v135, v238
  v_cvt_pk_bf16_f32 v161, v130, v131
  ds_read_b64_tr_b16 a[224:225], v244 offset:49152
  ds_read_b64_tr_b16 a[226:227], v244 offset:53248
  ds_read_b64_tr_b16 a[228:229], v245 offset:49152
  ds_read_b64_tr_b16 a[230:231], v245 offset:53248
  v_exp_f32 v137, v137
  ds_read_b64_tr_b16 a[232:233], v246 offset:49152
  ds_read_b64_tr_b16 a[234:235], v246 offset:53248
  ds_read_b64_tr_b16 a[236:237], v247 offset:49152
  ds_read_b64_tr_b16 a[238:239], v247 offset:53248
  v_add_f32 v239, v136, v239
  v_cvt_pk_bf16_f32 v162, v132, v133
  ds_read_b64_tr_b16 a[240:241], v248 offset:49152
  ds_read_b64_tr_b16 a[242:243], v248 offset:53248
  ds_read_b64_tr_b16 a[244:245], v249 offset:49152
  ds_read_b64_tr_b16 a[246:247], v249 offset:53248
  v_exp_f32 v138, v138
  ds_read_b64_tr_b16 a[248:249], v250 offset:49152
  ds_read_b64_tr_b16 a[250:251], v250 offset:53248
  ds_read_b64_tr_b16 a[252:253], v251 offset:49152
  ds_read_b64_tr_b16 a[254:255], v251 offset:53248
  v_add_f32 v239, v137, v239
  v_cvt_pk_bf16_f32 v163, v134, v135
  v_exp_f32 v139, v139
  v_add_f32 v239, v138, v239
  v_cvt_pk_bf16_f32 v164, v136, v137
  v_exp_f32 v140, v140
  v_add_f32 v239, v139, v239
  v_cvt_pk_bf16_f32 v165, v138, v139
  v_exp_f32 v141, v141
  v_add_f32 v239, v140, v239
  v_exp_f32 v142, v142
  v_add_f32 v239, v141, v239
  v_cvt_pk_bf16_f32 v166, v140, v141
  v_exp_f32 v143, v143
  v_add_f32 v239, v142, v239
  v_add_f32 v239, v143, v239
  v_cvt_pk_bf16_f32 v167, v142, v143
  s_mov_b32 s37, 0
.p2align 4
L_attn_LW:
  s_waitcnt lgkmcnt(15)
  v_mfma_f32_16x16x32_bf16 v[128:131], a[192:195], a[128:131], 0
  v_mfma_f32_16x16x32_bf16 v[136:139], a[192:195], a[144:147], 0
  v_mfma_f32_16x16x32_bf16 v[128:131], a[196:199], a[132:135], v[128:131]
  v_mfma_f32_16x16x32_bf16 v[136:139], a[196:199], a[148:151], v[136:139]
  v_mfma_f32_16x16x32_bf16 v[128:131], a[200:203], a[136:139], v[128:131]
  v_mfma_f32_16x16x32_bf16 v[136:139], a[200:203], a[152:155], v[136:139]
  v_mfma_f32_16x16x32_bf16 v[128:131], a[204:207], a[140:143], v[128:131]
  v_mfma_f32_16x16x32_bf16 v[136:139], a[204:207], a[156:159], v[136:139]
  v_mfma_f32_16x16x32_bf16 v[132:135], a[208:211], a[128:131], 0
  v_mfma_f32_16x16x32_bf16 v[140:143], a[208:211], a[144:147], 0
  v_mfma_f32_16x16x32_bf16 v[132:135], a[212:215], a[132:135], v[132:135]
  v_mfma_f32_16x16x32_bf16 v[140:143], a[212:215], a[148:151], v[140:143]
  v_mfma_f32_16x16x32_bf16 v[132:135], a[216:219], a[136:139], v[132:135]
  v_mfma_f32_16x16x32_bf16 v[140:143], a[216:219], a[152:155], v[140:143]
  v_mfma_f32_16x16x32_bf16 v[132:135], a[220:223], a[140:143], v[132:135]
  v_mfma_f32_16x16x32_bf16 v[140:143], a[220:223], a[156:159], v[140:143]
  s_waitcnt lgkmcnt(0)
  v_mfma_f32_16x16x32_bf16 v[0:3], a[224:227], v[160:163], v[0:3]
  v_mfma_f32_16x16x32_bf16 v[32:35], a[224:227], v[164:167], v[32:35]
  v_mfma_f32_16x16x32_bf16 v[4:7], a[228:231], v[160:163], v[4:7]
  v_exp_f32 v128, v128
  v_mfma_f32_16x16x32_bf16 v[36:39], a[228:231], v[164:167], v[36:39]
  v_mfma_f32_16x16x32_bf16 v[8:11], a[232:235], v[160:163], v[8:11]
  v_exp_f32 v129, v129
  v_mfma_f32_16x16x32_bf16 v[40:43], a[232:235], v[164:167], v[40:43]
  v_add_f32 v238, v128, v238
  v_mfma_f32_16x16x32_bf16 v[12:15], a[236:239], v[160:163], v[12:15]
  v_exp_f32 v130, v130
  v_mfma_f32_16x16x32_bf16 v[44:47], a[236:239], v[164:167], v[44:47]
  v_add_f32 v238, v129, v238
  v_mfma_f32_16x16x32_bf16 v[16:19], a[240:243], v[160:163], v[16:19]
  v_exp_f32 v131, v131
  v_mfma_f32_16x16x32_bf16 v[48:51], a[240:243], v[164:167], v[48:51]
  v_add_f32 v238, v130, v238
  v_mfma_f32_16x16x32_bf16 v[20:23], a[244:247], v[160:163], v[20:23]
  v_exp_f32 v132, v132
  v_mfma_f32_16x16x32_bf16 v[52:55], a[244:247], v[164:167], v[52:55]
  v_add_f32 v238, v131, v238
  v_mfma_f32_16x16x32_bf16 v[24:27], a[248:251], v[160:163], v[24:27]
  v_exp_f32 v133, v133
  v_mfma_f32_16x16x32_bf16 v[56:59], a[248:251], v[164:167], v[56:59]
  v_add_f32 v238, v132, v238
  v_mfma_f32_16x16x32_bf16 v[28:31], a[252:255], v[160:163], v[28:31]
  v_exp_f32 v134, v134
  v_mfma_f32_16x16x32_bf16 v[60:63], a[252:255], v[164:167], v[60:63]
  s_waitcnt vmcnt(32)
  s_barrier
  s_mov_b32 m0, 155648
  s_add_u32 s39, s88, 0
  buffer_load_dwordx4 v228, s[12:15], s39 offen offset:0 nt lds
  buffer_load_dwordx4 v229, s[12:15], s39 offen offset:1024 nt lds
  buffer_load_dwordx4 v230, s[12:15], s39 offen offset:2048 nt lds
  buffer_load_dwordx4 v231, s[12:15], s39 offen offset:3072 nt lds
  s_mov_b32 m0, 159744
  s_add_u32 s39, s88, 4096
  buffer_load_dwordx4 v228, s[12:15], s39 offen offset:0 nt lds
  buffer_load_dwordx4 v229, s[12:15], s39 offen offset:1024 nt lds
  buffer_load_dwordx4 v230, s[12:15], s39 offen offset:2048 nt lds
  buffer_load_dwordx4 v231, s[12:15], s39 offen offset:3072 nt lds
  s_add_u32 s88, s88, 8192
  s_mov_b32 m0, 147456
  s_add_u32 s39, s89, 0
  buffer_load_dwordx4 v232, s[16:19], s39 offen offset:0 nt lds
  buffer_load_dwordx4 v233, s[16:19], s39 offen offset:1024 nt lds
  buffer_load_dwordx4 v232, s[16:19], s39 offen offset:2048 nt lds
  buffer_load_dwordx4 v233, s[16:19], s39 offen offset:3072 nt lds
  s_mov_b32 m0, 151552
  s_add_u32 s39, s89, 4096
  buffer_load_dwordx4 v232, s[16:19], s39 offen offset:0 nt lds
  buffer_load_dwordx4 v233, s[16:19], s39 offen offset:1024 nt lds
  buffer_load_dwordx4 v232, s[16:19], s39 offen offset:2048 nt lds
  buffer_load_dwordx4 v233, s[16:19], s39 offen offset:3072 nt lds
  s_add_u32 s89, s89, 8192
  ds_read_b128 a[192:195], v240 offset:24576
  ds_read_b128 a[196:199], v241 offset:24576
  v_exp_f32 v135, v135
  ds_read_b128 a[200:203], v242 offset:24576
  ds_read_b128 a[204:207], v243 offset:24576
  v_add_f32 v238, v133, v238
  v_add_f32 v238, v134, v238
  v_cvt_pk_bf16_f32 v160, v128, v129
  ds_read_b128 a[208:211], v240 offset:28672
  ds_read_b128 a[212:215], v241 offset:28672
  v_exp_f32 v136, v136
  ds_read_b128 a[216:219], v242 offset:28672
  ds_read_b128 a[220:223], v243 offset:28672
  v_add_f32 v238, v135, v238
  v_cvt_pk_bf16_f32 v161, v130, v131
  ds_read_b64_tr_b16 a[224:225], v244 offset:0
  ds_read_b64_tr_b16 a[226:227], v244 offset:4096
  ds_read_b64_tr_b16 a[228:229], v245 offset:0
  ds_read_b64_tr_b16 a[230:231], v245 offset:4096
  v_exp_f32 v137, v137
  ds_read_b64_tr_b16 a[232:233], v246 offset:0
  ds_read_b64_tr_b16 a[234:235], v246 offset:4096
  ds_read_b64_tr_b16 a[236:237], v247 offset:0
  ds_read_b64_tr_b16 a[238:239], v247 offset:4096
  v_add_f32 v239, v136, v239
  v_cvt_pk_bf16_f32 v162, v132, v133
  ds_read_b64_tr_b16 a[240:241], v248 offset:0
  ds_read_b64_tr_b16 a[242:243], v248 offset:4096
  ds_read_b64_tr_b16 a[244:245], v249 offset:0
  ds_read_b64_tr_b16 a[246:247], v249 offset:4096
  v_exp_f32 v138, v138
  ds_read_b64_tr_b16 a[248:249], v250 offset:0
  ds_read_b64_tr_b16 a[250:251], v250 offset:4096
  ds_read_b64_tr_b16 a[252:253], v251 offset:0
  ds_read_b64_tr_b16 a[254:255], v251 offset:4096
  v_add_f32 v239, v137, v239
  v_cvt_pk_bf16_f32 v163, v134, v135
  v_exp_f32 v139, v139
  v_add_f32 v239, v138, v239
  v_cvt_pk_bf16_f32 v164, v136, v137
  v_exp_f32 v140, v140
  v_add_f32 v239, v139, v239
  v_cvt_pk_bf16_f32 v165, v138, v139
  v_exp_f32 v141, v141
  v_add_f32 v239, v140, v239
  v_exp_f32 v142, v142
  v_add_f32 v239, v141, v239
  v_cvt_pk_bf16_f32 v166, v140, v141
  v_exp_f32 v143, v143
  v_add_f32 v239, v142, v239
  v_add_f32 v239, v143, v239
  v_cvt_pk_bf16_f32 v167, v142, v143
  s_waitcnt lgkmcnt(15)
  v_mfma_f32_16x16x32_bf16 v[128:131], a[192:195], a[128:131], 0
  v_mfma_f32_16x16x32_bf16 v[136:139], a[192:195], a[144:147], 0
  v_mfma_f32_16x16x32_bf16 v[128:131], a[196:199], a[132:135], v[128:131]
  v_mfma_f32_16x16x32_bf16 v[136:139], a[196:199], a[148:151], v[136:139]
  v_mfma_f32_16x16x32_bf16 v[128:131], a[200:203], a[136:139], v[128:131]
  v_mfma_f32_16x16x32_bf16 v[136:139], a[200:203], a[152:155], v[136:139]
  v_mfma_f32_16x16x32_bf16 v[128:131], a[204:207], a[140:143], v[128:131]
  v_mfma_f32_16x16x32_bf16 v[136:139], a[204:207], a[156:159], v[136:139]
  v_mfma_f32_16x16x32_bf16 v[132:135], a[208:211], a[128:131], 0
  v_mfma_f32_16x16x32_bf16 v[140:143], a[208:211], a[144:147], 0
  v_mfma_f32_16x16x32_bf16 v[132:135], a[212:215], a[132:135], v[132:135]
  v_mfma_f32_16x16x32_bf16 v[140:143], a[212:215], a[148:151], v[140:143]
  v_mfma_f32_16x16x32_bf16 v[132:135], a[216:219], a[136:139], v[132:135]
  v_mfma_f32_16x16x32_bf16 v[140:143], a[216:219], a[152:155], v[140:143]
  v_mfma_f32_16x16x32_bf16 v[132:135], a[220:223], a[140:143], v[132:135]
  v_mfma_f32_16x16x32_bf16 v[140:143], a[220:223], a[156:159], v[140:143]
  s_waitcnt lgkmcnt(0)
  v_mfma_f32_16x16x32_bf16 v[0:3], a[224:227], v[160:163], v[0:3]
  v_mfma_f32_16x16x32_bf16 v[32:35], a[224:227], v[164:167], v[32:35]
  v_mfma_f32_16x16x32_bf16 v[4:7], a[228:231], v[160:163], v[4:7]
  v_exp_f32 v128, v128
  v_mfma_f32_16x16x32_bf16 v[36:39], a[228:231], v[164:167], v[36:39]
  v_mfma_f32_16x16x32_bf16 v[8:11], a[232:235], v[160:163], v[8:11]
  v_exp_f32 v129, v129
  v_mfma_f32_16x16x32_bf16 v[40:43], a[232:235], v[164:167], v[40:43]
  v_add_f32 v238, v128, v238
  v_mfma_f32_16x16x32_bf16 v[12:15], a[236:239], v[160:163], v[12:15]
  v_exp_f32 v130, v130
  v_mfma_f32_16x16x32_bf16 v[44:47], a[236:239], v[164:167], v[44:47]
  v_add_f32 v238, v129, v238
  v_mfma_f32_16x16x32_bf16 v[16:19], a[240:243], v[160:163], v[16:19]
  v_exp_f32 v131, v131
  v_mfma_f32_16x16x32_bf16 v[48:51], a[240:243], v[164:167], v[48:51]
  v_add_f32 v238, v130, v238
  v_mfma_f32_16x16x32_bf16 v[20:23], a[244:247], v[160:163], v[20:23]
  v_exp_f32 v132, v132
  v_mfma_f32_16x16x32_bf16 v[52:55], a[244:247], v[164:167], v[52:55]
  v_add_f32 v238, v131, v238
  v_mfma_f32_16x16x32_bf16 v[24:27], a[248:251], v[160:163], v[24:27]
  v_exp_f32 v133, v133
  v_mfma_f32_16x16x32_bf16 v[56:59], a[248:251], v[164:167], v[56:59]
  v_add_f32 v238, v132, v238
  v_mfma_f32_16x16x32_bf16 v[28:31], a[252:255], v[160:163], v[28:31]
  v_exp_f32 v134, v134
  v_mfma_f32_16x16x32_bf16 v[60:63], a[252:255], v[164:167], v[60:63]
  s_waitcnt vmcnt(32)
  s_barrier
  s_mov_b32 m0, 122880
  s_add_u32 s39, s88, 0
  buffer_load_dwordx4 v228, s[12:15], s39 offen offset:0 nt lds
  buffer_load_dwordx4 v229, s[12:15], s39 offen offset:1024 nt lds
  buffer_load_dwordx4 v230, s[12:15], s39 offen offset:2048 nt lds
  buffer_load_dwordx4 v231, s[12:15], s39 offen offset:3072 nt lds
  s_mov_b32 m0, 126976
  s_add_u32 s39, s88, 4096
  buffer_load_dwordx4 v228, s[12:15], s39 offen offset:0 nt lds
  buffer_load_dwordx4 v229, s[12:15], s39 offen offset:1024 nt lds
  buffer_load_dwordx4 v230, s[12:15], s39 offen offset:2048 nt lds
  buffer_load_dwordx4 v231, s[12:15], s39 offen offset:3072 nt lds
  s_add_u32 s88, s88, 8192
  s_mov_b32 m0, 98304
  s_add_u32 s39, s89, 0
  buffer_load_dwordx4 v232, s[16:19], s39 offen offset:0 nt lds
  buffer_load_dwordx4 v233, s[16:19], s39 offen offset:1024 nt lds
  buffer_load_dwordx4 v232, s[16:19], s39 offen offset:2048 nt lds
  buffer_load_dwordx4 v233, s[16:19], s39 offen offset:3072 nt lds
  s_mov_b32 m0, 102400
  s_add_u32 s39, s89, 4096
  buffer_load_dwordx4 v232, s[16:19], s39 offen offset:0 nt lds
  buffer_load_dwordx4 v233, s[16:19], s39 offen offset:1024 nt lds
  buffer_load_dwordx4 v232, s[16:19], s39 offen offset:2048 nt lds
  buffer_load_dwordx4 v233, s[16:19], s39 offen offset:3072 nt lds
  s_add_u32 s89, s89, 8192
  ds_read_b128 a[192:195], v240 offset:32768
  ds_read_b128 a[196:199], v241 offset:32768
  v_exp_f32 v135, v135
  ds_read_b128 a[200:203], v242 offset:32768
  ds_read_b128 a[204:207], v243 offset:32768
  v_add_f32 v238, v133, v238
  v_add_f32 v238, v134, v238
  v_cvt_pk_bf16_f32 v160, v128, v129
  ds_read_b128 a[208:211], v240 offset:36864
  ds_read_b128 a[212:215], v241 offset:36864
  v_exp_f32 v136, v136
  ds_read_b128 a[216:219], v242 offset:36864
  ds_read_b128 a[220:223], v243 offset:36864
  v_add_f32 v238, v135, v238
  v_cvt_pk_bf16_f32 v161, v130, v131
  ds_read_b64_tr_b16 a[224:225], v244 offset:8192
  ds_read_b64_tr_b16 a[226:227], v244 offset:12288
  ds_read_b64_tr_b16 a[228:229], v245 offset:8192
  ds_read_b64_tr_b16 a[230:231], v245 offset:12288
  v_exp_f32 v137, v137
  ds_read_b64_tr_b16 a[232:233], v246 offset:8192
  ds_read_b64_tr_b16 a[234:235], v246 offset:12288
  ds_read_b64_tr_b16 a[236:237], v247 offset:8192
  ds_read_b64_tr_b16 a[238:239], v247 offset:12288
  v_add_f32 v239, v136, v239
  v_cvt_pk_bf16_f32 v162, v132, v133
  ds_read_b64_tr_b16 a[240:241], v248 offset:8192
  ds_read_b64_tr_b16 a[242:243], v248 offset:12288
  ds_read_b64_tr_b16 a[244:245], v249 offset:8192
  ds_read_b64_tr_b16 a[246:247], v249 offset:12288
  v_exp_f32 v138, v138
  ds_read_b64_tr_b16 a[248:249], v250 offset:8192
  ds_read_b64_tr_b16 a[250:251], v250 offset:12288
  ds_read_b64_tr_b16 a[252:253], v251 offset:8192
  ds_read_b64_tr_b16 a[254:255], v251 offset:12288
  v_add_f32 v239, v137, v239
  v_cvt_pk_bf16_f32 v163, v134, v135
  v_exp_f32 v139, v139
  v_add_f32 v239, v138, v239
  v_cvt_pk_bf16_f32 v164, v136, v137
  v_exp_f32 v140, v140
  v_add_f32 v239, v139, v239
  v_cvt_pk_bf16_f32 v165, v138, v139
  v_exp_f32 v141, v141
  v_add_f32 v239, v140, v239
  v_exp_f32 v142, v142
  v_add_f32 v239, v141, v239
  v_cvt_pk_bf16_f32 v166, v140, v141
  v_exp_f32 v143, v143
  v_add_f32 v239, v142, v239
  v_add_f32 v239, v143, v239
  v_cvt_pk_bf16_f32 v167, v142, v143
  s_waitcnt lgkmcnt(15)
  v_mfma_f32_16x16x32_bf16 v[128:131], a[192:195], a[128:131], 0
  v_mfma_f32_16x16x32_bf16 v[136:139], a[192:195], a[144:147], 0
  v_mfma_f32_16x16x32_bf16 v[128:131], a[196:199], a[132:135], v[128:131]
  v_mfma_f32_16x16x32_bf16 v[136:139], a[196:199], a[148:151], v[136:139]
  v_mfma_f32_16x16x32_bf16 v[128:131], a[200:203], a[136:139], v[128:131]
  v_mfma_f32_16x16x32_bf16 v[136:139], a[200:203], a[152:155], v[136:139]
  v_mfma_f32_16x16x32_bf16 v[128:131], a[204:207], a[140:143], v[128:131]
  v_mfma_f32_16x16x32_bf16 v[136:139], a[204:207], a[156:159], v[136:139]
  v_mfma_f32_16x16x32_bf16 v[132:135], a[208:211], a[128:131], 0
  v_mfma_f32_16x16x32_bf16 v[140:143], a[208:211], a[144:147], 0
  v_mfma_f32_16x16x32_bf16 v[132:135], a[212:215], a[132:135], v[132:135]
  v_mfma_f32_16x16x32_bf16 v[140:143], a[212:215], a[148:151], v[140:143]
  v_mfma_f32_16x16x32_bf16 v[132:135], a[216:219], a[136:139], v[132:135]
  v_mfma_f32_16x16x32_bf16 v[140:143], a[216:219], a[152:155], v[140:143]
  v_mfma_f32_16x16x32_bf16 v[132:135], a[220:223], a[140:143], v[132:135]
  v_mfma_f32_16x16x32_bf16 v[140:143], a[220:223], a[156:159], v[140:143]
  s_waitcnt lgkmcnt(0)
  v_mfma_f32_16x16x32_bf16 v[0:3], a[224:227], v[160:163], v[0:3]
  v_mfma_f32_16x16x32_bf16 v[32:35], a[224:227], v[164:167], v[32:35]
  v_mfma_f32_16x16x32_bf16 v[4:7], a[228:231], v[160:163], v[4:7]
  v_exp_f32 v128, v128
  v_mfma_f32_16x16x32_bf16 v[36:39], a[228:231], v[164:167], v[36:39]
  v_mfma_f32_16x16x32_bf16 v[8:11], a[232:235], v[160:163], v[8:11]
  v_exp_f32 v129, v129
  v_mfma_f32_16x16x32_bf16 v[40:43], a[232:235], v[164:167], v[40:43]
  v_add_f32 v238, v128, v238
  v_mfma_f32_16x16x32_bf16 v[12:15], a[236:239], v[160:163], v[12:15]
  v_exp_f32 v130, v130
  v_mfma_f32_16x16x32_bf16 v[44:47], a[236:239], v[164:167], v[44:47]
  v_add_f32 v238, v129, v238
  v_mfma_f32_16x16x32_bf16 v[16:19], a[240:243], v[160:163], v[16:19]
  v_exp_f32 v131, v131
  v_mfma_f32_16x16x32_bf16 v[48:51], a[240:243], v[164:167], v[48:51]
  v_add_f32 v238, v130, v238
  v_mfma_f32_16x16x32_bf16 v[20:23], a[244:247], v[160:163], v[20:23]
  v_exp_f32 v132, v132
  v_mfma_f32_16x16x32_bf16 v[52:55], a[244:247], v[164:167], v[52:55]
  v_add_f32 v238, v131, v238
  v_mfma_f32_16x16x32_bf16 v[24:27], a[248:251], v[160:163], v[24:27]
  v_exp_f32 v133, v133
  v_mfma_f32_16x16x32_bf16 v[56:59], a[248:251], v[164:167], v[56:59]
  v_add_f32 v238, v132, v238
  v_mfma_f32_16x16x32_bf16 v[28:31], a[252:255], v[160:163], v[28:31]
  v_exp_f32 v134, v134
  v_mfma_f32_16x16x32_bf16 v[60:63], a[252:255], v[164:167], v[60:63]
  s_waitcnt vmcnt(32)
  s_barrier
  s_mov_b32 m0, 131072
  s_add_u32 s39, s88, 0
  buffer_load_dwordx4 v228, s[12:15], s39 offen offset:0 nt lds
  buffer_load_dwordx4 v229, s[12:15], s39 offen offset:1024 nt lds
  buffer_load_dwordx4 v230, s[12:15], s39 offen offset:2048 nt lds
  buffer_load_dwordx4 v231, s[12:15], s39 offen offset:3072 nt lds
  s_mov_b32 m0, 135168
  s_add_u32 s39, s88, 4096
  buffer_load_dwordx4 v228, s[12:15], s39 offen offset:0 nt lds
  buffer_load_dwordx4 v229, s[12:15], s39 offen offset:1024 nt lds
  buffer_load_dwordx4 v230, s[12:15], s39 offen offset:2048 nt lds
  buffer_load_dwordx4 v231, s[12:15], s39 offen offset:3072 nt lds
  s_add_u32 s88, s88, 8192
  s_mov_b32 m0, 106496
  s_add_u32 s39, s89, 0
  buffer_load_dwordx4 v232, s[16:19], s39 offen offset:0 nt lds
  buffer_load_dwordx4 v233, s[16:19], s39 offen offset:1024 nt lds
  buffer_load_dwordx4 v232, s[16:19], s39 offen offset:2048 nt lds
  buffer_load_dwordx4 v233, s[16:19], s39 offen offset:3072 nt lds
  s_mov_b32 m0, 110592
  s_add_u32 s39, s89, 4096
  buffer_load_dwordx4 v232, s[16:19], s39 offen offset:0 nt lds
  buffer_load_dwordx4 v233, s[16:19], s39 offen offset:1024 nt lds
  buffer_load_dwordx4 v232, s[16:19], s39 offen offset:2048 nt lds
  buffer_load_dwordx4 v233, s[16:19], s39 offen offset:3072 nt lds
  s_add_u32 s89, s89, 8192
  ds_read_b128 a[192:195], v240 offset:40960
  ds_read_b128 a[196:199], v241 offset:40960
  v_exp_f32 v135, v135
  ds_read_b128 a[200:203], v242 offset:40960
  ds_read_b128 a[204:207], v243 offset:40960
  v_add_f32 v238, v133, v238
  v_add_f32 v238, v134, v238
  v_cvt_pk_bf16_f32 v160, v128, v129
  ds_read_b128 a[208:211], v240 offset:45056
  ds_read_b128 a[212:215], v241 offset:45056
  v_exp_f32 v136, v136
  ds_read_b128 a[216:219], v242 offset:45056
  ds_read_b128 a[220:223], v243 offset:45056
  v_add_f32 v238, v135, v238
  v_cvt_pk_bf16_f32 v161, v130, v131
  ds_read_b64_tr_b16 a[224:225], v244 offset:16384
  ds_read_b64_tr_b16 a[226:227], v244 offset:20480
  ds_read_b64_tr_b16 a[228:229], v245 offset:16384
  ds_read_b64_tr_b16 a[230:231], v245 offset:20480
  v_exp_f32 v137, v137
  ds_read_b64_tr_b16 a[232:233], v246 offset:16384
  ds_read_b64_tr_b16 a[234:235], v246 offset:20480
  ds_read_b64_tr_b16 a[236:237], v247 offset:16384
  ds_read_b64_tr_b16 a[238:239], v247 offset:20480
  v_add_f32 v239, v136, v239
  v_cvt_pk_bf16_f32 v162, v132, v133
  ds_read_b64_tr_b16 a[240:241], v248 offset:16384
  ds_read_b64_tr_b16 a[242:243], v248 offset:20480
  ds_read_b64_tr_b16 a[244:245], v249 offset:16384
  ds_read_b64_tr_b16 a[246:247], v249 offset:20480
  v_exp_f32 v138, v138
  ds_read_b64_tr_b16 a[248:249], v250 offset:16384
  ds_read_b64_tr_b16 a[250:251], v250 offset:20480
  ds_read_b64_tr_b16 a[252:253], v251 offset:16384
  ds_read_b64_tr_b16 a[254:255], v251 offset:20480
  v_add_f32 v239, v137, v239
  v_cvt_pk_bf16_f32 v163, v134, v135
  v_exp_f32 v139, v139
  v_add_f32 v239, v138, v239
  v_cvt_pk_bf16_f32 v164, v136, v137
  v_exp_f32 v140, v140
  v_add_f32 v239, v139, v239
  v_cvt_pk_bf16_f32 v165, v138, v139
  v_exp_f32 v141, v141
  v_add_f32 v239, v140, v239
  v_exp_f32 v142, v142
  v_add_f32 v239, v141, v239
  v_cvt_pk_bf16_f32 v166, v140, v141
  v_exp_f32 v143, v143
  v_add_f32 v239, v142, v239
  v_add_f32 v239, v143, v239
  v_cvt_pk_bf16_f32 v167, v142, v143
  s_waitcnt lgkmcnt(15)
  v_mfma_f32_16x16x32_bf16 v[128:131], a[192:195], a[128:131], 0
  v_mfma_f32_16x16x32_bf16 v[136:139], a[192:195], a[144:147], 0
  v_mfma_f32_16x16x32_bf16 v[128:131], a[196:199], a[132:135], v[128:131]
  v_mfma_f32_16x16x32_bf16 v[136:139], a[196:199], a[148:151], v[136:139]
  v_mfma_f32_16x16x32_bf16 v[128:131], a[200:203], a[136:139], v[128:131]
  v_mfma_f32_16x16x32_bf16 v[136:139], a[200:203], a[152:155], v[136:139]
  v_mfma_f32_16x16x32_bf16 v[128:131], a[204:207], a[140:143], v[128:131]
  v_mfma_f32_16x16x32_bf16 v[136:139], a[204:207], a[156:159], v[136:139]
  v_mfma_f32_16x16x32_bf16 v[132:135], a[208:211], a[128:131], 0
  v_mfma_f32_16x16x32_bf16 v[140:143], a[208:211], a[144:147], 0
  v_mfma_f32_16x16x32_bf16 v[132:135], a[212:215], a[132:135], v[132:135]
  v_mfma_f32_16x16x32_bf16 v[140:143], a[212:215], a[148:151], v[140:143]
  v_mfma_f32_16x16x32_bf16 v[132:135], a[216:219], a[136:139], v[132:135]
  v_mfma_f32_16x16x32_bf16 v[140:143], a[216:219], a[152:155], v[140:143]
  v_mfma_f32_16x16x32_bf16 v[132:135], a[220:223], a[140:143], v[132:135]
  v_mfma_f32_16x16x32_bf16 v[140:143], a[220:223], a[156:159], v[140:143]
  s_waitcnt lgkmcnt(0)
  v_mfma_f32_16x16x32_bf16 v[0:3], a[224:227], v[160:163], v[0:3]
  v_mfma_f32_16x16x32_bf16 v[32:35], a[224:227], v[164:167], v[32:35]
  v_mfma_f32_16x16x32_bf16 v[4:7], a[228:231], v[160:163], v[4:7]
  v_exp_f32 v128, v128
  v_mfma_f32_16x16x32_bf16 v[36:39], a[228:231], v[164:167], v[36:39]
  v_mfma_f32_16x16x32_bf16 v[8:11], a[232:235], v[160:163], v[8:11]
  v_exp_f32 v129, v129
  v_mfma_f32_16x16x32_bf16 v[40:43], a[232:235], v[164:167], v[40:43]
  v_add_f32 v238, v128, v238
  v_mfma_f32_16x16x32_bf16 v[12:15], a[236:239], v[160:163], v[12:15]
  v_exp_f32 v130, v130
  v_mfma_f32_16x16x32_bf16 v[44:47], a[236:239], v[164:167], v[44:47]
  v_add_f32 v238, v129, v238
  v_mfma_f32_16x16x32_bf16 v[16:19], a[240:243], v[160:163], v[16:19]
  v_exp_f32 v131, v131
  v_mfma_f32_16x16x32_bf16 v[48:51], a[240:243], v[164:167], v[48:51]
  v_add_f32 v238, v130, v238
  v_mfma_f32_16x16x32_bf16 v[20:23], a[244:247], v[160:163], v[20:23]
  v_exp_f32 v132, v132
  v_mfma_f32_16x16x32_bf16 v[52:55], a[244:247], v[164:167], v[52:55]
  v_add_f32 v238, v131, v238
  v_mfma_f32_16x16x32_bf16 v[24:27], a[248:251], v[160:163], v[24:27]
  v_exp_f32 v133, v133
  v_mfma_f32_16x16x32_bf16 v[56:59], a[248:251], v[164:167], v[56:59]
  v_add_f32 v238, v132, v238
  v_mfma_f32_16x16x32_bf16 v[28:31], a[252:255], v[160:163], v[28:31]
  v_exp_f32 v134, v134
  v_mfma_f32_16x16x32_bf16 v[60:63], a[252:255], v[164:167], v[60:63]
  s_waitcnt vmcnt(32)
  s_barrier
  s_cmp_eq_u32 s37, 6
  s_cbranch_scc1 L_nok4
  s_mov_b32 m0, 139264
  s_add_u32 s39, s88, 0
  buffer_load_dwordx4 v228, s[12:15], s39 offen offset:0 nt lds
  buffer_load_dwordx4 v229, s[12:15], s39 offen offset:1024 nt lds
  buffer_load_dwordx4 v230, s[12:15], s39 offen offset:2048 nt lds
  buffer_load_dwordx4 v231, s[12:15], s39 offen offset:3072 nt lds
  s_mov_b32 m0, 143360
  s_add_u32 s39, s88, 4096
  buffer_load_dwordx4 v228, s[12:15], s39 offen offset:0 nt lds
  buffer_load_dwordx4 v229, s[12:15], s39 offen offset:1024 nt lds
  buffer_load_dwordx4 v230, s[12:15], s39 offen offset:2048 nt lds
  buffer_load_dwordx4 v231, s[12:15], s39 offen offset:3072 nt lds
  s_add_u32 s88, s88, 8192
L_nok4:
  s_mov_b32 m0, 114688
  s_add_u32 s39, s89, 0
  buffer_load_dwordx4 v232, s[16:19], s39 offen offset:0 nt lds
  buffer_load_dwordx4 v233, s[16:19], s39 offen offset:1024 nt lds
  buffer_load_dwordx4 v232, s[16:19], s39 offen offset:2048 nt lds
  buffer_load_dwordx4 v233, s[16:19], s39 offen offset:3072 nt lds
  s_mov_b32 m0, 118784
  s_add_u32 s39, s89, 4096
  buffer_load_dwordx4 v232, s[16:19], s39 offen offset:0 nt lds
  buffer_load_dwordx4 v233, s[16:19], s39 offen offset:1024 nt lds
  buffer_load_dwordx4 v232, s[16:19], s39 offen offset:2048 nt lds
  buffer_load_dwordx4 v233, s[16:19], s39 offen offset:3072 nt lds
  s_add_u32 s89, s89, 8192
  ds_read_b128 a[192:195], v240 offset:57344
  ds_read_b128 a[196:199], v241 offset:57344
  v_exp_f32 v135, v135
  ds_read_b128 a[200:203], v242 offset:57344
  ds_read_b128 a[204:207], v243 offset:57344
  v_add_f32 v238, v133, v238
  v_add_f32 v238, v134, v238
  v_cvt_pk_bf16_f32 v160, v128, v129
  ds_read_b128 a[208:211], v240 offset:61440
  ds_read_b128 a[212:215], v241 offset:61440
  v_exp_f32 v136, v136
  ds_read_b128 a[216:219], v242 offset:61440
  ds_read_b128 a[220:223], v243 offset:61440
  v_add_f32 v238, v135, v238
  v_cvt_pk_bf16_f32 v161, v130, v131
  ds_read_b64_tr_b16 a[224:225], v244 offset:49152
  ds_read_b64_tr_b16 a[226:227], v244 offset:53248
  ds_read_b64_tr_b16 a[228:229], v245 offset:49152
  ds_read_b64_tr_b16 a[230:231], v245 offset:53248
  v_exp_f32 v137, v137
  ds_read_b64_tr_b16 a[232:233], v246 offset:49152
  ds_read_b64_tr_b16 a[234:235], v246 offset:53248
  ds_read_b64_tr_b16 a[236:237], v247 offset:49152
  ds_read_b64_tr_b16 a[238:239], v247 offset:53248
  v_add_f32 v239, v136, v239
  v_cvt_pk_bf16_f32 v162, v132, v133
  ds_read_b64_tr_b16 a[240:241], v248 offset:49152
  ds_read_b64_tr_b16 a[242:243], v248 offset:53248
  ds_read_b64_tr_b16 a[244:245], v249 offset:49152
  ds_read_b64_tr_b16 a[246:247], v249 offset:53248
  v_exp_f32 v138, v138
  ds_read_b64_tr_b16 a[248:249], v250 offset:49152
  ds_read_b64_tr_b16 a[250:251], v250 offset:53248
  ds_read_b64_tr_b16 a[252:253], v251 offset:49152
  ds_read_b64_tr_b16 a[254:255], v251 offset:53248
  v_add_f32 v239, v137, v239
  v_cvt_pk_bf16_f32 v163, v134, v135
  v_exp_f32 v139, v139
  v_add_f32 v239, v138, v239
  v_cvt_pk_bf16_f32 v164, v136, v137
  v_exp_f32 v140, v140
  v_add_f32 v239, v139, v239
  v_cvt_pk_bf16_f32 v165, v138, v139
  v_exp_f32 v141, v141
  v_add_f32 v239, v140, v239
  v_exp_f32 v142, v142
  v_add_f32 v239, v141, v239
  v_cvt_pk_bf16_f32 v166, v140, v141
  v_exp_f32 v143, v143
  v_add_f32 v239, v142, v239
  v_add_f32 v239, v143, v239
  v_cvt_pk_bf16_f32 v167, v142, v143
  s_add_u32 s37, s37, 1
  s_cmp_lt_u32 s37, 7
  s_cbranch_scc1 L_attn_LW
  v_mov_b32 v126, 0
  global_load_dwordx2 v[120:121], v126, s[26:27] sc1
  s_waitcnt lgkmcnt(15)
  v_mfma_f32_16x16x32_bf16 v[128:131], a[192:195], a[128:131], 0
  v_mfma_f32_16x16x32_bf16 v[136:139], a[192:195], a[144:147], 0
  v_mfma_f32_16x16x32_bf16 v[128:131], a[196:199], a[132:135], v[128:131]
  v_mfma_f32_16x16x32_bf16 v[136:139], a[196:199], a[148:151], v[136:139]
  v_mfma_f32_16x16x32_bf16 v[128:131], a[200:203], a[136:139], v[128:131]
  v_mfma_f32_16x16x32_bf16 v[136:139], a[200:203], a[152:155], v[136:139]
  v_mfma_f32_16x16x32_bf16 v[128:131], a[204:207], a[140:143], v[128:131]
  v_mfma_f32_16x16x32_bf16 v[136:139], a[204:207], a[156:159], v[136:139]
  v_mfma_f32_16x16x32_bf16 v[132:135], a[208:211], a[128:131], 0
  v_mfma_f32_16x16x32_bf16 v[140:143], a[208:211], a[144:147], 0
  v_mfma_f32_16x16x32_bf16 v[132:135], a[212:215], a[132:135], v[132:135]
  v_mfma_f32_16x16x32_bf16 v[140:143], a[212:215], a[148:151], v[140:143]
  v_mfma_f32_16x16x32_bf16 v[132:135], a[216:219], a[136:139], v[132:135]
  v_mfma_f32_16x16x32_bf16 v[140:143], a[216:219], a[152:155], v[140:143]
  v_mfma_f32_16x16x32_bf16 v[132:135], a[220:223], a[140:143], v[132:135]
  v_mfma_f32_16x16x32_bf16 v[140:143], a[220:223], a[156:159], v[140:143]
  s_waitcnt lgkmcnt(0)
  v_mfma_f32_16x16x32_bf16 v[0:3], a[224:227], v[160:163], v[0:3]
  v_mfma_f32_16x16x32_bf16 v[32:35], a[224:227], v[164:167], v[32:35]
  v_mfma_f32_16x16x32_bf16 v[4:7], a[228:231], v[160:163], v[4:7]
  v_exp_f32 v128, v128
  v_mfma_f32_16x16x32_bf16 v[36:39], a[228:231], v[164:167], v[36:39]
  v_mfma_f32_16x16x32_bf16 v[8:11], a[232:235], v[160:163], v[8:11]
  v_exp_f32 v129, v129
  v_mfma_f32_16x16x32_bf16 v[40:43], a[232:235], v[164:167], v[40:43]
  v_add_f32 v238, v128, v238
  v_mfma_f32_16x16x32_bf16 v[12:15], a[236:239], v[160:163], v[12:15]
  v_exp_f32 v130, v130
  v_mfma_f32_16x16x32_bf16 v[44:47], a[236:239], v[164:167], v[44:47]
  v_add_f32 v238, v129, v238
  v_mfma_f32_16x16x32_bf16 v[16:19], a[240:243], v[160:163], v[16:19]
  v_exp_f32 v131, v131
  v_mfma_f32_16x16x32_bf16 v[48:51], a[240:243], v[164:167], v[48:51]
  v_add_f32 v238, v130, v238
  v_mfma_f32_16x16x32_bf16 v[20:23], a[244:247], v[160:163], v[20:23]
  v_exp_f32 v132, v132
  v_mfma_f32_16x16x32_bf16 v[52:55], a[244:247], v[164:167], v[52:55]
  v_add_f32 v238, v131, v238
  v_mfma_f32_16x16x32_bf16 v[24:27], a[248:251], v[160:163], v[24:27]
  v_exp_f32 v133, v133
  v_mfma_f32_16x16x32_bf16 v[56:59], a[248:251], v[164:167], v[56:59]
  v_add_f32 v238, v132, v238
  v_mfma_f32_16x16x32_bf16 v[28:31], a[252:255], v[160:163], v[28:31]
  v_exp_f32 v134, v134
  v_mfma_f32_16x16x32_bf16 v[60:63], a[252:255], v[164:167], v[60:63]
  s_waitcnt vmcnt(24)
  s_barrier
  s_mov_b32 m0, 139264
  s_add_u32 s39, s90, 0
  buffer_load_dwordx4 v234, s[20:23], s39 offen offset:0 lds
  buffer_load_dwordx4 v235, s[20:23], s39 offen offset:1024 lds
  buffer_load_dwordx4 v236, s[20:23], s39 offen offset:2048 lds
  buffer_load_dwordx4 v237, s[20:23], s39 offen offset:3072 lds
  s_mov_b32 m0, 143360
  s_add_u32 s39, s90, 16384
  buffer_load_dwordx4 v234, s[20:23], s39 offen offset:0 lds
  buffer_load_dwordx4 v235, s[20:23], s39 offen offset:1024 lds
  buffer_load_dwordx4 v236, s[20:23], s39 offen offset:2048 lds
  buffer_load_dwordx4 v237, s[20:23], s39 offen offset:3072 lds
  s_mov_b32 m0, 155648
  s_add_u32 s39, s90, 32768
  buffer_load_dwordx4 v234, s[20:23], s39 offen offset:0 lds
  buffer_load_dwordx4 v235, s[20:23], s39 offen offset:1024 lds
  buffer_load_dwordx4 v236, s[20:23], s39 offen offset:2048 lds
  buffer_load_dwordx4 v237, s[20:23], s39 offen offset:3072 lds
  s_mov_b32 m0, 159744
  s_add_u32 s39, s90, 49152
  buffer_load_dwordx4 v234, s[20:23], s39 offen offset:0 lds
  buffer_load_dwordx4 v235, s[20:23], s39 offen offset:1024 lds
  buffer_load_dwordx4 v236, s[20:23], s39 offen offset:2048 lds
  buffer_load_dwordx4 v237, s[20:23], s39 offen offset:3072 lds
  ds_read_b128 a[192:195], v240 offset:24576
  ds_read_b128 a[196:199], v241 offset:24576
  v_exp_f32 v135, v135
  ds_read_b128 a[200:203], v242 offset:24576
  ds_read_b128 a[204:207], v243 offset:24576
  v_add_f32 v238, v133, v238
  v_add_f32 v238, v134, v238
  v_cvt_pk_bf16_f32 v160, v128, v129
  ds_read_b128 a[208:211], v240 offset:28672
  ds_read_b128 a[212:215], v241 offset:28672
  v_exp_f32 v136, v136
  ds_read_b128 a[216:219], v242 offset:28672
  ds_read_b128 a[220:223], v243 offset:28672
  v_add_f32 v238, v135, v238
  v_cvt_pk_bf16_f32 v161, v130, v131
  ds_read_b64_tr_b16 a[224:225], v244 offset:0
  ds_read_b64_tr_b16 a[226:227], v244 offset:4096
  ds_read_b64_tr_b16 a[228:229], v245 offset:0
  ds_read_b64_tr_b16 a[230:231], v245 offset:4096
  v_exp_f32 v137, v137
  ds_read_b64_tr_b16 a[232:233], v246 offset:0
  ds_read_b64_tr_b16 a[234:235], v246 offset:4096
  ds_read_b64_tr_b16 a[236:237], v247 offset:0
  ds_read_b64_tr_b16 a[238:239], v247 offset:4096
  v_add_f32 v239, v136, v239
  v_cvt_pk_bf16_f32 v162, v132, v133
  ds_read_b64_tr_b16 a[240:241], v248 offset:0
  ds_read_b64_tr_b16 a[242:243], v248 offset:4096
  ds_read_b64_tr_b16 a[244:245], v249 offset:0
  ds_read_b64_tr_b16 a[246:247], v249 offset:4096
  v_exp_f32 v138, v138
  ds_read_b64_tr_b16 a[248:249], v250 offset:0
  ds_read_b64_tr_b16 a[250:251], v250 offset:4096
  ds_read_b64_tr_b16 a[252:253], v251 offset:0
  ds_read_b64_tr_b16 a[254:255], v251 offset:4096
  v_add_f32 v239, v137, v239
  v_cvt_pk_bf16_f32 v163, v134, v135
  v_exp_f32 v139, v139
  v_add_f32 v239, v138, v239
  v_cvt_pk_bf16_f32 v164, v136, v137
  v_exp_f32 v140, v140
  v_add_f32 v239, v139, v239
  v_cvt_pk_bf16_f32 v165, v138, v139
  v_exp_f32 v141, v141
  v_add_f32 v239, v140, v239
  v_exp_f32 v142, v142
  v_add_f32 v239, v141, v239
  v_cvt_pk_bf16_f32 v166, v140, v141
  v_exp_f32 v143, v143
  v_add_f32 v239, v142, v239
  v_add_f32 v239, v143, v239
  v_cvt_pk_bf16_f32 v167, v142, v143
  s_waitcnt lgkmcnt(15)
  v_mfma_f32_16x16x32_bf16 v[128:131], a[192:195], a[128:131], 0
  v_mfma_f32_16x16x32_bf16 v[136:139], a[192:195], a[144:147], 0
  v_mfma_f32_16x16x32_bf16 v[128:131], a[196:199], a[132:135], v[128:131]
  v_mfma_f32_16x16x32_bf16 v[136:139], a[196:199], a[148:151], v[136:139]
  v_mfma_f32_16x16x32_bf16 v[128:131], a[200:203], a[136:139], v[128:131]
  v_mfma_f32_16x16x32_bf16 v[136:139], a[200:203], a[152:155], v[136:139]
  v_mfma_f32_16x16x32_bf16 v[128:131], a[204:207], a[140:143], v[128:131]
  v_mfma_f32_16x16x32_bf16 v[136:139], a[204:207], a[156:159], v[136:139]
  v_mfma_f32_16x16x32_bf16 v[132:135], a[208:211], a[128:131], 0
  v_mfma_f32_16x16x32_bf16 v[140:143], a[208:211], a[144:147], 0
  v_mfma_f32_16x16x32_bf16 v[132:135], a[212:215], a[132:135], v[132:135]
  v_mfma_f32_16x16x32_bf16 v[140:143], a[212:215], a[148:151], v[140:143]
  v_mfma_f32_16x16x32_bf16 v[132:135], a[216:219], a[136:139], v[132:135]
  v_mfma_f32_16x16x32_bf16 v[140:143], a[216:219], a[152:155], v[140:143]
  v_mfma_f32_16x16x32_bf16 v[132:135], a[220:223], a[140:143], v[132:135]
  v_mfma_f32_16x16x32_bf16 v[140:143], a[220:223], a[156:159], v[140:143]
  s_waitcnt lgkmcnt(0)
  v_mfma_f32_16x16x32_bf16 v[0:3], a[224:227], v[160:163], v[0:3]
  v_mfma_f32_16x16x32_bf16 v[32:35], a[224:227], v[164:167], v[32:35]
  v_mfma_f32_16x16x32_bf16 v[4:7], a[228:231], v[160:163], v[4:7]
  v_exp_f32 v128, v128
  v_mfma_f32_16x16x32_bf16 v[36:39], a[228:231], v[164:167], v[36:39]
  v_mfma_f32_16x16x32_bf16 v[8:11], a[232:235], v[160:163], v[8:11]
  v_exp_f32 v129, v129
  v_mfma_f32_16x16x32_bf16 v[40:43], a[232:235], v[164:167], v[40:43]
  v_add_f32 v238, v128, v238
  v_mfma_f32_16x16x32_bf16 v[12:15], a[236:239], v[160:163], v[12:15]
  v_exp_f32 v130, v130
  v_mfma_f32_16x16x32_bf16 v[44:47], a[236:239], v[164:167], v[44:47]
  v_add_f32 v238, v129, v238
  v_mfma_f32_16x16x32_bf16 v[16:19], a[240:243], v[160:163], v[16:19]
  v_exp_f32 v131, v131
  v_mfma_f32_16x16x32_bf16 v[48:51], a[240:243], v[164:167], v[48:51]
  v_add_f32 v238, v130, v238
  v_mfma_f32_16x16x32_bf16 v[20:23], a[244:247], v[160:163], v[20:23]
  v_exp_f32 v132, v132
  v_mfma_f32_16x16x32_bf16 v[52:55], a[244:247], v[164:167], v[52:55]
  v_add_f32 v238, v131, v238
  v_mfma_f32_16x16x32_bf16 v[24:27], a[248:251], v[160:163], v[24:27]
  v_exp_f32 v133, v133
  v_mfma_f32_16x16x32_bf16 v[56:59], a[248:251], v[164:167], v[56:59]
  v_add_f32 v238, v132, v238
  v_mfma_f32_16x16x32_bf16 v[28:31], a[252:255], v[160:163], v[28:31]
  v_exp_f32 v134, v134
  v_mfma_f32_16x16x32_bf16 v[60:63], a[252:255], v[164:167], v[60:63]
  s_waitcnt vmcnt(24)
  s_barrier
  s_mov_b32 m0, 122880
  s_add_u32 s39, s90, 65536
  buffer_load_dwordx4 v234, s[20:23], s39 offen offset:0 lds
  buffer_load_dwordx4 v235, s[20:23], s39 offen offset:1024 lds
  buffer_load_dwordx4 v236, s[20:23], s39 offen offset:2048 lds
  buffer_load_dwordx4 v237, s[20:23], s39 offen offset:3072 lds
  s_mov_b32 m0, 126976
  s_add_u32 s39, s90, 81920
  buffer_load_dwordx4 v234, s[20:23], s39 offen offset:0 lds
  buffer_load_dwordx4 v235, s[20:23], s39 offen offset:1024 lds
  buffer_load_dwordx4 v236, s[20:23], s39 offen offset:2048 lds
  buffer_load_dwordx4 v237, s[20:23], s39 offen offset:3072 lds
  ds_read_b128 a[192:195], v240 offset:32768
  ds_read_b128 a[196:199], v241 offset:32768
  v_exp_f32 v135, v135
  ds_read_b128 a[200:203], v242 offset:32768
  ds_read_b128 a[204:207], v243 offset:32768
  v_add_f32 v238, v133, v238
  v_add_f32 v238, v134, v238
  v_cvt_pk_bf16_f32 v160, v128, v129
  ds_read_b128 a[208:211], v240 offset:36864
  ds_read_b128 a[212:215], v241 offset:36864
  v_exp_f32 v136, v136
  ds_read_b128 a[216:219], v242 offset:36864
  ds_read_b128 a[220:223], v243 offset:36864
  v_add_f32 v238, v135, v238
  v_cvt_pk_bf16_f32 v161, v130, v131
  ds_read_b64_tr_b16 a[224:225], v244 offset:8192
  ds_read_b64_tr_b16 a[226:227], v244 offset:12288
  ds_read_b64_tr_b16 a[228:229], v245 offset:8192
  ds_read_b64_tr_b16 a[230:231], v245 offset:12288
  v_exp_f32 v137, v137
  ds_read_b64_tr_b16 a[232:233], v246 offset:8192
  ds_read_b64_tr_b16 a[234:235], v246 offset:12288
  ds_read_b64_tr_b16 a[236:237], v247 offset:8192
  ds_read_b64_tr_b16 a[238:239], v247 offset:12288
  v_add_f32 v239, v136, v239
  v_cvt_pk_bf16_f32 v162, v132, v133
  ds_read_b64_tr_b16 a[240:241], v248 offset:8192
  ds_read_b64_tr_b16 a[242:243], v248 offset:12288
  ds_read_b64_tr_b16 a[244:245], v249 offset:8192
  ds_read_b64_tr_b16 a[246:247], v249 offset:12288
  v_exp_f32 v138, v138
  ds_read_b64_tr_b16 a[248:249], v250 offset:8192
  ds_read_b64_tr_b16 a[250:251], v250 offset:12288
  ds_read_b64_tr_b16 a[252:253], v251 offset:8192
  ds_read_b64_tr_b16 a[254:255], v251 offset:12288
  v_add_f32 v239, v137, v239
  v_cvt_pk_bf16_f32 v163, v134, v135
  v_exp_f32 v139, v139
  v_add_f32 v239, v138, v239
  v_cvt_pk_bf16_f32 v164, v136, v137
  v_exp_f32 v140, v140
  v_add_f32 v239, v139, v239
  v_cvt_pk_bf16_f32 v165, v138, v139
  v_exp_f32 v141, v141
  v_add_f32 v239, v140, v239
  v_exp_f32 v142, v142
  v_add_f32 v239, v141, v239
  v_cvt_pk_bf16_f32 v166, v140, v141
  v_exp_f32 v143, v143
  v_add_f32 v239, v142, v239
  v_add_f32 v239, v143, v239
  v_cvt_pk_bf16_f32 v167, v142, v143
  s_waitcnt lgkmcnt(15)
  v_mfma_f32_16x16x32_bf16 v[128:131], a[192:195], a[128:131], 0
  v_mfma_f32_16x16x32_bf16 v[136:139], a[192:195], a[144:147], 0
  v_mfma_f32_16x16x32_bf16 v[128:131], a[196:199], a[132:135], v[128:131]
  v_mfma_f32_16x16x32_bf16 v[136:139], a[196:199], a[148:151], v[136:139]
  v_mfma_f32_16x16x32_bf16 v[128:131], a[200:203], a[136:139], v[128:131]
  v_mfma_f32_16x16x32_bf16 v[136:139], a[200:203], a[152:155], v[136:139]
  v_mfma_f32_16x16x32_bf16 v[128:131], a[204:207], a[140:143], v[128:131]
  v_mfma_f32_16x16x32_bf16 v[136:139], a[204:207], a[156:159], v[136:139]
  v_mfma_f32_16x16x32_bf16 v[132:135], a[208:211], a[128:131], 0
  v_mfma_f32_16x16x32_bf16 v[140:143], a[208:211], a[144:147], 0
  v_mfma_f32_16x16x32_bf16 v[132:135], a[212:215], a[132:135], v[132:135]
  v_mfma_f32_16x16x32_bf16 v[140:143], a[212:215], a[148:151], v[140:143]
  v_mfma_f32_16x16x32_bf16 v[132:135], a[216:219], a[136:139], v[132:135]
  v_mfma_f32_16x16x32_bf16 v[140:143], a[216:219], a[152:155], v[140:143]
  v_mfma_f32_16x16x32_bf16 v[132:135], a[220:223], a[140:143], v[132:135]
  v_mfma_f32_16x16x32_bf16 v[140:143], a[220:223], a[156:159], v[140:143]
  s_waitcnt lgkmcnt(0)
  v_mfma_f32_16x16x32_bf16 v[0:3], a[224:227], v[160:163], v[0:3]
  v_mfma_f32_16x16x32_bf16 v[32:35], a[224:227], v[164:167], v[32:35]
  v_mfma_f32_16x16x32_bf16 v[4:7], a[228:231], v[160:163], v[4:7]
  v_exp_f32 v128, v128
  v_mfma_f32_16x16x32_bf16 v[36:39], a[228:231], v[164:167], v[36:39]
  v_mfma_f32_16x16x32_bf16 v[8:11], a[232:235], v[160:163], v[8:11]
  v_exp_f32 v129, v129
  v_mfma_f32_16x16x32_bf16 v[40:43], a[232:235], v[164:167], v[40:43]
  v_add_f32 v238, v128, v238
  v_mfma_f32_16x16x32_bf16 v[12:15], a[236:239], v[160:163], v[12:15]
  v_exp_f32 v130, v130
  v_mfma_f32_16x16x32_bf16 v[44:47], a[236:239], v[164:167], v[44:47]
  v_add_f32 v238, v129, v238
  v_mfma_f32_16x16x32_bf16 v[16:19], a[240:243], v[160:163], v[16:19]
  v_exp_f32 v131, v131
  v_mfma_f32_16x16x32_bf16 v[48:51], a[240:243], v[164:167], v[48:51]
  v_add_f32 v238, v130, v238
  v_mfma_f32_16x16x32_bf16 v[20:23], a[244:247], v[160:163], v[20:23]
  v_exp_f32 v132, v132
  v_mfma_f32_16x16x32_bf16 v[52:55], a[244:247], v[164:167], v[52:55]
  v_add_f32 v238, v131, v238
  v_mfma_f32_16x16x32_bf16 v[24:27], a[248:251], v[160:163], v[24:27]
  v_exp_f32 v133, v133
  v_mfma_f32_16x16x32_bf16 v[56:59], a[248:251], v[164:167], v[56:59]
  v_add_f32 v238, v132, v238
  v_mfma_f32_16x16x32_bf16 v[28:31], a[252:255], v[160:163], v[28:31]
  v_exp_f32 v134, v134
  v_mfma_f32_16x16x32_bf16 v[60:63], a[252:255], v[164:167], v[60:63]
  s_waitcnt vmcnt(24)
  s_barrier
  s_mov_b32 m0, 131072
  s_add_u32 s39, s90, 98304
  buffer_load_dwordx4 v234, s[20:23], s39 offen offset:0 lds
  buffer_load_dwordx4 v235, s[20:23], s39 offen offset:1024 lds
  buffer_load_dwordx4 v236, s[20:23], s39 offen offset:2048 lds
  buffer_load_dwordx4 v237, s[20:23], s39 offen offset:3072 lds
  s_mov_b32 m0, 135168
  s_add_u32 s39, s90, 114688
  buffer_load_dwordx4 v234, s[20:23], s39 offen offset:0 lds
  buffer_load_dwordx4 v235, s[20:23], s39 offen offset:1024 lds
  buffer_load_dwordx4 v236, s[20:23], s39 offen offset:2048 lds
  buffer_load_dwordx4 v237, s[20:23], s39 offen offset:3072 lds
  v_exp_f32 v135, v135
  v_add_f32 v238, v133, v238
  v_add_f32 v238, v134, v238
  v_cvt_pk_bf16_f32 v160, v128, v129
  v_exp_f32 v136, v136
  v_add_f32 v238, v135, v238
  v_cvt_pk_bf16_f32 v161, v130, v131
  ds_read_b64_tr_b16 a[224:225], v244 offset:16384
  ds_read_b64_tr_b16 a[226:227], v244 offset:20480
  ds_read_b64_tr_b16 a[228:229], v245 offset:16384
  ds_read_b64_tr_b16 a[230:231], v245 offset:20480
  v_exp_f32 v137, v137
  ds_read_b64_tr_b16 a[232:233], v246 offset:16384
  ds_read_b64_tr_b16 a[234:235], v246 offset:20480
  ds_read_b64_tr_b16 a[236:237], v247 offset:16384
  ds_read_b64_tr_b16 a[238:239], v247 offset:20480
  v_add_f32 v239, v136, v239
  v_cvt_pk_bf16_f32 v162, v132, v133
  ds_read_b64_tr_b16 a[240:241], v248 offset:16384
  ds_read_b64_tr_b16 a[242:243], v248 offset:20480
  ds_read_b64_tr_b16 a[244:245], v249 offset:16384
  ds_read_b64_tr_b16 a[246:247], v249 offset:20480
  v_exp_f32 v138, v138
  ds_read_b64_tr_b16 a[248:249], v250 offset:16384
  ds_read_b64_tr_b16 a[250:251], v250 offset:20480
  ds_read_b64_tr_b16 a[252:253], v251 offset:16384
  ds_read_b64_tr_b16 a[254:255], v251 offset:20480
  v_add_f32 v239, v137, v239
  v_cvt_pk_bf16_f32 v163, v134, v135
  v_exp_f32 v139, v139
  v_add_f32 v239, v138, v239
  v_cvt_pk_bf16_f32 v164, v136, v137
  v_exp_f32 v140, v140
  v_add_f32 v239, v139, v239
  v_cvt_pk_bf16_f32 v165, v138, v139
  v_exp_f32 v141, v141
  v_add_f32 v239, v140, v239
  v_exp_f32 v142, v142
  v_add_f32 v239, v141, v239
  v_cvt_pk_bf16_f32 v166, v140, v141
  v_exp_f32 v143, v143
  v_add_f32 v239, v142, v239
  v_add_f32 v239, v143, v239
  v_cvt_pk_bf16_f32 v167, v142, v143
  s_waitcnt lgkmcnt(0)
  v_mfma_f32_16x16x32_bf16 v[0:3], a[224:227], v[160:163], v[0:3]
  v_mfma_f32_16x16x32_bf16 v[32:35], a[224:227], v[164:167], v[32:35]
  v_mfma_f32_16x16x32_bf16 v[4:7], a[228:231], v[160:163], v[4:7]
  v_mfma_f32_16x16x32_bf16 v[36:39], a[228:231], v[164:167], v[36:39]
  v_mfma_f32_16x16x32_bf16 v[8:11], a[232:235], v[160:163], v[8:11]
  v_mfma_f32_16x16x32_bf16 v[40:43], a[232:235], v[164:167], v[40:43]
  v_mfma_f32_16x16x32_bf16 v[12:15], a[236:239], v[160:163], v[12:15]
  v_mfma_f32_16x16x32_bf16 v[44:47], a[236:239], v[164:167], v[44:47]
  v_mfma_f32_16x16x32_bf16 v[16:19], a[240:243], v[160:163], v[16:19]
  v_mfma_f32_16x16x32_bf16 v[48:51], a[240:243], v[164:167], v[48:51]
  v_mfma_f32_16x16x32_bf16 v[20:23], a[244:247], v[160:163], v[20:23]
  v_mfma_f32_16x16x32_bf16 v[52:55], a[244:247], v[164:167], v[52:55]
  v_mfma_f32_16x16x32_bf16 v[24:27], a[248:251], v[160:163], v[24:27]
  v_mfma_f32_16x16x32_bf16 v[56:59], a[248:251], v[164:167], v[56:59]
  v_mfma_f32_16x16x32_bf16 v[28:31], a[252:255], v[160:163], v[28:31]
  v_mfma_f32_16x16x32_bf16 v[60:63], a[252:255], v[164:167], v[60:63]
  s_barrier
  v_mov_b32 v252, v238
  v_mov_b32 v254, v239
  s_nop 1
  v_permlane16_swap_b32 v238, v252
  v_permlane16_swap_b32 v239, v254
  v_add_f32 v238, v238, v252
  v_add_f32 v239, v239, v254
  v_mov_b32 v252, v238
  v_mov_b32 v254, v239
  s_nop 1
  v_permlane32_swap_b32 v238, v252
  v_permlane32_swap_b32 v239, v254
  v_add_f32 v238, v238, v252
  v_add_f32 v239, v239, v254
  v_rcp_f32 v252, v238
  v_rcp_f32 v254, v239
  s_nop 0
  s_mov_b32 s38, 0x2b800000
  s_mov_b32 s39, 0x53800000
  v_cmp_nle_f32 s[42:43], s38, v238
  v_cmp_nge_f32 vcc, s39, v238
  s_nop 1
  s_or_b64 s[42:43], s[42:43], vcc
  v_cmp_nle_f32 vcc, s38, v239
  s_nop 1
  s_or_b64 s[42:43], s[42:43], vcc
  v_cmp_nge_f32 vcc, s39, v239
  s_nop 1
  s_or_b64 s[42:43], s[42:43], vcc
  s_cmp_lg_u64 s[42:43], 0
  s_cbranch_scc1 L_slow_LW
L_resume_LW:
  ds_read_b64_tr_b16 a[192:193], v192 offset:0
  ds_read_b64_tr_b16 a[194:195], v192 offset:4096
  ds_read_b64_tr_b16 a[196:197], v193 offset:0
  ds_read_b64_tr_b16 a[198:199], v193 offset:4096
  ds_read_b64_tr_b16 a[200:201], v194 offset:0
  ds_read_b64_tr_b16 a[202:203], v194 offset:4096
  ds_read_b64_tr_b16 a[204:205], v195 offset:0
  ds_read_b64_tr_b16 a[206:207], v195 offset:4096
  ds_read_b64_tr_b16 a[208:209], v196 offset:0
  ds_read_b64_tr_b16 a[210:211], v196 offset:4096
  ds_read_b64_tr_b16 a[212:213], v197 offset:0
  ds_read_b64_tr_b16 a[214:215], v197 offset:4096
  ds_read_b64_tr_b16 a[216:217], v198 offset:0
  ds_read_b64_tr_b16 a[218:219], v198 offset:4096
  ds_read_b64_tr_b16 a[220:221], v199 offset:0
  ds_read_b64_tr_b16 a[222:223], v199 offset:4096
  v_pk_mul_f32 v[0:1], v[0:1], v[252:253] op_sel_hi:[1,0]
  v_pk_mul_f32 v[2:3], v[2:3], v[252:253] op_sel_hi:[1,0]
  v_pk_mul_f32 v[4:5], v[4:5], v[252:253] op_sel_hi:[1,0]
  v_pk_mul_f32 v[6:7], v[6:7], v[252:253] op_sel_hi:[1,0]
  v_cvt_pk_bf16_f32 v128, v0, v1
  v_cvt_pk_bf16_f32 v129, v2, v3
  v_cvt_pk_bf16_f32 v130, v4, v5
  v_cvt_pk_bf16_f32 v131, v6, v7
  s_add_u32 s39, s76, 0
  buffer_store_dwordx4 v[128:131], v204, s[60:63], s39 offen offset:0 sc1
  v_pk_mul_f32 v[8:9], v[8:9], v[252:253] op_sel_hi:[1,0]
  v_pk_mul_f32 v[10:11], v[10:11], v[252:253] op_sel_hi:[1,0]
  v_pk_mul_f32 v[12:13], v[12:13], v[252:253] op_sel_hi:[1,0]
  v_pk_mul_f32 v[14:15], v[14:15], v[252:253] op_sel_hi:[1,0]
  v_cvt_pk_bf16_f32 v132, v8, v9
  v_cvt_pk_bf16_f32 v133, v10, v11
  v_cvt_pk_bf16_f32 v134, v12, v13
  v_cvt_pk_bf16_f32 v135, v14, v15
  buffer_store_dwordx4 v[132:135], v204, s[60:63], s39 offen offset:1024 sc1
  v_pk_mul_f32 v[16:17], v[16:17], v[252:253] op_sel_hi:[1,0]
  v_pk_mul_f32 v[18:19], v[18:19], v[252:253] op_sel_hi:[1,0]
  v_pk_mul_f32 v[20:21], v[20:21], v[252:253] op_sel_hi:[1,0]
  v_pk_mul_f32 v[22:23], v[22:23], v[252:253] op_sel_hi:[1,0]
  v_cvt_pk_bf16_f32 v136, v16, v17
  v_cvt_pk_bf16_f32 v137, v18, v19
  v_cvt_pk_bf16_f32 v138, v20, v21
  v_cvt_pk_bf16_f32 v139, v22, v23
  buffer_store_dwordx4 v[136:139], v204, s[60:63], s39 offen offset:2048 sc1
  v_pk_mul_f32 v[24:25], v[24:25], v[252:253] op_sel_hi:[1,0]
  v_pk_mul_f32 v[26:27], v[26:27], v[252:253] op_sel_hi:[1,0]
  v_pk_mul_f32 v[28:29], v[28:29], v[252:253] op_sel_hi:[1,0]
  v_pk_mul_f32 v[30:31], v[30:31], v[252:253] op_sel_hi:[1,0]
  v_cvt_pk_bf16_f32 v140, v24, v25
  v_cvt_pk_bf16_f32 v141, v26, v27
  v_cvt_pk_bf16_f32 v142, v28, v29
  v_cvt_pk_bf16_f32 v143, v30, v31
  buffer_store_dwordx4 v[140:143], v204, s[60:63], s39 offen offset:3072 sc1
  v_pk_mul_f32 v[32:33], v[32:33], v[254:255] op_sel_hi:[1,0]
  v_pk_mul_f32 v[34:35], v[34:35], v[254:255] op_sel_hi:[1,0]
  v_pk_mul_f32 v[36:37], v[36:37], v[254:255] op_sel_hi:[1,0]
  v_pk_mul_f32 v[38:39], v[38:39], v[254:255] op_sel_hi:[1,0]
  v_cvt_pk_bf16_f32 v144, v32, v33
  v_cvt_pk_bf16_f32 v145, v34, v35
  v_cvt_pk_bf16_f32 v146, v36, v37
  v_cvt_pk_bf16_f32 v147, v38, v39
  s_add_u32 s39, s76, 4096
  buffer_store_dwordx4 v[144:147], v204, s[60:63], s39 offen offset:0 sc1
  v_pk_mul_f32 v[40:41], v[40:41], v[254:255] op_sel_hi:[1,0]
  v_pk_mul_f32 v[42:43], v[42:43], v[254:255] op_sel_hi:[1,0]
  v_pk_mul_f32 v[44:45], v[44:45], v[254:255] op_sel_hi:[1,0]
  v_pk_mul_f32 v[46:47], v[46:47], v[254:255] op_sel_hi:[1,0]
  v_cvt_pk_bf16_f32 v148, v40, v41
  v_cvt_pk_bf16_f32 v149, v42, v43
  v_cvt_pk_bf16_f32 v150, v44, v45
  v_cvt_pk_bf16_f32 v151, v46, v47
  buffer_store_dwordx4 v[148:151], v204, s[60:63], s39 offen offset:1024 sc1
  v_pk_mul_f32 v[48:49], v[48:49], v[254:255] op_sel_hi:[1,0]
  v_pk_mul_f32 v[50:51], v[50:51], v[254:255] op_sel_hi:[1,0]
  v_pk_mul_f32 v[52:53], v[52:53], v[254:255] op_sel_hi:[1,0]
  v_pk_mul_f32 v[54:55], v[54:55], v[254:255] op_sel_hi:[1,0]
  v_cvt_pk_bf16_f32 v152, v48, v49
  v_cvt_pk_bf16_f32 v153, v50, v51
  v_cvt_pk_bf16_f32 v154, v52, v53
  v_cvt_pk_bf16_f32 v155, v54, v55
  buffer_store_dwordx4 v[152:155], v204, s[60:63], s39 offen offset:2048 sc1
  v_pk_mul_f32 v[56:57], v[56:57], v[254:255] op_sel_hi:[1,0]
  v_pk_mul_f32 v[58:59], v[58:59], v[254:255] op_sel_hi:[1,0]
  v_pk_mul_f32 v[60:61], v[60:61], v[254:255] op_sel_hi:[1,0]
  v_pk_mul_f32 v[62:63], v[62:63], v[254:255] op_sel_hi:[1,0]
  v_cvt_pk_bf16_f32 v156, v56, v57
  v_cvt_pk_bf16_f32 v157, v58, v59
  v_cvt_pk_bf16_f32 v158, v60, v61
  v_cvt_pk_bf16_f32 v159, v62, v63
  buffer_store_dwordx4 v[156:159], v204, s[60:63], s39 offen offset:3072 sc1
  s_mov_b32 s37, 0
L_ep5:
  v_readfirstlane_b32 s40, v120
  v_readfirstlane_b32 s41, v121
  s_nop 3
  s_or_b32 s38, s40, s41
  s_cbranch_scc1 L_epd6
  s_add_u32 s37, s37, 1
  s_cmp_gt_u32 s37, 0x40000
  s_cbranch_scc1 L_epd6
  global_load_dwordx2 v[120:121], v126, s[26:27] sc1
  s_waitcnt vmcnt(0)
  s_branch L_ep5
L_epd6:
  s_waitcnt lgkmcnt(0)
  v_mfma_f32_16x16x32_bf16 v[0:3], a[192:195], v[128:131], 0
  ds_read_b64_tr_b16 a[224:225], v192 offset:8192
  ds_read_b64_tr_b16 a[226:227], v192 offset:12288
  v_mfma_f32_16x16x32_bf16 v[32:35], a[192:195], v[144:147], 0
  ds_read_b64_tr_b16 a[228:229], v193 offset:8192
  v_mfma_f32_16x16x32_bf16 v[4:7], a[196:199], v[128:131], 0
  ds_read_b64_tr_b16 a[230:231], v193 offset:12288
  v_mfma_f32_16x16x32_bf16 v[36:39], a[196:199], v[144:147], 0
  ds_read_b64_tr_b16 a[232:233], v194 offset:8192
  ds_read_b64_tr_b16 a[234:235], v194 offset:12288
  v_mfma_f32_16x16x32_bf16 v[8:11], a[200:203], v[128:131], 0
  ds_read_b64_tr_b16 a[236:237], v195 offset:8192
  v_mfma_f32_16x16x32_bf16 v[40:43], a[200:203], v[144:147], 0
  ds_read_b64_tr_b16 a[238:239], v195 offset:12288
  v_mfma_f32_16x16x32_bf16 v[12:15], a[204:207], v[128:131], 0
  ds_read_b64_tr_b16 a[240:241], v196 offset:8192
  ds_read_b64_tr_b16 a[242:243], v196 offset:12288
  v_mfma_f32_16x16x32_bf16 v[44:47], a[204:207], v[144:147], 0
  ds_read_b64_tr_b16 a[244:245], v197 offset:8192
  v_mfma_f32_16x16x32_bf16 v[16:19], a[208:211], v[128:131], 0
  ds_read_b64_tr_b16 a[246:247], v197 offset:12288
  v_mfma_f32_16x16x32_bf16 v[48:51], a[208:211], v[144:147], 0
  ds_read_b64_tr_b16 a[248:249], v198 offset:8192
  ds_read_b64_tr_b16 a[250:251], v198 offset:12288
  v_mfma_f32_16x16x32_bf16 v[20:23], a[212:215], v[128:131], 0
  ds_read_b64_tr_b16 a[252:253], v199 offset:8192
  v_mfma_f32_16x16x32_bf16 v[52:55], a[212:215], v[144:147], 0
  ds_read_b64_tr_b16 a[254:255], v199 offset:12288
  v_mfma_f32_16x16x32_bf16 v[24:27], a[216:219], v[128:131], 0
  v_mfma_f32_16x16x32_bf16 v[56:59], a[216:219], v[144:147], 0
  v_mfma_f32_16x16x32_bf16 v[28:31], a[220:223], v[128:131], 0
  v_mfma_f32_16x16x32_bf16 v[60:63], a[220:223], v[144:147], 0
  s_waitcnt lgkmcnt(0)
  v_mfma_f32_16x16x32_bf16 v[0:3], a[224:227], v[132:135], v[0:3]
  ds_read_b64_tr_b16 a[192:193], v192 offset:16384
  ds_read_b64_tr_b16 a[194:195], v192 offset:20480
  v_mfma_f32_16x16x32_bf16 v[32:35], a[224:227], v[148:151], v[32:35]
  ds_read_b64_tr_b16 a[196:197], v193 offset:16384
  v_mfma_f32_16x16x32_bf16 v[4:7], a[228:231], v[132:135], v[4:7]
  ds_read_b64_tr_b16 a[198:199], v193 offset:20480
  v_mfma_f32_16x16x32_bf16 v[36:39], a[228:231], v[148:151], v[36:39]
  ds_read_b64_tr_b16 a[200:201], v194 offset:16384
  ds_read_b64_tr_b16 a[202:203], v194 offset:20480
  v_mfma_f32_16x16x32_bf16 v[8:11], a[232:235], v[132:135], v[8:11]
  ds_read_b64_tr_b16 a[204:205], v195 offset:16384
  v_mfma_f32_16x16x32_bf16 v[40:43], a[232:235], v[148:151], v[40:43]
  ds_read_b64_tr_b16 a[206:207], v195 offset:20480
  v_mfma_f32_16x16x32_bf16 v[12:15], a[236:239], v[132:135], v[12:15]
  ds_read_b64_tr_b16 a[208:209], v196 offset:16384
  ds_read_b64_tr_b16 a[210:211], v196 offset:20480
  v_mfma_f32_16x16x32_bf16 v[44:47], a[236:239], v[148:151], v[44:47]
  ds_read_b64_tr_b16 a[212:213], v197 offset:16384
  v_mfma_f32_16x16x32_bf16 v[16:19], a[240:243], v[132:135], v[16:19]
  ds_read_b64_tr_b16 a[214:215], v197 offset:20480
  v_mfma_f32_16x16x32_bf16 v[48:51], a[240:243], v[148:151], v[48:51]
  ds_read_b64_tr_b16 a[216:217], v198 offset:16384
  ds_read_b64_tr_b16 a[218:219], v198 offset:20480
  v_mfma_f32_16x16x32_bf16 v[20:23], a[244:247], v[132:135], v[20:23]
  ds_read_b64_tr_b16 a[220:221], v199 offset:16384
  v_mfma_f32_16x16x32_bf16 v[52:55], a[244:247], v[148:151], v[52:55]
  ds_read_b64_tr_b16 a[222:223], v199 offset:20480
  v_mfma_f32_16x16x32_bf16 v[24:27], a[248:251], v[132:135], v[24:27]
  v_mfma_f32_16x16x32_bf16 v[56:59], a[248:251], v[148:151], v[56:59]
  v_mfma_f32_16x16x32_bf16 v[28:31], a[252:255], v[132:135], v[28:31]
  v_mfma_f32_16x16x32_bf16 v[60:63], a[252:255], v[148:151], v[60:63]
  s_waitcnt vmcnt(0)
  s_barrier
  s_lshl_b32 s38, s2, 7
  s_add_u32 s38, s38, 0
  v_mov_b32 v126, s38
  s_mov_b64 s[42:43], exec
  s_mov_b64 exec, 1
  buffer_store_dwordx2 v[120:121], v126, s[60:63], 0 offen sc1
  s_mov_b64 exec, s[42:43]
  s_waitcnt lgkmcnt(0)
  v_mfma_f32_16x16x32_bf16 v[0:3], a[192:195], v[136:139], v[0:3]
  ds_read_b64_tr_b16 a[224:225], v192 offset:24576
  ds_read_b64_tr_b16 a[226:227], v192 offset:28672
  v_mfma_f32_16x16x32_bf16 v[32:35], a[192:195], v[152:155], v[32:35]
  ds_read_b64_tr_b16 a[228:229], v193 offset:24576
  v_mfma_f32_16x16x32_bf16 v[4:7], a[196:199], v[136:139], v[4:7]
  ds_read_b64_tr_b16 a[230:231], v193 offset:28672
  v_mfma_f32_16x16x32_bf16 v[36:39], a[196:199], v[152:155], v[36:39]
  ds_read_b64_tr_b16 a[232:233], v194 offset:24576
  ds_read_b64_tr_b16 a[234:235], v194 offset:28672
  v_mfma_f32_16x16x32_bf16 v[8:11], a[200:203], v[136:139], v[8:11]
  ds_read_b64_tr_b16 a[236:237], v195 offset:24576
  v_mfma_f32_16x16x32_bf16 v[40:43], a[200:203], v[152:155], v[40:43]
  ds_read_b64_tr_b16 a[238:239], v195 offset:28672
  v_mfma_f32_16x16x32_bf16 v[12:15], a[204:207], v[136:139], v[12:15]
  ds_read_b64_tr_b16 a[240:241], v196 offset:24576
  ds_read_b64_tr_b16 a[242:243], v196 offset:28672
  v_mfma_f32_16x16x32_bf16 v[44:47], a[204:207], v[152:155], v[44:47]
  ds_read_b64_tr_b16 a[244:245], v197 offset:24576
  v_mfma_f32_16x16x32_bf16 v[16:19], a[208:211], v[136:139], v[16:19]
  ds_read_b64_tr_b16 a[246:247], v197 offset:28672
  v_mfma_f32_16x16x32_bf16 v[48:51], a[208:211], v[152:155], v[48:51]
  ds_read_b64_tr_b16 a[248:249], v198 offset:24576
  ds_read_b64_tr_b16 a[250:251], v198 offset:28672
  v_mfma_f32_16x16x32_bf16 v[20:23], a[212:215], v[136:139], v[20:23]
  ds_read_b64_tr_b16 a[252:253], v199 offset:24576
  v_mfma_f32_16x16x32_bf16 v[52:55], a[212:215], v[152:155], v[52:55]
  ds_read_b64_tr_b16 a[254:255], v199 offset:28672
  v_mfma_f32_16x16x32_bf16 v[24:27], a[216:219], v[136:139], v[24:27]
  v_mfma_f32_16x16x32_bf16 v[56:59], a[216:219], v[152:155], v[56:59]
  v_mfma_f32_16x16x32_bf16 v[28:31], a[220:223], v[136:139], v[28:31]
  v_mfma_f32_16x16x32_bf16 v[60:63], a[220:223], v[152:155], v[60:63]
  s_waitcnt lgkmcnt(0)
  v_mfma_f32_16x16x32_bf16 v[0:3], a[224:227], v[140:143], v[0:3]
  ds_read_b64_tr_b16 a[192:193], v192 offset:32768
  ds_read_b64_tr_b16 a[194:195], v192 offset:36864
  v_mfma_f32_16x16x32_bf16 v[32:35], a[224:227], v[156:159], v[32:35]
  ds_read_b64_tr_b16 a[196:197], v193 offset:32768
  v_mfma_f32_16x16x32_bf16 v[4:7], a[228:231], v[140:143], v[4:7]
  ds_read_b64_tr_b16 a[198:199], v193 offset:36864
  v_mfma_f32_16x16x32_bf16 v[36:39], a[228:231], v[156:159], v[36:39]
  ds_read_b64_tr_b16 a[200:201], v194 offset:32768
  ds_read_b64_tr_b16 a[202:203], v194 offset:36864
  v_mfma_f32_16x16x32_bf16 v[8:11], a[232:235], v[140:143], v[8:11]
  ds_read_b64_tr_b16 a[204:205], v195 offset:32768
  v_mfma_f32_16x16x32_bf16 v[40:43], a[232:235], v[156:159], v[40:43]
  ds_read_b64_tr_b16 a[206:207], v195 offset:36864
  v_mfma_f32_16x16x32_bf16 v[12:15], a[236:239], v[140:143], v[12:15]
  ds_read_b64_tr_b16 a[208:209], v196 offset:32768
  ds_read_b64_tr_b16 a[210:211], v196 offset:36864
  v_mfma_f32_16x16x32_bf16 v[44:47], a[236:239], v[156:159], v[44:47]
  ds_read_b64_tr_b16 a[212:213], v197 offset:32768
  v_mfma_f32_16x16x32_bf16 v[16:19], a[240:243], v[140:143], v[16:19]
  ds_read_b64_tr_b16 a[214:215], v197 offset:36864
  v_mfma_f32_16x16x32_bf16 v[48:51], a[240:243], v[156:159], v[48:51]
  ds_read_b64_tr_b16 a[216:217], v198 offset:32768
  ds_read_b64_tr_b16 a[218:219], v198 offset:36864
  v_mfma_f32_16x16x32_bf16 v[20:23], a[244:247], v[140:143], v[20:23]
  ds_read_b64_tr_b16 a[220:221], v199 offset:32768
  v_mfma_f32_16x16x32_bf16 v[52:55], a[244:247], v[156:159], v[52:55]
  ds_read_b64_tr_b16 a[222:223], v199 offset:36864
  v_mfma_f32_16x16x32_bf16 v[24:27], a[248:251], v[140:143], v[24:27]
  v_mfma_f32_16x16x32_bf16 v[56:59], a[248:251], v[156:159], v[56:59]
  v_mfma_f32_16x16x32_bf16 v[28:31], a[252:255], v[140:143], v[28:31]
  v_mfma_f32_16x16x32_bf16 v[60:63], a[252:255], v[156:159], v[60:63]
  s_barrier
  s_lshl_b32 s38, s2, 7
  s_add_u32 s38, s38, 65536
  v_mov_b32 v126, s38
  s_mov_b64 s[42:43], exec
  s_mov_b64 exec, 1
  buffer_store_dwordx2 v[120:121], v126, s[60:63], 0 offen sc1
  s_mov_b64 exec, s[42:43]
  v_add_u32 v126, 1, v255
  v_lshlrev_b32 v126, 3, v126
  v_xor_b32 v126, s2, v126
  v_lshlrev_b32 v126, 7, v126
  s_mov_b64 s[42:43], exec
  s_mov_b64 exec, 7
  s_mov_b32 s37, 0
  buffer_load_dwordx2 v[214:215], v126, s[60:63], 0 offen sc1
  buffer_load_dwordx2 v[216:217], v126, s[60:63], 0 offen sc1
  buffer_load_dwordx2 v[218:219], v126, s[60:63], 0 offen sc1
L_poll7:
  buffer_load_dwordx2 v[220:221], v126, s[60:63], 0 offen sc1
  s_waitcnt vmcnt(3)
  v_cmp_ne_u64 vcc, s[40:41], v[214:215]
  s_nop 4
  s_cbranch_vccz L_polld8
  buffer_load_dwordx2 v[214:215], v126, s[60:63], 0 offen sc1
  s_waitcnt vmcnt(3)
  v_cmp_ne_u64 vcc, s[40:41], v[216:217]
  s_nop 4
  s_cbranch_vccz L_polld8
  buffer_load_dwordx2 v[216:217], v126, s[60:63], 0 offen sc1
  s_waitcnt vmcnt(3)
  v_cmp_ne_u64 vcc, s[40:41], v[218:219]
  s_nop 4
  s_cbranch_vccz L_polld8
  buffer_load_dwordx2 v[218:219], v126, s[60:63], 0 offen sc1
  s_waitcnt vmcnt(3)
  v_cmp_ne_u64 vcc, s[40:41], v[220:221]
  s_nop 4
  s_cbranch_vccz L_polld8
  s_add_u32 s37, s37, 1
  s_cmp_gt_u32 s37, 0x10000
  s_cbranch_scc0 L_poll7
L_polld8:
  s_mov_b64 exec, s[42:43]
  s_barrier
  s_add_u32 s39, s78, 0
  buffer_load_dwordx4 a[0:3], v204, s[60:63], s39 offen offset:0 sc1
  buffer_load_dwordx4 a[4:7], v204, s[60:63], s39 offen offset:1024 sc1
  buffer_load_dwordx4 a[8:11], v204, s[60:63], s39 offen offset:2048 sc1
  buffer_load_dwordx4 a[12:15], v204, s[60:63], s39 offen offset:3072 sc1
  s_add_u32 s39, s78, 4096
  buffer_load_dwordx4 a[16:19], v204, s[60:63], s39 offen offset:0 sc1
  buffer_load_dwordx4 a[20:23], v204, s[60:63], s39 offen offset:1024 sc1
  buffer_load_dwordx4 a[24:27], v204, s[60:63], s39 offen offset:2048 sc1
  buffer_load_dwordx4 a[28:31], v204, s[60:63], s39 offen offset:3072 sc1
  s_add_u32 s39, s79, 0
  buffer_load_dwordx4 a[64:67], v204, s[60:63], s39 offen offset:0 sc1
  buffer_load_dwordx4 a[68:71], v204, s[60:63], s39 offen offset:1024 sc1
  buffer_load_dwordx4 a[72:75], v204, s[60:63], s39 offen offset:2048 sc1
  buffer_load_dwordx4 a[76:79], v204, s[60:63], s39 offen offset:3072 sc1
  s_add_u32 s39, s79, 4096
  buffer_load_dwordx4 a[80:83], v204, s[60:63], s39 offen offset:0 sc1
  buffer_load_dwordx4 a[84:87], v204, s[60:63], s39 offen offset:1024 sc1
  buffer_load_dwordx4 a[88:91], v204, s[60:63], s39 offen offset:2048 sc1
  buffer_load_dwordx4 a[92:95], v204, s[60:63], s39 offen offset:3072 sc1
  s_add_u32 s39, s80, 0
  buffer_load_dwordx4 a[128:131], v204, s[60:63], s39 offen offset:0 sc1
  buffer_load_dwordx4 a[132:135], v204, s[60:63], s39 offen offset:1024 sc1
  buffer_load_dwordx4 a[136:139], v204, s[60:63], s39 offen offset:2048 sc1
  buffer_load_dwordx4 a[140:143], v204, s[60:63], s39 offen offset:3072 sc1
  s_add_u32 s39, s80, 4096
  buffer_load_dwordx4 a[144:147], v204, s[60:63], s39 offen offset:0 sc1
  buffer_load_dwordx4 a[148:151], v204, s[60:63], s39 offen offset:1024 sc1
  buffer_load_dwordx4 a[152:155], v204, s[60:63], s39 offen offset:2048 sc1
  buffer_load_dwordx4 a[156:159], v204, s[60:63], s39 offen offset:3072 sc1
  v_add_u32 v126, 1, v255
  v_lshlrev_b32 v126, 3, v126
  v_xor_b32 v126, s2, v126
  v_lshlrev_b32 v126, 7, v126
  v_add_u32 v126, 65536, v126
  s_mov_b64 s[42:43], exec
  s_mov_b64 exec, 7
  s_mov_b32 s37, 0
  buffer_load_dwordx2 v[214:215], v126, s[60:63], 0 offen sc1
  buffer_load_dwordx2 v[216:217], v126, s[60:63], 0 offen sc1
  buffer_load_dwordx2 v[218:219], v126, s[60:63], 0 offen sc1
L_poll9:
  buffer_load_dwordx2 v[220:221], v126, s[60:63], 0 offen sc1
  s_waitcnt vmcnt(3)
  v_cmp_ne_u64 vcc, s[40:41], v[214:215]
  s_nop 4
  s_cbranch_vccz L_polld10
  buffer_load_dwordx2 v[214:215], v126, s[60:63], 0 offen sc1
  s_waitcnt vmcnt(3)
  v_cmp_ne_u64 vcc, s[40:41], v[216:217]
  s_nop 4
  s_cbranch_vccz L_polld10
  buffer_load_dwordx2 v[216:217], v126, s[60:63], 0 offen sc1
  s_waitcnt vmcnt(3)
  v_cmp_ne_u64 vcc, s[40:41], v[218:219]
  s_nop 4
  s_cbranch_vccz L_polld10
  buffer_load_dwordx2 v[218:219], v126, s[60:63], 0 offen sc1
  s_waitcnt vmcnt(3)
  v_cmp_ne_u64 vcc, s[40:41], v[220:221]
  s_nop 4
  s_cbranch_vccz L_polld10
  s_add_u32 s37, s37, 1
  s_cmp_gt_u32 s37, 0x10000
  s_cbranch_scc0 L_poll9
L_polld10:
  s_mov_b64 exec, s[42:43]
  s_barrier
  s_waitcnt vmcnt(0)
  s_waitcnt lgkmcnt(0)
  v_mfma_f32_16x16x32_bf16 v[0:3], a[192:195], a[0:3], v[0:3]
  ds_read_b64_tr_b16 a[224:225], v192 offset:40960
  ds_read_b64_tr_b16 a[226:227], v192 offset:45056
  v_mfma_f32_16x16x32_bf16 v[32:35], a[192:195], a[16:19], v[32:35]
  ds_read_b64_tr_b16 a[228:229], v193 offset:40960
  v_mfma_f32_16x16x32_bf16 v[4:7], a[196:199], a[0:3], v[4:7]
  ds_read_b64_tr_b16 a[230:231], v193 offset:45056
  v_mfma_f32_16x16x32_bf16 v[36:39], a[196:199], a[16:19], v[36:39]
  ds_read_b64_tr_b16 a[232:233], v194 offset:40960
  ds_read_b64_tr_b16 a[234:235], v194 offset:45056
  v_mfma_f32_16x16x32_bf16 v[8:11], a[200:203], a[0:3], v[8:11]
  ds_read_b64_tr_b16 a[236:237], v195 offset:40960
  v_mfma_f32_16x16x32_bf16 v[40:43], a[200:203], a[16:19], v[40:43]
  ds_read_b64_tr_b16 a[238:239], v195 offset:45056
  v_mfma_f32_16x16x32_bf16 v[12:15], a[204:207], a[0:3], v[12:15]
  ds_read_b64_tr_b16 a[240:241], v196 offset:40960
  ds_read_b64_tr_b16 a[242:243], v196 offset:45056
  v_mfma_f32_16x16x32_bf16 v[44:47], a[204:207], a[16:19], v[44:47]
  ds_read_b64_tr_b16 a[244:245], v197 offset:40960
  v_mfma_f32_16x16x32_bf16 v[16:19], a[208:211], a[0:3], v[16:19]
  ds_read_b64_tr_b16 a[246:247], v197 offset:45056
  v_mfma_f32_16x16x32_bf16 v[48:51], a[208:211], a[16:19], v[48:51]
  ds_read_b64_tr_b16 a[248:249], v198 offset:40960
  ds_read_b64_tr_b16 a[250:251], v198 offset:45056
  v_mfma_f32_16x16x32_bf16 v[20:23], a[212:215], a[0:3], v[20:23]
  ds_read_b64_tr_b16 a[252:253], v199 offset:40960
  v_mfma_f32_16x16x32_bf16 v[52:55], a[212:215], a[16:19], v[52:55]
  ds_read_b64_tr_b16 a[254:255], v199 offset:45056
  v_mfma_f32_16x16x32_bf16 v[24:27], a[216:219], a[0:3], v[24:27]
  v_mfma_f32_16x16x32_bf16 v[56:59], a[216:219], a[16:19], v[56:59]
  v_mfma_f32_16x16x32_bf16 v[28:31], a[220:223], a[0:3], v[28:31]
  v_mfma_f32_16x16x32_bf16 v[60:63], a[220:223], a[16:19], v[60:63]
  s_waitcnt lgkmcnt(0)
  v_mfma_f32_16x16x32_bf16 v[0:3], a[224:227], a[4:7], v[0:3]
  ds_read_b64_tr_b16 a[192:193], v192 offset:49152
  ds_read_b64_tr_b16 a[194:195], v192 offset:53248
  v_mfma_f32_16x16x32_bf16 v[32:35], a[224:227], a[20:23], v[32:35]
  ds_read_b64_tr_b16 a[196:197], v193 offset:49152
  v_mfma_f32_16x16x32_bf16 v[4:7], a[228:231], a[4:7], v[4:7]
  ds_read_b64_tr_b16 a[198:199], v193 offset:53248
  v_mfma_f32_16x16x32_bf16 v[36:39], a[228:231], a[20:23], v[36:39]
  ds_read_b64_tr_b16 a[200:201], v194 offset:49152
  ds_read_b64_tr_b16 a[202:203], v194 offset:53248
  v_mfma_f32_16x16x32_bf16 v[8:11], a[232:235], a[4:7], v[8:11]
  ds_read_b64_tr_b16 a[204:205], v195 offset:49152
  v_mfma_f32_16x16x32_bf16 v[40:43], a[232:235], a[20:23], v[40:43]
  ds_read_b64_tr_b16 a[206:207], v195 offset:53248
  v_mfma_f32_16x16x32_bf16 v[12:15], a[236:239], a[4:7], v[12:15]
  ds_read_b64_tr_b16 a[208:209], v196 offset:49152
  ds_read_b64_tr_b16 a[210:211], v196 offset:53248
  v_mfma_f32_16x16x32_bf16 v[44:47], a[236:239], a[20:23], v[44:47]
  ds_read_b64_tr_b16 a[212:213], v197 offset:49152
  v_mfma_f32_16x16x32_bf16 v[16:19], a[240:243], a[4:7], v[16:19]
  ds_read_b64_tr_b16 a[214:215], v197 offset:53248
  v_mfma_f32_16x16x32_bf16 v[48:51], a[240:243], a[20:23], v[48:51]
  ds_read_b64_tr_b16 a[216:217], v198 offset:49152
  ds_read_b64_tr_b16 a[218:219], v198 offset:53248
  v_mfma_f32_16x16x32_bf16 v[20:23], a[244:247], a[4:7], v[20:23]
  ds_read_b64_tr_b16 a[220:221], v199 offset:49152
  v_mfma_f32_16x16x32_bf16 v[52:55], a[244:247], a[20:23], v[52:55]
  ds_read_b64_tr_b16 a[222:223], v199 offset:53248
  v_mfma_f32_16x16x32_bf16 v[24:27], a[248:251], a[4:7], v[24:27]
  v_mfma_f32_16x16x32_bf16 v[56:59], a[248:251], a[20:23], v[56:59]
  v_mfma_f32_16x16x32_bf16 v[28:31], a[252:255], a[4:7], v[28:31]
  v_mfma_f32_16x16x32_bf16 v[60:63], a[252:255], a[20:23], v[60:63]
  s_waitcnt lgkmcnt(0)
  v_mfma_f32_16x16x32_bf16 v[0:3], a[192:195], a[8:11], v[0:3]
  ds_read_b64_tr_b16 a[224:225], v192 offset:57344
  ds_read_b64_tr_b16 a[226:227], v192 offset:61440
  v_mfma_f32_16x16x32_bf16 v[32:35], a[192:195], a[24:27], v[32:35]
  ds_read_b64_tr_b16 a[228:229], v193 offset:57344
  v_mfma_f32_16x16x32_bf16 v[4:7], a[196:199], a[8:11], v[4:7]
  ds_read_b64_tr_b16 a[230:231], v193 offset:61440
  v_mfma_f32_16x16x32_bf16 v[36:39], a[196:199], a[24:27], v[36:39]
  ds_read_b64_tr_b16 a[232:233], v194 offset:57344
  ds_read_b64_tr_b16 a[234:235], v194 offset:61440
  v_mfma_f32_16x16x32_bf16 v[8:11], a[200:203], a[8:11], v[8:11]
  ds_read_b64_tr_b16 a[236:237], v195 offset:57344
  v_mfma_f32_16x16x32_bf16 v[40:43], a[200:203], a[24:27], v[40:43]
  ds_read_b64_tr_b16 a[238:239], v195 offset:61440
  v_mfma_f32_16x16x32_bf16 v[12:15], a[204:207], a[8:11], v[12:15]
  ds_read_b64_tr_b16 a[240:241], v196 offset:57344
  ds_read_b64_tr_b16 a[242:243], v196 offset:61440
  v_mfma_f32_16x16x32_bf16 v[44:47], a[204:207], a[24:27], v[44:47]
  ds_read_b64_tr_b16 a[244:245], v197 offset:57344
  v_mfma_f32_16x16x32_bf16 v[16:19], a[208:211], a[8:11], v[16:19]
  ds_read_b64_tr_b16 a[246:247], v197 offset:61440
  v_mfma_f32_16x16x32_bf16 v[48:51], a[208:211], a[24:27], v[48:51]
  ds_read_b64_tr_b16 a[248:249], v198 offset:57344
  ds_read_b64_tr_b16 a[250:251], v198 offset:61440
  v_mfma_f32_16x16x32_bf16 v[20:23], a[212:215], a[8:11], v[20:23]
  ds_read_b64_tr_b16 a[252:253], v199 offset:57344
  v_mfma_f32_16x16x32_bf16 v[52:55], a[212:215], a[24:27], v[52:55]
  ds_read_b64_tr_b16 a[254:255], v199 offset:61440
  v_mfma_f32_16x16x32_bf16 v[24:27], a[216:219], a[8:11], v[24:27]
  v_mfma_f32_16x16x32_bf16 v[56:59], a[216:219], a[24:27], v[56:59]
  v_mfma_f32_16x16x32_bf16 v[28:31], a[220:223], a[8:11], v[28:31]
  v_mfma_f32_16x16x32_bf16 v[60:63], a[220:223], a[24:27], v[60:63]
  s_waitcnt lgkmcnt(0)
  v_mfma_f32_16x16x32_bf16 v[0:3], a[224:227], a[12:15], v[0:3]
  ds_read_b64_tr_b16 a[192:193], v205 offset:0
  ds_read_b64_tr_b16 a[194:195], v205 offset:4096
  v_mfma_f32_16x16x32_bf16 v[32:35], a[224:227], a[28:31], v[32:35]
  ds_read_b64_tr_b16 a[196:197], v206 offset:0
  v_mfma_f32_16x16x32_bf16 v[4:7], a[228:231], a[12:15], v[4:7]
  ds_read_b64_tr_b16 a[198:199], v206 offset:4096
  v_mfma_f32_16x16x32_bf16 v[36:39], a[228:231], a[28:31], v[36:39]
  ds_read_b64_tr_b16 a[200:201], v207 offset:0
  ds_read_b64_tr_b16 a[202:203], v207 offset:4096
  v_mfma_f32_16x16x32_bf16 v[8:11], a[232:235], a[12:15], v[8:11]
  ds_read_b64_tr_b16 a[204:205], v208 offset:0
  v_mfma_f32_16x16x32_bf16 v[40:43], a[232:235], a[28:31], v[40:43]
  ds_read_b64_tr_b16 a[206:207], v208 offset:4096
  v_mfma_f32_16x16x32_bf16 v[12:15], a[236:239], a[12:15], v[12:15]
  ds_read_b64_tr_b16 a[208:209], v209 offset:0
  ds_read_b64_tr_b16 a[210:211], v209 offset:4096
  v_mfma_f32_16x16x32_bf16 v[44:47], a[236:239], a[28:31], v[44:47]
  ds_read_b64_tr_b16 a[212:213], v210 offset:0
  v_mfma_f32_16x16x32_bf16 v[16:19], a[240:243], a[12:15], v[16:19]
  ds_read_b64_tr_b16 a[214:215], v210 offset:4096
  v_mfma_f32_16x16x32_bf16 v[48:51], a[240:243], a[28:31], v[48:51]
  ds_read_b64_tr_b16 a[216:217], v211 offset:0
  ds_read_b64_tr_b16 a[218:219], v211 offset:4096
  v_mfma_f32_16x16x32_bf16 v[20:23], a[244:247], a[12:15], v[20:23]
  ds_read_b64_tr_b16 a[220:221], v212 offset:0
  v_mfma_f32_16x16x32_bf16 v[52:55], a[244:247], a[28:31], v[52:55]
  ds_read_b64_tr_b16 a[222:223], v212 offset:4096
  v_mfma_f32_16x16x32_bf16 v[24:27], a[248:251], a[12:15], v[24:27]
  v_mfma_f32_16x16x32_bf16 v[56:59], a[248:251], a[28:31], v[56:59]
  v_mfma_f32_16x16x32_bf16 v[28:31], a[252:255], a[12:15], v[28:31]
  v_mfma_f32_16x16x32_bf16 v[60:63], a[252:255], a[28:31], v[60:63]
  s_waitcnt lgkmcnt(0)
  v_mfma_f32_16x16x32_bf16 v[0:3], a[192:195], a[64:67], v[0:3]
  ds_read_b64_tr_b16 a[224:225], v205 offset:8192
  ds_read_b64_tr_b16 a[226:227], v205 offset:12288
  v_mfma_f32_16x16x32_bf16 v[32:35], a[192:195], a[80:83], v[32:35]
  ds_read_b64_tr_b16 a[228:229], v206 offset:8192
  v_mfma_f32_16x16x32_bf16 v[4:7], a[196:199], a[64:67], v[4:7]
  ds_read_b64_tr_b16 a[230:231], v206 offset:12288
  v_mfma_f32_16x16x32_bf16 v[36:39], a[196:199], a[80:83], v[36:39]
  ds_read_b64_tr_b16 a[232:233], v207 offset:8192
  ds_read_b64_tr_b16 a[234:235], v207 offset:12288
  v_mfma_f32_16x16x32_bf16 v[8:11], a[200:203], a[64:67], v[8:11]
  ds_read_b64_tr_b16 a[236:237], v208 offset:8192
  v_mfma_f32_16x16x32_bf16 v[40:43], a[200:203], a[80:83], v[40:43]
  ds_read_b64_tr_b16 a[238:239], v208 offset:12288
  v_mfma_f32_16x16x32_bf16 v[12:15], a[204:207], a[64:67], v[12:15]
  ds_read_b64_tr_b16 a[240:241], v209 offset:8192
  ds_read_b64_tr_b16 a[242:243], v209 offset:12288
  v_mfma_f32_16x16x32_bf16 v[44:47], a[204:207], a[80:83], v[44:47]
  ds_read_b64_tr_b16 a[244:245], v210 offset:8192
  v_mfma_f32_16x16x32_bf16 v[16:19], a[208:211], a[64:67], v[16:19]
  ds_read_b64_tr_b16 a[246:247], v210 offset:12288
  v_mfma_f32_16x16x32_bf16 v[48:51], a[208:211], a[80:83], v[48:51]
  ds_read_b64_tr_b16 a[248:249], v211 offset:8192
  ds_read_b64_tr_b16 a[250:251], v211 offset:12288
  v_mfma_f32_16x16x32_bf16 v[20:23], a[212:215], a[64:67], v[20:23]
  ds_read_b64_tr_b16 a[252:253], v212 offset:8192
  v_mfma_f32_16x16x32_bf16 v[52:55], a[212:215], a[80:83], v[52:55]
  ds_read_b64_tr_b16 a[254:255], v212 offset:12288
  v_mfma_f32_16x16x32_bf16 v[24:27], a[216:219], a[64:67], v[24:27]
  v_mfma_f32_16x16x32_bf16 v[56:59], a[216:219], a[80:83], v[56:59]
  v_mfma_f32_16x16x32_bf16 v[28:31], a[220:223], a[64:67], v[28:31]
  v_mfma_f32_16x16x32_bf16 v[60:63], a[220:223], a[80:83], v[60:63]
  s_waitcnt lgkmcnt(0)
  v_mfma_f32_16x16x32_bf16 v[0:3], a[224:227], a[68:71], v[0:3]
  ds_read_b64_tr_b16 a[192:193], v205 offset:16384
  ds_read_b64_tr_b16 a[194:195], v205 offset:20480
  v_mfma_f32_16x16x32_bf16 v[32:35], a[224:227], a[84:87], v[32:35]
  ds_read_b64_tr_b16 a[196:197], v206 offset:16384
  v_mfma_f32_16x16x32_bf16 v[4:7], a[228:231], a[68:71], v[4:7]
  ds_read_b64_tr_b16 a[198:199], v206 offset:20480
  v_mfma_f32_16x16x32_bf16 v[36:39], a[228:231], a[84:87], v[36:39]
  ds_read_b64_tr_b16 a[200:201], v207 offset:16384
  ds_read_b64_tr_b16 a[202:203], v207 offset:20480
  v_mfma_f32_16x16x32_bf16 v[8:11], a[232:235], a[68:71], v[8:11]
  ds_read_b64_tr_b16 a[204:205], v208 offset:16384
  v_mfma_f32_16x16x32_bf16 v[40:43], a[232:235], a[84:87], v[40:43]
  ds_read_b64_tr_b16 a[206:207], v208 offset:20480
  v_mfma_f32_16x16x32_bf16 v[12:15], a[236:239], a[68:71], v[12:15]
  ds_read_b64_tr_b16 a[208:209], v209 offset:16384
  ds_read_b64_tr_b16 a[210:211], v209 offset:20480
  v_mfma_f32_16x16x32_bf16 v[44:47], a[236:239], a[84:87], v[44:47]
  ds_read_b64_tr_b16 a[212:213], v210 offset:16384
  v_mfma_f32_16x16x32_bf16 v[16:19], a[240:243], a[68:71], v[16:19]
  ds_read_b64_tr_b16 a[214:215], v210 offset:20480
  v_mfma_f32_16x16x32_bf16 v[48:51], a[240:243], a[84:87], v[48:51]
  ds_read_b64_tr_b16 a[216:217], v211 offset:16384
  ds_read_b64_tr_b16 a[218:219], v211 offset:20480
  v_mfma_f32_16x16x32_bf16 v[20:23], a[244:247], a[68:71], v[20:23]
  ds_read_b64_tr_b16 a[220:221], v212 offset:16384
  v_mfma_f32_16x16x32_bf16 v[52:55], a[244:247], a[84:87], v[52:55]
  ds_read_b64_tr_b16 a[222:223], v212 offset:20480
  v_mfma_f32_16x16x32_bf16 v[24:27], a[248:251], a[68:71], v[24:27]
  v_mfma_f32_16x16x32_bf16 v[56:59], a[248:251], a[84:87], v[56:59]
  v_mfma_f32_16x16x32_bf16 v[28:31], a[252:255], a[68:71], v[28:31]
  v_mfma_f32_16x16x32_bf16 v[60:63], a[252:255], a[84:87], v[60:63]
  s_waitcnt lgkmcnt(0)
  v_mfma_f32_16x16x32_bf16 v[0:3], a[192:195], a[72:75], v[0:3]
  ds_read_b64_tr_b16 a[224:225], v205 offset:24576
  ds_read_b64_tr_b16 a[226:227], v205 offset:28672
  v_mfma_f32_16x16x32_bf16 v[32:35], a[192:195], a[88:91], v[32:35]
  ds_read_b64_tr_b16 a[228:229], v206 offset:24576
  v_mfma_f32_16x16x32_bf16 v[4:7], a[196:199], a[72:75], v[4:7]
  ds_read_b64_tr_b16 a[230:231], v206 offset:28672
  v_mfma_f32_16x16x32_bf16 v[36:39], a[196:199], a[88:91], v[36:39]
  ds_read_b64_tr_b16 a[232:233], v207 offset:24576
  ds_read_b64_tr_b16 a[234:235], v207 offset:28672
  v_mfma_f32_16x16x32_bf16 v[8:11], a[200:203], a[72:75], v[8:11]
  ds_read_b64_tr_b16 a[236:237], v208 offset:24576
  v_mfma_f32_16x16x32_bf16 v[40:43], a[200:203], a[88:91], v[40:43]
  ds_read_b64_tr_b16 a[238:239], v208 offset:28672
  v_mfma_f32_16x16x32_bf16 v[12:15], a[204:207], a[72:75], v[12:15]
  ds_read_b64_tr_b16 a[240:241], v209 offset:24576
  ds_read_b64_tr_b16 a[242:243], v209 offset:28672
  v_mfma_f32_16x16x32_bf16 v[44:47], a[204:207], a[88:91], v[44:47]
  ds_read_b64_tr_b16 a[244:245], v210 offset:24576
  v_mfma_f32_16x16x32_bf16 v[16:19], a[208:211], a[72:75], v[16:19]
  ds_read_b64_tr_b16 a[246:247], v210 offset:28672
  v_mfma_f32_16x16x32_bf16 v[48:51], a[208:211], a[88:91], v[48:51]
  ds_read_b64_tr_b16 a[248:249], v211 offset:24576
  ds_read_b64_tr_b16 a[250:251], v211 offset:28672
  v_mfma_f32_16x16x32_bf16 v[20:23], a[212:215], a[72:75], v[20:23]
  ds_read_b64_tr_b16 a[252:253], v212 offset:24576
  v_mfma_f32_16x16x32_bf16 v[52:55], a[212:215], a[88:91], v[52:55]
  ds_read_b64_tr_b16 a[254:255], v212 offset:28672
  v_mfma_f32_16x16x32_bf16 v[24:27], a[216:219], a[72:75], v[24:27]
  v_mfma_f32_16x16x32_bf16 v[56:59], a[216:219], a[88:91], v[56:59]
  v_mfma_f32_16x16x32_bf16 v[28:31], a[220:223], a[72:75], v[28:31]
  v_mfma_f32_16x16x32_bf16 v[60:63], a[220:223], a[88:91], v[60:63]
  s_waitcnt lgkmcnt(0)
  v_mfma_f32_16x16x32_bf16 v[0:3], a[224:227], a[76:79], v[0:3]
  ds_read_b64_tr_b16 a[192:193], v244 offset:40960
  ds_read_b64_tr_b16 a[194:195], v244 offset:45056
  v_mfma_f32_16x16x32_bf16 v[32:35], a[224:227], a[92:95], v[32:35]
  ds_read_b64_tr_b16 a[196:197], v245 offset:40960
  v_mfma_f32_16x16x32_bf16 v[4:7], a[228:231], a[76:79], v[4:7]
  ds_read_b64_tr_b16 a[198:199], v245 offset:45056
  v_mfma_f32_16x16x32_bf16 v[36:39], a[228:231], a[92:95], v[36:39]
  ds_read_b64_tr_b16 a[200:201], v246 offset:40960
  ds_read_b64_tr_b16 a[202:203], v246 offset:45056
  v_mfma_f32_16x16x32_bf16 v[8:11], a[232:235], a[76:79], v[8:11]
  ds_read_b64_tr_b16 a[204:205], v247 offset:40960
  v_mfma_f32_16x16x32_bf16 v[40:43], a[232:235], a[92:95], v[40:43]
  ds_read_b64_tr_b16 a[206:207], v247 offset:45056
  v_mfma_f32_16x16x32_bf16 v[12:15], a[236:239], a[76:79], v[12:15]
  ds_read_b64_tr_b16 a[208:209], v248 offset:40960
  ds_read_b64_tr_b16 a[210:211], v248 offset:45056
  v_mfma_f32_16x16x32_bf16 v[44:47], a[236:239], a[92:95], v[44:47]
  ds_read_b64_tr_b16 a[212:213], v249 offset:40960
  v_mfma_f32_16x16x32_bf16 v[16:19], a[240:243], a[76:79], v[16:19]
  ds_read_b64_tr_b16 a[214:215], v249 offset:45056
  v_mfma_f32_16x16x32_bf16 v[48:51], a[240:243], a[92:95], v[48:51]
  ds_read_b64_tr_b16 a[216:217], v250 offset:40960
  ds_read_b64_tr_b16 a[218:219], v250 offset:45056
  v_mfma_f32_16x16x32_bf16 v[20:23], a[244:247], a[76:79], v[20:23]
  ds_read_b64_tr_b16 a[220:221], v251 offset:40960
  v_mfma_f32_16x16x32_bf16 v[52:55], a[244:247], a[92:95], v[52:55]
  ds_read_b64_tr_b16 a[222:223], v251 offset:45056
  v_mfma_f32_16x16x32_bf16 v[24:27], a[248:251], a[76:79], v[24:27]
  v_mfma_f32_16x16x32_bf16 v[56:59], a[248:251], a[92:95], v[56:59]
  v_mfma_f32_16x16x32_bf16 v[28:31], a[252:255], a[76:79], v[28:31]
  v_mfma_f32_16x16x32_bf16 v[60:63], a[252:255], a[92:95], v[60:63]
  s_waitcnt lgkmcnt(0)
  v_mfma_f32_16x16x32_bf16 v[0:3], a[192:195], a[128:131], v[0:3]
  ds_read_b64_tr_b16 a[224:225], v244 offset:57344
  ds_read_b64_tr_b16 a[226:227], v244 offset:61440
  v_mfma_f32_16x16x32_bf16 v[32:35], a[192:195], a[144:147], v[32:35]
  ds_read_b64_tr_b16 a[228:229], v245 offset:57344
  v_mfma_f32_16x16x32_bf16 v[4:7], a[196:199], a[128:131], v[4:7]
  ds_read_b64_tr_b16 a[230:231], v245 offset:61440
  v_mfma_f32_16x16x32_bf16 v[36:39], a[196:199], a[144:147], v[36:39]
  ds_read_b64_tr_b16 a[232:233], v246 offset:57344
  ds_read_b64_tr_b16 a[234:235], v246 offset:61440
  v_mfma_f32_16x16x32_bf16 v[8:11], a[200:203], a[128:131], v[8:11]
  ds_read_b64_tr_b16 a[236:237], v247 offset:57344
  v_mfma_f32_16x16x32_bf16 v[40:43], a[200:203], a[144:147], v[40:43]
  ds_read_b64_tr_b16 a[238:239], v247 offset:61440
  v_mfma_f32_16x16x32_bf16 v[12:15], a[204:207], a[128:131], v[12:15]
  ds_read_b64_tr_b16 a[240:241], v248 offset:57344
  ds_read_b64_tr_b16 a[242:243], v248 offset:61440
  v_mfma_f32_16x16x32_bf16 v[44:47], a[204:207], a[144:147], v[44:47]
  ds_read_b64_tr_b16 a[244:245], v249 offset:57344
  v_mfma_f32_16x16x32_bf16 v[16:19], a[208:211], a[128:131], v[16:19]
  ds_read_b64_tr_b16 a[246:247], v249 offset:61440
  v_mfma_f32_16x16x32_bf16 v[48:51], a[208:211], a[144:147], v[48:51]
  ds_read_b64_tr_b16 a[248:249], v250 offset:57344
  ds_read_b64_tr_b16 a[250:251], v250 offset:61440
  v_mfma_f32_16x16x32_bf16 v[20:23], a[212:215], a[128:131], v[20:23]
  ds_read_b64_tr_b16 a[252:253], v251 offset:57344
  v_mfma_f32_16x16x32_bf16 v[52:55], a[212:215], a[144:147], v[52:55]
  ds_read_b64_tr_b16 a[254:255], v251 offset:61440
  v_mfma_f32_16x16x32_bf16 v[24:27], a[216:219], a[128:131], v[24:27]
  v_mfma_f32_16x16x32_bf16 v[56:59], a[216:219], a[144:147], v[56:59]
  v_mfma_f32_16x16x32_bf16 v[28:31], a[220:223], a[128:131], v[28:31]
  v_mfma_f32_16x16x32_bf16 v[60:63], a[220:223], a[144:147], v[60:63]
  s_waitcnt lgkmcnt(0)
  v_mfma_f32_16x16x32_bf16 v[0:3], a[224:227], a[132:135], v[0:3]
  ds_read_b64_tr_b16 a[192:193], v244 offset:24576
  ds_read_b64_tr_b16 a[194:195], v244 offset:28672
  v_mfma_f32_16x16x32_bf16 v[32:35], a[224:227], a[148:151], v[32:35]
  ds_read_b64_tr_b16 a[196:197], v245 offset:24576
  v_mfma_f32_16x16x32_bf16 v[4:7], a[228:231], a[132:135], v[4:7]
  ds_read_b64_tr_b16 a[198:199], v245 offset:28672
  v_mfma_f32_16x16x32_bf16 v[36:39], a[228:231], a[148:151], v[36:39]
  ds_read_b64_tr_b16 a[200:201], v246 offset:24576
  ds_read_b64_tr_b16 a[202:203], v246 offset:28672
  v_mfma_f32_16x16x32_bf16 v[8:11], a[232:235], a[132:135], v[8:11]
  ds_read_b64_tr_b16 a[204:205], v247 offset:24576
  v_mfma_f32_16x16x32_bf16 v[40:43], a[232:235], a[148:151], v[40:43]
  ds_read_b64_tr_b16 a[206:207], v247 offset:28672
  v_mfma_f32_16x16x32_bf16 v[12:15], a[236:239], a[132:135], v[12:15]
  ds_read_b64_tr_b16 a[208:209], v248 offset:24576
  ds_read_b64_tr_b16 a[210:211], v248 offset:28672
  v_mfma_f32_16x16x32_bf16 v[44:47], a[236:239], a[148:151], v[44:47]
  ds_read_b64_tr_b16 a[212:213], v249 offset:24576
  v_mfma_f32_16x16x32_bf16 v[16:19], a[240:243], a[132:135], v[16:19]
  ds_read_b64_tr_b16 a[214:215], v249 offset:28672
  v_mfma_f32_16x16x32_bf16 v[48:51], a[240:243], a[148:151], v[48:51]
  ds_read_b64_tr_b16 a[216:217], v250 offset:24576
  ds_read_b64_tr_b16 a[218:219], v250 offset:28672
  v_mfma_f32_16x16x32_bf16 v[20:23], a[244:247], a[132:135], v[20:23]
  ds_read_b64_tr_b16 a[220:221], v251 offset:24576
  v_mfma_f32_16x16x32_bf16 v[52:55], a[244:247], a[148:151], v[52:55]
  ds_read_b64_tr_b16 a[222:223], v251 offset:28672
  v_mfma_f32_16x16x32_bf16 v[24:27], a[248:251], a[132:135], v[24:27]
  v_mfma_f32_16x16x32_bf16 v[56:59], a[248:251], a[148:151], v[56:59]
  v_mfma_f32_16x16x32_bf16 v[28:31], a[252:255], a[132:135], v[28:31]
  v_mfma_f32_16x16x32_bf16 v[60:63], a[252:255], a[148:151], v[60:63]
  s_waitcnt lgkmcnt(0)
  v_mfma_f32_16x16x32_bf16 v[0:3], a[192:195], a[136:139], v[0:3]
  ds_read_b64_tr_b16 a[224:225], v244 offset:32768
  ds_read_b64_tr_b16 a[226:227], v244 offset:36864
  v_mfma_f32_16x16x32_bf16 v[32:35], a[192:195], a[152:155], v[32:35]
  ds_read_b64_tr_b16 a[228:229], v245 offset:32768
  v_mfma_f32_16x16x32_bf16 v[4:7], a[196:199], a[136:139], v[4:7]
  ds_read_b64_tr_b16 a[230:231], v245 offset:36864
  v_mfma_f32_16x16x32_bf16 v[36:39], a[196:199], a[152:155], v[36:39]
  ds_read_b64_tr_b16 a[232:233], v246 offset:32768
  ds_read_b64_tr_b16 a[234:235], v246 offset:36864
  v_mfma_f32_16x16x32_bf16 v[8:11], a[200:203], a[136:139], v[8:11]
  ds_read_b64_tr_b16 a[236:237], v247 offset:32768
  v_mfma_f32_16x16x32_bf16 v[40:43], a[200:203], a[152:155], v[40:43]
  ds_read_b64_tr_b16 a[238:239], v247 offset:36864
  v_mfma_f32_16x16x32_bf16 v[12:15], a[204:207], a[136:139], v[12:15]
  ds_read_b64_tr_b16 a[240:241], v248 offset:32768
  ds_read_b64_tr_b16 a[242:243], v248 offset:36864
  v_mfma_f32_16x16x32_bf16 v[44:47], a[204:207], a[152:155], v[44:47]
  ds_read_b64_tr_b16 a[244:245], v249 offset:32768
  v_mfma_f32_16x16x32_bf16 v[16:19], a[208:211], a[136:139], v[16:19]
  ds_read_b64_tr_b16 a[246:247], v249 offset:36864
  v_mfma_f32_16x16x32_bf16 v[48:51], a[208:211], a[152:155], v[48:51]
  ds_read_b64_tr_b16 a[248:249], v250 offset:32768
  ds_read_b64_tr_b16 a[250:251], v250 offset:36864
  v_mfma_f32_16x16x32_bf16 v[20:23], a[212:215], a[136:139], v[20:23]
  ds_read_b64_tr_b16 a[252:253], v251 offset:32768
  v_mfma_f32_16x16x32_bf16 v[52:55], a[212:215], a[152:155], v[52:55]
  ds_read_b64_tr_b16 a[254:255], v251 offset:36864
  v_mfma_f32_16x16x32_bf16 v[24:27], a[216:219], a[136:139], v[24:27]
  v_mfma_f32_16x16x32_bf16 v[56:59], a[216:219], a[152:155], v[56:59]
  v_mfma_f32_16x16x32_bf16 v[28:31], a[220:223], a[136:139], v[28:31]
  v_mfma_f32_16x16x32_bf16 v[60:63], a[220:223], a[152:155], v[60:63]
  s_waitcnt lgkmcnt(0)
  v_mfma_f32_16x16x32_bf16 v[0:3], a[224:227], a[140:143], v[0:3]
  v_mfma_f32_16x16x32_bf16 v[32:35], a[224:227], a[156:159], v[32:35]
  v_mfma_f32_16x16x32_bf16 v[4:7], a[228:231], a[140:143], v[4:7]
  v_mfma_f32_16x16x32_bf16 v[36:39], a[228:231], a[156:159], v[36:39]
  v_mfma_f32_16x16x32_bf16 v[8:11], a[232:235], a[140:143], v[8:11]
  v_mfma_f32_16x16x32_bf16 v[40:43], a[232:235], a[156:159], v[40:43]
  v_mfma_f32_16x16x32_bf16 v[12:15], a[236:239], a[140:143], v[12:15]
  v_mfma_f32_16x16x32_bf16 v[44:47], a[236:239], a[156:159], v[44:47]
  v_mfma_f32_16x16x32_bf16 v[16:19], a[240:243], a[140:143], v[16:19]
  v_mfma_f32_16x16x32_bf16 v[48:51], a[240:243], a[156:159], v[48:51]
  v_mfma_f32_16x16x32_bf16 v[20:23], a[244:247], a[140:143], v[20:23]
  v_mfma_f32_16x16x32_bf16 v[52:55], a[244:247], a[156:159], v[52:55]
  v_mfma_f32_16x16x32_bf16 v[24:27], a[248:251], a[140:143], v[24:27]
  v_mfma_f32_16x16x32_bf16 v[56:59], a[248:251], a[156:159], v[56:59]
  v_mfma_f32_16x16x32_bf16 v[28:31], a[252:255], a[140:143], v[28:31]
  v_mfma_f32_16x16x32_bf16 v[60:63], a[252:255], a[156:159], v[60:63]
  s_nop 7
  s_nop 7
  v_cvt_pk_bf16_f32 v128, v0, v1
  v_cvt_pk_bf16_f32 v129, v2, v3
  v_cvt_pk_bf16_f32 v130, v4, v5
  v_cvt_pk_bf16_f32 v131, v6, v7
  v_cvt_pk_bf16_f32 v132, v8, v9
  v_cvt_pk_bf16_f32 v133, v10, v11
  v_cvt_pk_bf16_f32 v134, v12, v13
  v_cvt_pk_bf16_f32 v135, v14, v15
  v_cvt_pk_bf16_f32 v136, v16, v17
  v_cvt_pk_bf16_f32 v137, v18, v19
  v_cvt_pk_bf16_f32 v138, v20, v21
  v_cvt_pk_bf16_f32 v139, v22, v23
  v_cvt_pk_bf16_f32 v140, v24, v25
  v_cvt_pk_bf16_f32 v141, v26, v27
  v_cvt_pk_bf16_f32 v142, v28, v29
  v_cvt_pk_bf16_f32 v143, v30, v31
  v_cvt_pk_bf16_f32 v144, v32, v33
  v_cvt_pk_bf16_f32 v145, v34, v35
  v_cvt_pk_bf16_f32 v146, v36, v37
  v_cvt_pk_bf16_f32 v147, v38, v39
  v_cvt_pk_bf16_f32 v148, v40, v41
  v_cvt_pk_bf16_f32 v149, v42, v43
  v_cvt_pk_bf16_f32 v150, v44, v45
  v_cvt_pk_bf16_f32 v151, v46, v47
  v_cvt_pk_bf16_f32 v152, v48, v49
  v_cvt_pk_bf16_f32 v153, v50, v51
  v_cvt_pk_bf16_f32 v154, v52, v53
  v_cvt_pk_bf16_f32 v155, v54, v55
  v_cvt_pk_bf16_f32 v156, v56, v57
  v_cvt_pk_bf16_f32 v157, v58, v59
  v_cvt_pk_bf16_f32 v158, v60, v61
  v_cvt_pk_bf16_f32 v159, v62, v63
  s_add_u32 s39, s77, 0
  buffer_store_dwordx4 v[128:131], v204, s[60:63], s39 offen offset:0 sc1
  buffer_store_dwordx4 v[132:135], v204, s[60:63], s39 offen offset:1024 sc1
  buffer_store_dwordx4 v[136:139], v204, s[60:63], s39 offen offset:2048 sc1
  buffer_store_dwordx4 v[140:143], v204, s[60:63], s39 offen offset:3072 sc1
  s_add_u32 s39, s77, 4096
  buffer_store_dwordx4 v[144:147], v204, s[60:63], s39 offen offset:0 sc1
  buffer_store_dwordx4 v[148:151], v204, s[60:63], s39 offen offset:1024 sc1
  buffer_store_dwordx4 v[152:155], v204, s[60:63], s39 offen offset:2048 sc1
  buffer_store_dwordx4 v[156:159], v204, s[60:63], s39 offen offset:3072 sc1
  s_waitcnt vmcnt(0)
  s_barrier
  s_lshl_b32 s38, s2, 7
  s_add_u32 s38, s38, 131072
  v_mov_b32 v126, s38
  s_mov_b64 s[42:43], exec
  s_mov_b64 exec, 1
  buffer_store_dwordx2 v[120:121], v126, s[60:63], 0 offen sc1
  s_mov_b64 exec, s[42:43]
  v_add_u32 v126, 131072, v224
  s_mov_b64 s[42:43], exec
  s_mov_b64 exec, 255
  s_mov_b32 s37, 0
  buffer_load_dwordx2 v[214:215], v126, s[60:63], 0 offen sc1
  buffer_load_dwordx2 v[216:217], v126, s[60:63], 0 offen sc1
  buffer_load_dwordx2 v[218:219], v126, s[60:63], 0 offen sc1
L_poll11:
  buffer_load_dwordx2 v[220:221], v126, s[60:63], 0 offen sc1
  s_waitcnt vmcnt(3)
  v_cmp_ne_u64 vcc, s[40:41], v[214:215]
  s_nop 4
  s_cbranch_vccz L_polld12
  buffer_load_dwordx2 v[214:215], v126, s[60:63], 0 offen sc1
  s_waitcnt vmcnt(3)
  v_cmp_ne_u64 vcc, s[40:41], v[216:217]
  s_nop 4
  s_cbranch_vccz L_polld12
  buffer_load_dwordx2 v[216:217], v126, s[60:63], 0 offen sc1
  s_waitcnt vmcnt(3)
  v_cmp_ne_u64 vcc, s[40:41], v[218:219]
  s_nop 4
  s_cbranch_vccz L_polld12
  buffer_load_dwordx2 v[218:219], v126, s[60:63], 0 offen sc1
  s_waitcnt vmcnt(3)
  v_cmp_ne_u64 vcc, s[40:41], v[220:221]
  s_nop 4
  s_cbranch_vccz L_polld12
  s_add_u32 s37, s37, 1
  s_cmp_gt_u32 s37, 0x10000
  s_cbranch_scc0 L_poll11
L_polld12:
  s_mov_b64 exec, s[42:43]
  s_barrier
  s_lshl_b32 s38, s2, 7
  s_add_u32 s38, s38, 196608
  v_mov_b32 v126, s38
  s_mov_b64 s[42:43], exec
  s_mov_b64 exec, 1
  buffer_store_dwordx2 v[120:121], v126, s[60:63], 0 offen sc1
  s_mov_b64 exec, s[42:43]
  s_add_u32 s39, s81, 0
  buffer_load_dwordx4 v[0:3], v226, s[60:63], s39 offen sc1
  s_add_u32 s39, s81, 65536
  buffer_load_dwordx4 v[4:7], v226, s[60:63], s39 offen sc1
  s_add_u32 s39, s81, 131072
  buffer_load_dwordx4 v[8:11], v226, s[60:63], s39 offen sc1
  s_add_u32 s39, s81, 196608
  buffer_load_dwordx4 v[12:15], v226, s[60:63], s39 offen sc1
  s_add_u32 s39, s81, 262144
  buffer_load_dwordx4 v[16:19], v226, s[60:63], s39 offen sc1
  s_add_u32 s39, s81, 327680
  buffer_load_dwordx4 v[20:23], v226, s[60:63], s39 offen sc1
  s_add_u32 s39, s81, 393216
  buffer_load_dwordx4 v[24:27], v226, s[60:63], s39 offen sc1
  s_add_u32 s39, s81, 458752
  buffer_load_dwordx4 v[28:31], v226, s[60:63], s39 offen sc1
  v_add_u32 v126, 196608, v224
  s_mov_b64 s[42:43], exec
  s_mov_b64 exec, 255
  s_mov_b32 s37, 0
  buffer_load_dwordx2 v[214:215], v126, s[60:63], 0 offen sc1
  buffer_load_dwordx2 v[216:217], v126, s[60:63], 0 offen sc1
  buffer_load_dwordx2 v[218:219], v126, s[60:63], 0 offen sc1
L_poll13:
  buffer_load_dwordx2 v[220:221], v126, s[60:63], 0 offen sc1
  s_waitcnt vmcnt(3)
  v_cmp_ne_u64 vcc, s[40:41], v[214:215]
  s_nop 4
  s_cbranch_vccz L_polld14
  buffer_load_dwordx2 v[214:215], v126, s[60:63], 0 offen sc1
  s_waitcnt vmcnt(3)
  v_cmp_ne_u64 vcc, s[40:41], v[216:217]
  s_nop 4
  s_cbranch_vccz L_polld14
  buffer_load_dwordx2 v[216:217], v126, s[60:63], 0 offen sc1
  s_waitcnt vmcnt(3)
  v_cmp_ne_u64 vcc, s[40:41], v[218:219]
  s_nop 4
  s_cbranch_vccz L_polld14
  buffer_load_dwordx2 v[218:219], v126, s[60:63], 0 offen sc1
  s_waitcnt vmcnt(3)
  v_cmp_ne_u64 vcc, s[40:41], v[220:221]
  s_nop 4
  s_cbranch_vccz L_polld14
  s_add_u32 s37, s37, 1
  s_cmp_gt_u32 s37, 0x10000
  s_cbranch_scc0 L_poll13
L_polld14:
  s_mov_b64 exec, s[42:43]
  s_barrier
  s_waitcnt vmcnt(4)
  v_dot2_f32_bf16 v176, v0, s83, 0
  v_dot2_f32_bf16 v180, v0, s84, 0
  v_dot2_f32_bf16 v177, v1, s83, 0
  v_dot2_f32_bf16 v181, v1, s84, 0
  v_dot2_f32_bf16 v178, v2, s83, 0
  v_dot2_f32_bf16 v182, v2, s84, 0
  v_dot2_f32_bf16 v179, v3, s83, 0
  v_dot2_f32_bf16 v183, v3, s84, 0
  v_dot2_f32_bf16 v176, v4, s83, v176
  v_dot2_f32_bf16 v180, v4, s84, v180
  v_dot2_f32_bf16 v177, v5, s83, v177
  v_dot2_f32_bf16 v181, v5, s84, v181
  v_dot2_f32_bf16 v178, v6, s83, v178
  v_dot2_f32_bf16 v182, v6, s84, v182
  v_dot2_f32_bf16 v179, v7, s83, v179
  v_dot2_f32_bf16 v183, v7, s84, v183
  v_dot2_f32_bf16 v176, v8, s83, v176
  v_dot2_f32_bf16 v180, v8, s84, v180
  v_dot2_f32_bf16 v177, v9, s83, v177
  v_dot2_f32_bf16 v181, v9, s84, v181
  v_dot2_f32_bf16 v178, v10, s83, v178
  v_dot2_f32_bf16 v182, v10, s84, v182
  v_dot2_f32_bf16 v179, v11, s83, v179
  v_dot2_f32_bf16 v183, v11, s84, v183
  v_dot2_f32_bf16 v176, v12, s83, v176
  v_dot2_f32_bf16 v180, v12, s84, v180
  v_dot2_f32_bf16 v177, v13, s83, v177
  v_dot2_f32_bf16 v181, v13, s84, v181
  v_dot2_f32_bf16 v178, v14, s83, v178
  v_dot2_f32_bf16 v182, v14, s84, v182
  v_dot2_f32_bf16 v179, v15, s83, v179
  v_dot2_f32_bf16 v183, v15, s84, v183
  s_waitcnt vmcnt(0)
  v_dot2_f32_bf16 v176, v16, s83, v176
  v_dot2_f32_bf16 v180, v16, s84, v180
  v_dot2_f32_bf16 v177, v17, s83, v177
  v_dot2_f32_bf16 v181, v17, s84, v181
  v_dot2_f32_bf16 v178, v18, s83, v178
  v_dot2_f32_bf16 v182, v18, s84, v182
  v_dot2_f32_bf16 v179, v19, s83, v179
  v_dot2_f32_bf16 v183, v19, s84, v183
  v_dot2_f32_bf16 v176, v20, s83, v176
  v_dot2_f32_bf16 v180, v20, s84, v180
  v_dot2_f32_bf16 v177, v21, s83, v177
  v_dot2_f32_bf16 v181, v21, s84, v181
  v_dot2_f32_bf16 v178, v22, s83, v178
  v_dot2_f32_bf16 v182, v22, s84, v182
  v_dot2_f32_bf16 v179, v23, s83, v179
  v_dot2_f32_bf16 v183, v23, s84, v183
  v_dot2_f32_bf16 v176, v24, s83, v176
  v_dot2_f32_bf16 v180, v24, s84, v180
  v_dot2_f32_bf16 v177, v25, s83, v177
  v_dot2_f32_bf16 v181, v25, s84, v181
  v_dot2_f32_bf16 v178, v26, s83, v178
  v_dot2_f32_bf16 v182, v26, s84, v182
  v_dot2_f32_bf16 v179, v27, s83, v179
  v_dot2_f32_bf16 v183, v27, s84, v183
  v_dot2_f32_bf16 v176, v28, s83, v176
  v_dot2_f32_bf16 v180, v28, s84, v180
  v_dot2_f32_bf16 v177, v29, s83, v177
  v_dot2_f32_bf16 v181, v29, s84, v181
  v_dot2_f32_bf16 v178, v30, s83, v178
  v_dot2_f32_bf16 v182, v30, s84, v182
  v_dot2_f32_bf16 v179, v31, s83, v179
  v_dot2_f32_bf16 v183, v31, s84, v183
  s_nop 1
  v_cvt_pk_bf16_f32 v228, v176, v180
  v_cvt_pk_bf16_f32 v229, v177, v181
  v_cvt_pk_bf16_f32 v230, v178, v182
  v_cvt_pk_bf16_f32 v231, v179, v183
  s_nop 1
  v_permlane16_swap_b32 v228, v230
  v_permlane16_swap_b32 v229, v231
  s_add_u32 s39, s82, 0
  buffer_store_dwordx4 v[228:231], v225, s[64:67], s39 offen
  s_cmp_ge_u32 s34, 6
  s_cbranch_scc1 L_fin_LW
  s_add_u32 s39, s81, 8192
  buffer_load_dwordx4 v[32:35], v226, s[60:63], s39 offen sc1
  s_add_u32 s39, s81, 73728
  buffer_load_dwordx4 v[36:39], v226, s[60:63], s39 offen sc1
  s_add_u32 s39, s81, 139264
  buffer_load_dwordx4 v[40:43], v226, s[60:63], s39 offen sc1
  s_add_u32 s39, s81, 204800
  buffer_load_dwordx4 v[44:47], v226, s[60:63], s39 offen sc1
  s_add_u32 s39, s81, 270336
  buffer_load_dwordx4 v[48:51], v226, s[60:63], s39 offen sc1
  s_add_u32 s39, s81, 335872
  buffer_load_dwordx4 v[52:55], v226, s[60:63], s39 offen sc1
  s_add_u32 s39, s81, 401408
  buffer_load_dwordx4 v[56:59], v226, s[60:63], s39 offen sc1
  s_add_u32 s39, s81, 466944
  buffer_load_dwordx4 v[60:63], v226, s[60:63], s39 offen sc1
  s_waitcnt vmcnt(4)
  v_dot2_f32_bf16 v184, v32, s83, 0
  v_dot2_f32_bf16 v188, v32, s84, 0
  v_dot2_f32_bf16 v185, v33, s83, 0
  v_dot2_f32_bf16 v189, v33, s84, 0
  v_dot2_f32_bf16 v186, v34, s83, 0
  v_dot2_f32_bf16 v190, v34, s84, 0
  v_dot2_f32_bf16 v187, v35, s83, 0
  v_dot2_f32_bf16 v191, v35, s84, 0
  v_dot2_f32_bf16 v184, v36, s83, v184
  v_dot2_f32_bf16 v188, v36, s84, v188
  v_dot2_f32_bf16 v185, v37, s83, v185
  v_dot2_f32_bf16 v189, v37, s84, v189
  v_dot2_f32_bf16 v186, v38, s83, v186
  v_dot2_f32_bf16 v190, v38, s84, v190
  v_dot2_f32_bf16 v187, v39, s83, v187
  v_dot2_f32_bf16 v191, v39, s84, v191
  v_dot2_f32_bf16 v184, v40, s83, v184
  v_dot2_f32_bf16 v188, v40, s84, v188
  v_dot2_f32_bf16 v185, v41, s83, v185
  v_dot2_f32_bf16 v189, v41, s84, v189
  v_dot2_f32_bf16 v186, v42, s83, v186
  v_dot2_f32_bf16 v190, v42, s84, v190
  v_dot2_f32_bf16 v187, v43, s83, v187
  v_dot2_f32_bf16 v191, v43, s84, v191
  v_dot2_f32_bf16 v184, v44, s83, v184
  v_dot2_f32_bf16 v188, v44, s84, v188
  v_dot2_f32_bf16 v185, v45, s83, v185
  v_dot2_f32_bf16 v189, v45, s84, v189
  v_dot2_f32_bf16 v186, v46, s83, v186
  v_dot2_f32_bf16 v190, v46, s84, v190
  v_dot2_f32_bf16 v187, v47, s83, v187
  v_dot2_f32_bf16 v191, v47, s84, v191
  s_waitcnt vmcnt(0)
  v_dot2_f32_bf16 v184, v48, s83, v184
  v_dot2_f32_bf16 v188, v48, s84, v188
  v_dot2_f32_bf16 v185, v49, s83, v185
  v_dot2_f32_bf16 v189, v49, s84, v189
  v_dot2_f32_bf16 v186, v50, s83, v186
  v_dot2_f32_bf16 v190, v50, s84, v190
  v_dot2_f32_bf16 v187, v51, s83, v187
  v_dot2_f32_bf16 v191, v51, s84, v191
  v_dot2_f32_bf16 v184, v52, s83, v184
  v_dot2_f32_bf16 v188, v52, s84, v188
  v_dot2_f32_bf16 v185, v53, s83, v185
  v_dot2_f32_bf16 v189, v53, s84, v189
  v_dot2_f32_bf16 v186, v54, s83, v186
  v_dot2_f32_bf16 v190, v54, s84, v190
  v_dot2_f32_bf16 v187, v55, s83, v187
  v_dot2_f32_bf16 v191, v55, s84, v191
  v_dot2_f32_bf16 v184, v56, s83, v184
  v_dot2_f32_bf16 v188, v56, s84, v188
  v_dot2_f32_bf16 v185, v57, s83, v185
  v_dot2_f32_bf16 v189, v57, s84, v189
  v_dot2_f32_bf16 v186, v58, s83, v186
  v_dot2_f32_bf16 v190, v58, s84, v190
  v_dot2_f32_bf16 v187, v59, s83, v187
  v_dot2_f32_bf16 v191, v59, s84, v191
  v_dot2_f32_bf16 v184, v60, s83, v184
  v_dot2_f32_bf16 v188, v60, s84, v188
  v_dot2_f32_bf16 v185, v61, s83, v185
  v_dot2_f32_bf16 v189, v61, s84, v189
  v_dot2_f32_bf16 v186, v62, s83, v186
  v_dot2_f32_bf16 v190, v62, s84, v190
  v_dot2_f32_bf16 v187, v63, s83, v187
  v_dot2_f32_bf16 v191, v63, s84, v191
  s_nop 1
  v_cvt_pk_bf16_f32 v232, v184, v188
  v_cvt_pk_bf16_f32 v233, v185, v189
  v_cvt_pk_bf16_f32 v234, v186, v190
  v_cvt_pk_bf16_f32 v235, v187, v191
  s_nop 1
  v_permlane16_swap_b32 v232, v234
  v_permlane16_swap_b32 v233, v235
  s_add_u32 s39, s82, 32768
  buffer_store_dwordx4 v[232:235], v225, s[64:67], s39 offen
L_fin_LW:
  s_branch L_end
L_slow_CW:
  s_mov_b32 s38, 147456
  s_cmp_eq_u32 s30, 1
  s_cselect_b32 s38, 98304, s38
  s_cmp_eq_u32 s30, 2
  s_cselect_b32 s38, 106496, s38
  s_cmp_eq_u32 s30, 3
  s_cselect_b32 s38, 114688, s38
  s_sub_u32 s39, s38, 98304
  v_add_u32 v214, s39, v240
  v_add_u32 v215, s39, v241
  v_add_u32 v216, s39, v242
  v_add_u32 v217, s39, v243
  v_add_u32 v176, s39, v244
  v_add_u32 v177, s39, v245
  v_add_u32 v178, s39, v246
  v_add_u32 v179, s39, v247
  v_add_u32 v180, s39, v248
  v_add_u32 v181, s39, v249
  v_add_u32 v182, s39, v250
  v_add_u32 v183, s39, v251
  v_mov_b32 v0, 0
  v_mov_b32 v1, 0
  v_mov_b32 v2, 0
  v_mov_b32 v3, 0
  v_mov_b32 v4, 0
  v_mov_b32 v5, 0
  v_mov_b32 v6, 0
  v_mov_b32 v7, 0
  v_mov_b32 v8, 0
  v_mov_b32 v9, 0
  v_mov_b32 v10, 0
  v_mov_b32 v11, 0
  v_mov_b32 v12, 0
  v_mov_b32 v13, 0
  v_mov_b32 v14, 0
  v_mov_b32 v15, 0
  v_mov_b32 v16, 0
  v_mov_b32 v17, 0
  v_mov_b32 v18, 0
  v_mov_b32 v19, 0
  v_mov_b32 v20, 0
  v_mov_b32 v21, 0
  v_mov_b32 v22, 0
  v_mov_b32 v23, 0
  v_mov_b32 v24, 0
  v_mov_b32 v25, 0
  v_mov_b32 v26, 0
  v_mov_b32 v27, 0
  v_mov_b32 v28, 0
  v_mov_b32 v29, 0
  v_mov_b32 v30, 0
  v_mov_b32 v31, 0
  v_mov_b32 v32, 0
  v_mov_b32 v33, 0
  v_mov_b32 v34, 0
  v_mov_b32 v35, 0
  v_mov_b32 v36, 0
  v_mov_b32 v37, 0
  v_mov_b32 v38, 0
  v_mov_b32 v39, 0
  v_mov_b32 v40, 0
  v_mov_b32 v41, 0
  v_mov_b32 v42, 0
  v_mov_b32 v43, 0
  v_mov_b32 v44, 0
  v_mov_b32 v45, 0
  v_mov_b32 v46, 0
  v_mov_b32 v47, 0
  v_mov_b32 v48, 0
  v_mov_b32 v49, 0
  v_mov_b32 v50, 0
  v_mov_b32 v51, 0
  v_mov_b32 v52, 0
  v_mov_b32 v53, 0
  v_mov_b32 v54, 0
  v_mov_b32 v55, 0
  v_mov_b32 v56, 0
  v_mov_b32 v57, 0
  v_mov_b32 v58, 0
  v_mov_b32 v59, 0
  v_mov_b32 v60, 0
  v_mov_b32 v61, 0
  v_mov_b32 v62, 0
  v_mov_b32 v63, 0
  v_mov_b32 v64, 0
  v_mov_b32 v65, 0
  v_mov_b32 v66, 0
  v_mov_b32 v67, 0
  v_mov_b32 v68, 0
  v_mov_b32 v69, 0
  v_mov_b32 v70, 0
  v_mov_b32 v71, 0
  v_mov_b32 v72, 0
  v_mov_b32 v73, 0
  v_mov_b32 v74, 0
  v_mov_b32 v75, 0
  v_mov_b32 v76, 0
  v_mov_b32 v77, 0
  v_mov_b32 v78, 0
  v_mov_b32 v79, 0
  v_mov_b32 v80, 0
  v_mov_b32 v81, 0
  v_mov_b32 v82, 0
  v_mov_b32 v83, 0
  v_mov_b32 v84, 0
  v_mov_b32 v85, 0
  v_mov_b32 v86, 0
  v_mov_b32 v87, 0
  v_mov_b32 v88, 0
  v_mov_b32 v89, 0
  v_mov_b32 v90, 0
  v_mov_b32 v91, 0
  v_mov_b32 v92, 0
  v_mov_b32 v93, 0
  v_mov_b32 v94, 0
  v_mov_b32 v95, 0
  v_mov_b32 v96, 0
  v_mov_b32 v97, 0
  v_mov_b32 v98, 0
  v_mov_b32 v99, 0
  v_mov_b32 v100, 0
  v_mov_b32 v101, 0
  v_mov_b32 v102, 0
  v_mov_b32 v103, 0
  v_mov_b32 v104, 0
  v_mov_b32 v105, 0
  v_mov_b32 v106, 0
  v_mov_b32 v107, 0
  v_mov_b32 v108, 0
  v_mov_b32 v109, 0
  v_mov_b32 v110, 0
  v_mov_b32 v111, 0
  v_mov_b32 v112, 0
  v_mov_b32 v113, 0
  v_mov_b32 v114, 0
  v_mov_b32 v115, 0
  v_mov_b32 v116, 0
  v_mov_b32 v117, 0
  v_mov_b32 v118, 0
  v_mov_b32 v119, 0
  v_mov_b32 v120, 0
  v_mov_b32 v121, 0
  v_mov_b32 v122, 0
  v_mov_b32 v123, 0
  v_mov_b32 v124, 0
  v_mov_b32 v125, 0
  v_mov_b32 v126, 0
  v_mov_b32 v127, 0
  v_mov_b32 v238, 0
  v_mov_b32 v184, 0xff800000
  v_mov_b32 v239, 0
  v_mov_b32 v185, 0xff800000
  v_mov_b32 v222, 0
  v_mov_b32 v186, 0xff800000
  v_mov_b32 v223, 0
  v_mov_b32 v187, 0xff800000
  s_mov_b32 s88, 0
L_slowl_CW:
  s_add_u32 m0, s38, 0
  s_add_u32 s39, s88, 0
  buffer_load_dwordx4 v228, s[12:15], s39 offen offset:0 lds
  buffer_load_dwordx4 v229, s[12:15], s39 offen offset:1024 lds
  buffer_load_dwordx4 v230, s[12:15], s39 offen offset:2048 lds
  buffer_load_dwordx4 v231, s[12:15], s39 offen offset:3072 lds
  s_add_u32 m0, s38, 4096
  s_add_u32 s39, s88, 4096
  buffer_load_dwordx4 v228, s[12:15], s39 offen offset:0 lds
  buffer_load_dwordx4 v229, s[12:15], s39 offen offset:1024 lds
  buffer_load_dwordx4 v230, s[12:15], s39 offen offset:2048 lds
  buffer_load_dwordx4 v231, s[12:15], s39 offen offset:3072 lds
  s_waitcnt vmcnt(0)
  ds_read_b128 a[192:195], v214 offset:0
  ds_read_b128 a[196:199], v215 offset:0
  ds_read_b128 a[200:203], v216 offset:0
  ds_read_b128 a[204:207], v217 offset:0
  ds_read_b128 a[208:211], v214 offset:4096
  ds_read_b128 a[212:215], v215 offset:4096
  ds_read_b128 a[216:219], v216 offset:4096
  ds_read_b128 a[220:223], v217 offset:4096
  s_waitcnt lgkmcnt(0)
  s_add_u32 m0, s38, 0
  s_add_u32 s39, s88, 0
  buffer_load_dwordx4 v232, s[16:19], s39 offen offset:0 lds
  buffer_load_dwordx4 v233, s[16:19], s39 offen offset:1024 lds
  buffer_load_dwordx4 v232, s[16:19], s39 offen offset:2048 lds
  buffer_load_dwordx4 v233, s[16:19], s39 offen offset:3072 lds
  s_add_u32 m0, s38, 4096
  s_add_u32 s39, s88, 4096
  buffer_load_dwordx4 v232, s[16:19], s39 offen offset:0 lds
  buffer_load_dwordx4 v233, s[16:19], s39 offen offset:1024 lds
  buffer_load_dwordx4 v232, s[16:19], s39 offen offset:2048 lds
  buffer_load_dwordx4 v233, s[16:19], s39 offen offset:3072 lds
  s_waitcnt vmcnt(0)
  ds_read_b64_tr_b16 a[224:225], v176 offset:0
  ds_read_b64_tr_b16 a[226:227], v176 offset:4096
  ds_read_b64_tr_b16 a[228:229], v177 offset:0
  ds_read_b64_tr_b16 a[230:231], v177 offset:4096
  ds_read_b64_tr_b16 a[232:233], v178 offset:0
  ds_read_b64_tr_b16 a[234:235], v178 offset:4096
  ds_read_b64_tr_b16 a[236:237], v179 offset:0
  ds_read_b64_tr_b16 a[238:239], v179 offset:4096
  ds_read_b64_tr_b16 a[240:241], v180 offset:0
  ds_read_b64_tr_b16 a[242:243], v180 offset:4096
  ds_read_b64_tr_b16 a[244:245], v181 offset:0
  ds_read_b64_tr_b16 a[246:247], v181 offset:4096
  ds_read_b64_tr_b16 a[248:249], v182 offset:0
  ds_read_b64_tr_b16 a[250:251], v182 offset:4096
  ds_read_b64_tr_b16 a[252:253], v183 offset:0
  ds_read_b64_tr_b16 a[254:255], v183 offset:4096
  v_mfma_f32_16x16x32_bf16 v[128:131], a[192:195], a[128:131], 0
  v_mfma_f32_16x16x32_bf16 v[136:139], a[192:195], a[144:147], 0
  v_mfma_f32_16x16x32_bf16 v[128:131], a[196:199], a[132:135], v[128:131]
  v_mfma_f32_16x16x32_bf16 v[136:139], a[196:199], a[148:151], v[136:139]
  v_mfma_f32_16x16x32_bf16 v[128:131], a[200:203], a[136:139], v[128:131]
  v_mfma_f32_16x16x32_bf16 v[136:139], a[200:203], a[152:155], v[136:139]
  v_mfma_f32_16x16x32_bf16 v[128:131], a[204:207], a[140:143], v[128:131]
  v_mfma_f32_16x16x32_bf16 v[136:139], a[204:207], a[156:159], v[136:139]
  v_mfma_f32_16x16x32_bf16 v[132:135], a[208:211], a[128:131], 0
  v_mfma_f32_16x16x32_bf16 v[140:143], a[208:211], a[144:147], 0
  v_mfma_f32_16x16x32_bf16 v[132:135], a[212:215], a[132:135], v[132:135]
  v_mfma_f32_16x16x32_bf16 v[140:143], a[212:215], a[148:151], v[140:143]
  v_mfma_f32_16x16x32_bf16 v[132:135], a[216:219], a[136:139], v[132:135]
  v_mfma_f32_16x16x32_bf16 v[140:143], a[216:219], a[152:155], v[140:143]
  v_mfma_f32_16x16x32_bf16 v[132:135], a[220:223], a[140:143], v[132:135]
  v_mfma_f32_16x16x32_bf16 v[140:143], a[220:223], a[156:159], v[140:143]
  s_nop 15
  v_max3_f32 v188, v128, v129, v130
  v_max3_f32 v188, v188, v131, v132
  v_max3_f32 v188, v188, v133, v134
  v_max_f32 v188, v188, v135
  v_mov_b32 v189, v188
  s_nop 1
  v_permlane16_swap_b32 v188, v189
  v_max_f32 v188, v188, v189
  v_mov_b32 v189, v188
  s_nop 1
  v_permlane32_swap_b32 v188, v189
  v_max_f32 v188, v188, v189
  v_max_f32 v188, v188, v184
  v_sub_f32 v189, v184, v188
  v_exp_f32 v189, v189
  v_mov_b32 v184, v188
  v_sub_f32 v128, v128, v188
  v_sub_f32 v129, v129, v188
  v_sub_f32 v130, v130, v188
  v_sub_f32 v131, v131, v188
  v_sub_f32 v132, v132, v188
  v_sub_f32 v133, v133, v188
  v_sub_f32 v134, v134, v188
  v_sub_f32 v135, v135, v188
  v_exp_f32 v128, v128
  v_exp_f32 v129, v129
  v_exp_f32 v130, v130
  v_exp_f32 v131, v131
  v_exp_f32 v132, v132
  v_exp_f32 v133, v133
  v_exp_f32 v134, v134
  v_exp_f32 v135, v135
  v_mul_f32 v238, v238, v189
  v_add_f32 v238, v238, v128
  v_add_f32 v238, v238, v129
  v_add_f32 v238, v238, v130
  v_add_f32 v238, v238, v131
  v_add_f32 v238, v238, v132
  v_add_f32 v238, v238, v133
  v_add_f32 v238, v238, v134
  v_add_f32 v238, v238, v135
  v_cvt_pk_bf16_f32 v160, v128, v129
  v_cvt_pk_bf16_f32 v161, v130, v131
  v_cvt_pk_bf16_f32 v162, v132, v133
  v_cvt_pk_bf16_f32 v163, v134, v135
  v_mul_f32 v0, v0, v189
  v_mul_f32 v1, v1, v189
  v_mul_f32 v2, v2, v189
  v_mul_f32 v3, v3, v189
  v_mul_f32 v4, v4, v189
  v_mul_f32 v5, v5, v189
  v_mul_f32 v6, v6, v189
  v_mul_f32 v7, v7, v189
  v_mul_f32 v8, v8, v189
  v_mul_f32 v9, v9, v189
  v_mul_f32 v10, v10, v189
  v_mul_f32 v11, v11, v189
  v_mul_f32 v12, v12, v189
  v_mul_f32 v13, v13, v189
  v_mul_f32 v14, v14, v189
  v_mul_f32 v15, v15, v189
  v_mul_f32 v16, v16, v189
  v_mul_f32 v17, v17, v189
  v_mul_f32 v18, v18, v189
  v_mul_f32 v19, v19, v189
  v_mul_f32 v20, v20, v189
  v_mul_f32 v21, v21, v189
  v_mul_f32 v22, v22, v189
  v_mul_f32 v23, v23, v189
  v_mul_f32 v24, v24, v189
  v_mul_f32 v25, v25, v189
  v_mul_f32 v26, v26, v189
  v_mul_f32 v27, v27, v189
  v_mul_f32 v28, v28, v189
  v_mul_f32 v29, v29, v189
  v_mul_f32 v30, v30, v189
  v_mul_f32 v31, v31, v189
  v_max3_f32 v188, v136, v137, v138
  v_max3_f32 v188, v188, v139, v140
  v_max3_f32 v188, v188, v141, v142
  v_max_f32 v188, v188, v143
  v_mov_b32 v189, v188
  s_nop 1
  v_permlane16_swap_b32 v188, v189
  v_max_f32 v188, v188, v189
  v_mov_b32 v189, v188
  s_nop 1
  v_permlane32_swap_b32 v188, v189
  v_max_f32 v188, v188, v189
  v_max_f32 v188, v188, v185
  v_sub_f32 v189, v185, v188
  v_exp_f32 v189, v189
  v_mov_b32 v185, v188
  v_sub_f32 v136, v136, v188
  v_sub_f32 v137, v137, v188
  v_sub_f32 v138, v138, v188
  v_sub_f32 v139, v139, v188
  v_sub_f32 v140, v140, v188
  v_sub_f32 v141, v141, v188
  v_sub_f32 v142, v142, v188
  v_sub_f32 v143, v143, v188
  v_exp_f32 v136, v136
  v_exp_f32 v137, v137
  v_exp_f32 v138, v138
  v_exp_f32 v139, v139
  v_exp_f32 v140, v140
  v_exp_f32 v141, v141
  v_exp_f32 v142, v142
  v_exp_f32 v143, v143
  v_mul_f32 v239, v239, v189
  v_add_f32 v239, v239, v136
  v_add_f32 v239, v239, v137
  v_add_f32 v239, v239, v138
  v_add_f32 v239, v239, v139
  v_add_f32 v239, v239, v140
  v_add_f32 v239, v239, v141
  v_add_f32 v239, v239, v142
  v_add_f32 v239, v239, v143
  v_cvt_pk_bf16_f32 v164, v136, v137
  v_cvt_pk_bf16_f32 v165, v138, v139
  v_cvt_pk_bf16_f32 v166, v140, v141
  v_cvt_pk_bf16_f32 v167, v142, v143
  v_mul_f32 v32, v32, v189
  v_mul_f32 v33, v33, v189
  v_mul_f32 v34, v34, v189
  v_mul_f32 v35, v35, v189
  v_mul_f32 v36, v36, v189
  v_mul_f32 v37, v37, v189
  v_mul_f32 v38, v38, v189
  v_mul_f32 v39, v39, v189
  v_mul_f32 v40, v40, v189
  v_mul_f32 v41, v41, v189
  v_mul_f32 v42, v42, v189
  v_mul_f32 v43, v43, v189
  v_mul_f32 v44, v44, v189
  v_mul_f32 v45, v45, v189
  v_mul_f32 v46, v46, v189
  v_mul_f32 v47, v47, v189
  v_mul_f32 v48, v48, v189
  v_mul_f32 v49, v49, v189
  v_mul_f32 v50, v50, v189
  v_mul_f32 v51, v51, v189
  v_mul_f32 v52, v52, v189
  v_mul_f32 v53, v53, v189
  v_mul_f32 v54, v54, v189
  v_mul_f32 v55, v55, v189
  v_mul_f32 v56, v56, v189
  v_mul_f32 v57, v57, v189
  v_mul_f32 v58, v58, v189
  v_mul_f32 v59, v59, v189
  v_mul_f32 v60, v60, v189
  v_mul_f32 v61, v61, v189
  v_mul_f32 v62, v62, v189
  v_mul_f32 v63, v63, v189
  v_mfma_f32_16x16x32_bf16 v[144:147], a[192:195], a[160:163], 0
  v_mfma_f32_16x16x32_bf16 v[152:155], a[192:195], a[176:179], 0
  v_mfma_f32_16x16x32_bf16 v[144:147], a[196:199], a[164:167], v[144:147]
  v_mfma_f32_16x16x32_bf16 v[152:155], a[196:199], a[180:183], v[152:155]
  v_mfma_f32_16x16x32_bf16 v[144:147], a[200:203], a[168:171], v[144:147]
  v_mfma_f32_16x16x32_bf16 v[152:155], a[200:203], a[184:187], v[152:155]
  v_mfma_f32_16x16x32_bf16 v[144:147], a[204:207], a[172:175], v[144:147]
  v_mfma_f32_16x16x32_bf16 v[152:155], a[204:207], a[188:191], v[152:155]
  v_mfma_f32_16x16x32_bf16 v[148:151], a[208:211], a[160:163], 0
  v_mfma_f32_16x16x32_bf16 v[156:159], a[208:211], a[176:179], 0
  v_mfma_f32_16x16x32_bf16 v[148:151], a[212:215], a[164:167], v[148:151]
  v_mfma_f32_16x16x32_bf16 v[156:159], a[212:215], a[180:183], v[156:159]
  v_mfma_f32_16x16x32_bf16 v[148:151], a[216:219], a[168:171], v[148:151]
  v_mfma_f32_16x16x32_bf16 v[156:159], a[216:219], a[184:187], v[156:159]
  v_mfma_f32_16x16x32_bf16 v[148:151], a[220:223], a[172:175], v[148:151]
  v_mfma_f32_16x16x32_bf16 v[156:159], a[220:223], a[188:191], v[156:159]
  s_nop 15
  v_max3_f32 v188, v144, v145, v146
  v_max3_f32 v188, v188, v147, v148
  v_max3_f32 v188, v188, v149, v150
  v_max_f32 v188, v188, v151
  v_mov_b32 v189, v188
  s_nop 1
  v_permlane16_swap_b32 v188, v189
  v_max_f32 v188, v188, v189
  v_mov_b32 v189, v188
  s_nop 1
  v_permlane32_swap_b32 v188, v189
  v_max_f32 v188, v188, v189
  v_max_f32 v188, v188, v186
  v_sub_f32 v189, v186, v188
  v_exp_f32 v189, v189
  v_mov_b32 v186, v188
  v_sub_f32 v144, v144, v188
  v_sub_f32 v145, v145, v188
  v_sub_f32 v146, v146, v188
  v_sub_f32 v147, v147, v188
  v_sub_f32 v148, v148, v188
  v_sub_f32 v149, v149, v188
  v_sub_f32 v150, v150, v188
  v_sub_f32 v151, v151, v188
  v_exp_f32 v144, v144
  v_exp_f32 v145, v145
  v_exp_f32 v146, v146
  v_exp_f32 v147, v147
  v_exp_f32 v148, v148
  v_exp_f32 v149, v149
  v_exp_f32 v150, v150
  v_exp_f32 v151, v151
  v_mul_f32 v222, v222, v189
  v_add_f32 v222, v222, v144
  v_add_f32 v222, v222, v145
  v_add_f32 v222, v222, v146
  v_add_f32 v222, v222, v147
  v_add_f32 v222, v222, v148
  v_add_f32 v222, v222, v149
  v_add_f32 v222, v222, v150
  v_add_f32 v222, v222, v151
  v_cvt_pk_bf16_f32 v168, v144, v145
  v_cvt_pk_bf16_f32 v169, v146, v147
  v_cvt_pk_bf16_f32 v170, v148, v149
  v_cvt_pk_bf16_f32 v171, v150, v151
  v_mul_f32 v64, v64, v189
  v_mul_f32 v65, v65, v189
  v_mul_f32 v66, v66, v189
  v_mul_f32 v67, v67, v189
  v_mul_f32 v68, v68, v189
  v_mul_f32 v69, v69, v189
  v_mul_f32 v70, v70, v189
  v_mul_f32 v71, v71, v189
  v_mul_f32 v72, v72, v189
  v_mul_f32 v73, v73, v189
  v_mul_f32 v74, v74, v189
  v_mul_f32 v75, v75, v189
  v_mul_f32 v76, v76, v189
  v_mul_f32 v77, v77, v189
  v_mul_f32 v78, v78, v189
  v_mul_f32 v79, v79, v189
  v_mul_f32 v80, v80, v189
  v_mul_f32 v81, v81, v189
  v_mul_f32 v82, v82, v189
  v_mul_f32 v83, v83, v189
  v_mul_f32 v84, v84, v189
  v_mul_f32 v85, v85, v189
  v_mul_f32 v86, v86, v189
  v_mul_f32 v87, v87, v189
  v_mul_f32 v88, v88, v189
  v_mul_f32 v89, v89, v189
  v_mul_f32 v90, v90, v189
  v_mul_f32 v91, v91, v189
  v_mul_f32 v92, v92, v189
  v_mul_f32 v93, v93, v189
  v_mul_f32 v94, v94, v189
  v_mul_f32 v95, v95, v189
  v_max3_f32 v188, v152, v153, v154
  v_max3_f32 v188, v188, v155, v156
  v_max3_f32 v188, v188, v157, v158
  v_max_f32 v188, v188, v159
  v_mov_b32 v189, v188
  s_nop 1
  v_permlane16_swap_b32 v188, v189
  v_max_f32 v188, v188, v189
  v_mov_b32 v189, v188
  s_nop 1
  v_permlane32_swap_b32 v188, v189
  v_max_f32 v188, v188, v189
  v_max_f32 v188, v188, v187
  v_sub_f32 v189, v187, v188
  v_exp_f32 v189, v189
  v_mov_b32 v187, v188
  v_sub_f32 v152, v152, v188
  v_sub_f32 v153, v153, v188
  v_sub_f32 v154, v154, v188
  v_sub_f32 v155, v155, v188
  v_sub_f32 v156, v156, v188
  v_sub_f32 v157, v157, v188
  v_sub_f32 v158, v158, v188
  v_sub_f32 v159, v159, v188
  v_exp_f32 v152, v152
  v_exp_f32 v153, v153
  v_exp_f32 v154, v154
  v_exp_f32 v155, v155
  v_exp_f32 v156, v156
  v_exp_f32 v157, v157
  v_exp_f32 v158, v158
  v_exp_f32 v159, v159
  v_mul_f32 v223, v223, v189
  v_add_f32 v223, v223, v152
  v_add_f32 v223, v223, v153
  v_add_f32 v223, v223, v154
  v_add_f32 v223, v223, v155
  v_add_f32 v223, v223, v156
  v_add_f32 v223, v223, v157
  v_add_f32 v223, v223, v158
  v_add_f32 v223, v223, v159
  v_cvt_pk_bf16_f32 v172, v152, v153
  v_cvt_pk_bf16_f32 v173, v154, v155
  v_cvt_pk_bf16_f32 v174, v156, v157
  v_cvt_pk_bf16_f32 v175, v158, v159
  v_mul_f32 v96, v96, v189
  v_mul_f32 v97, v97, v189
  v_mul_f32 v98, v98, v189
  v_mul_f32 v99, v99, v189
  v_mul_f32 v100, v100, v189
  v_mul_f32 v101, v101, v189
  v_mul_f32 v102, v102, v189
  v_mul_f32 v103, v103, v189
  v_mul_f32 v104, v104, v189
  v_mul_f32 v105, v105, v189
  v_mul_f32 v106, v106, v189
  v_mul_f32 v107, v107, v189
  v_mul_f32 v108, v108, v189
  v_mul_f32 v109, v109, v189
  v_mul_f32 v110, v110, v189
  v_mul_f32 v111, v111, v189
  v_mul_f32 v112, v112, v189
  v_mul_f32 v113, v113, v189
  v_mul_f32 v114, v114, v189
  v_mul_f32 v115, v115, v189
  v_mul_f32 v116, v116, v189
  v_mul_f32 v117, v117, v189
  v_mul_f32 v118, v118, v189
  v_mul_f32 v119, v119, v189
  v_mul_f32 v120, v120, v189
  v_mul_f32 v121, v121, v189
  v_mul_f32 v122, v122, v189
  v_mul_f32 v123, v123, v189
  v_mul_f32 v124, v124, v189
  v_mul_f32 v125, v125, v189
  v_mul_f32 v126, v126, v189
  v_mul_f32 v127, v127, v189
  s_waitcnt lgkmcnt(0)
  v_mfma_f32_16x16x32_bf16 v[0:3], a[224:227], v[160:163], v[0:3]
  v_mfma_f32_16x16x32_bf16 v[32:35], a[224:227], v[164:167], v[32:35]
  v_mfma_f32_16x16x32_bf16 v[4:7], a[228:231], v[160:163], v[4:7]
  v_mfma_f32_16x16x32_bf16 v[36:39], a[228:231], v[164:167], v[36:39]
  v_mfma_f32_16x16x32_bf16 v[8:11], a[232:235], v[160:163], v[8:11]
  v_mfma_f32_16x16x32_bf16 v[40:43], a[232:235], v[164:167], v[40:43]
  v_mfma_f32_16x16x32_bf16 v[12:15], a[236:239], v[160:163], v[12:15]
  v_mfma_f32_16x16x32_bf16 v[44:47], a[236:239], v[164:167], v[44:47]
  v_mfma_f32_16x16x32_bf16 v[16:19], a[240:243], v[160:163], v[16:19]
  v_mfma_f32_16x16x32_bf16 v[48:51], a[240:243], v[164:167], v[48:51]
  v_mfma_f32_16x16x32_bf16 v[20:23], a[244:247], v[160:163], v[20:23]
  v_mfma_f32_16x16x32_bf16 v[52:55], a[244:247], v[164:167], v[52:55]
  v_mfma_f32_16x16x32_bf16 v[24:27], a[248:251], v[160:163], v[24:27]
  v_mfma_f32_16x16x32_bf16 v[56:59], a[248:251], v[164:167], v[56:59]
  v_mfma_f32_16x16x32_bf16 v[28:31], a[252:255], v[160:163], v[28:31]
  v_mfma_f32_16x16x32_bf16 v[60:63], a[252:255], v[164:167], v[60:63]
  v_mfma_f32_16x16x32_bf16 v[64:67], a[224:227], v[168:171], v[64:67]
  v_mfma_f32_16x16x32_bf16 v[96:99], a[224:227], v[172:175], v[96:99]
  v_mfma_f32_16x16x32_bf16 v[68:71], a[228:231], v[168:171], v[68:71]
  v_mfma_f32_16x16x32_bf16 v[100:103], a[228:231], v[172:175], v[100:103]
  v_mfma_f32_16x16x32_bf16 v[72:75], a[232:235], v[168:171], v[72:75]
  v_mfma_f32_16x16x32_bf16 v[104:107], a[232:235], v[172:175], v[104:107]
  v_mfma_f32_16x16x32_bf16 v[76:79], a[236:239], v[168:171], v[76:79]
  v_mfma_f32_16x16x32_bf16 v[108:111], a[236:239], v[172:175], v[108:111]
  v_mfma_f32_16x16x32_bf16 v[80:83], a[240:243], v[168:171], v[80:83]
  v_mfma_f32_16x16x32_bf16 v[112:115], a[240:243], v[172:175], v[112:115]
  v_mfma_f32_16x16x32_bf16 v[84:87], a[244:247], v[168:171], v[84:87]
  v_mfma_f32_16x16x32_bf16 v[116:119], a[244:247], v[172:175], v[116:119]
  v_mfma_f32_16x16x32_bf16 v[88:91], a[248:251], v[168:171], v[88:91]
  v_mfma_f32_16x16x32_bf16 v[120:123], a[248:251], v[172:175], v[120:123]
  v_mfma_f32_16x16x32_bf16 v[92:95], a[252:255], v[168:171], v[92:95]
  v_mfma_f32_16x16x32_bf16 v[124:127], a[252:255], v[172:175], v[124:127]
  s_nop 15
  s_add_u32 s88, s88, 8192
  s_cmp_lt_u32 s88, 0x40000
  s_cbranch_scc1 L_slowl_CW
  v_mov_b32 v252, v238
  v_mov_b32 v254, v239
  v_mov_b32 v200, v222
  v_mov_b32 v202, v223
  s_nop 1
  v_permlane16_swap_b32 v238, v252
  v_permlane16_swap_b32 v239, v254
  v_permlane16_swap_b32 v222, v200
  v_permlane16_swap_b32 v223, v202
  v_add_f32 v238, v238, v252
  v_add_f32 v239, v239, v254
  v_add_f32 v222, v222, v200
  v_add_f32 v223, v223, v202
  v_mov_b32 v252, v238
  v_mov_b32 v254, v239
  v_mov_b32 v200, v222
  v_mov_b32 v202, v223
  s_nop 1
  v_permlane32_swap_b32 v238, v252
  v_permlane32_swap_b32 v239, v254
  v_permlane32_swap_b32 v222, v200
  v_permlane32_swap_b32 v223, v202
  v_add_f32 v238, v238, v252
  v_add_f32 v239, v239, v254
  v_add_f32 v222, v222, v200
  v_add_f32 v223, v223, v202
  v_rcp_f32 v252, v238
  v_rcp_f32 v254, v239
  v_rcp_f32 v200, v222
  v_rcp_f32 v202, v223
  s_nop 0
  s_branch L_resume_CW
L_slow_LW:
  s_mov_b32 s38, 147456
  s_cmp_eq_u32 s30, 1
  s_cselect_b32 s38, 98304, s38
  s_cmp_eq_u32 s30, 2
  s_cselect_b32 s38, 106496, s38
  s_cmp_eq_u32 s30, 3
  s_cselect_b32 s38, 114688, s38
  s_sub_u32 s39, s38, 98304
  v_add_u32 v214, s39, v240
  v_add_u32 v215, s39, v241
  v_add_u32 v216, s39, v242
  v_add_u32 v217, s39, v243
  v_add_u32 v176, s39, v244
  v_add_u32 v177, s39, v245
  v_add_u32 v178, s39, v246
  v_add_u32 v179, s39, v247
  v_add_u32 v180, s39, v248
  v_add_u32 v181, s39, v249
  v_add_u32 v182, s39, v250
  v_add_u32 v183, s39, v251
  v_mov_b32 v0, 0
  v_mov_b32 v1, 0
  v_mov_b32 v2, 0
  v_mov_b32 v3, 0
  v_mov_b32 v4, 0
  v_mov_b32 v5, 0
  v_mov_b32 v6, 0
  v_mov_b32 v7, 0
  v_mov_b32 v8, 0
  v_mov_b32 v9, 0
  v_mov_b32 v10, 0
  v_mov_b32 v11, 0
  v_mov_b32 v12, 0
  v_mov_b32 v13, 0
  v_mov_b32 v14, 0
  v_mov_b32 v15, 0
  v_mov_b32 v16, 0
  v_mov_b32 v17, 0
  v_mov_b32 v18, 0
  v_mov_b32 v19, 0
  v_mov_b32 v20, 0
  v_mov_b32 v21, 0
  v_mov_b32 v22, 0
  v_mov_b32 v23, 0
  v_mov_b32 v24, 0
  v_mov_b32 v25, 0
  v_mov_b32 v26, 0
  v_mov_b32 v27, 0
  v_mov_b32 v28, 0
  v_mov_b32 v29, 0
  v_mov_b32 v30, 0
  v_mov_b32 v31, 0
  v_mov_b32 v32, 0
  v_mov_b32 v33, 0
  v_mov_b32 v34, 0
  v_mov_b32 v35, 0
  v_mov_b32 v36, 0
  v_mov_b32 v37, 0
  v_mov_b32 v38, 0
  v_mov_b32 v39, 0
  v_mov_b32 v40, 0
  v_mov_b32 v41, 0
  v_mov_b32 v42, 0
  v_mov_b32 v43, 0
  v_mov_b32 v44, 0
  v_mov_b32 v45, 0
  v_mov_b32 v46, 0
  v_mov_b32 v47, 0
  v_mov_b32 v48, 0
  v_mov_b32 v49, 0
  v_mov_b32 v50, 0
  v_mov_b32 v51, 0
  v_mov_b32 v52, 0
  v_mov_b32 v53, 0
  v_mov_b32 v54, 0
  v_mov_b32 v55, 0
  v_mov_b32 v56, 0
  v_mov_b32 v57, 0
  v_mov_b32 v58, 0
  v_mov_b32 v59, 0
  v_mov_b32 v60, 0
  v_mov_b32 v61, 0
  v_mov_b32 v62, 0
  v_mov_b32 v63, 0
  v_mov_b32 v238, 0
  v_mov_b32 v184, 0xff800000
  v_mov_b32 v239, 0
  v_mov_b32 v185, 0xff800000
  s_mov_b32 s88, 0
L_slowl_LW:
  s_add_u32 m0, s38, 0
  s_add_u32 s39, s88, 0
  buffer_load_dwordx4 v228, s[12:15], s39 offen offset:0 lds
  buffer_load_dwordx4 v229, s[12:15], s39 offen offset:1024 lds
  buffer_load_dwordx4 v230, s[12:15], s39 offen offset:2048 lds
  buffer_load_dwordx4 v231, s[12:15], s39 offen offset:3072 lds
  s_add_u32 m0, s38, 4096
  s_add_u32 s39, s88, 4096
  buffer_load_dwordx4 v228, s[12:15], s39 offen offset:0 lds
  buffer_load_dwordx4 v229, s[12:15], s39 offen offset:1024 lds
  buffer_load_dwordx4 v230, s[12:15], s39 offen offset:2048 lds
  buffer_load_dwordx4 v231, s[12:15], s39 offen offset:3072 lds
  s_waitcnt vmcnt(0)
  ds_read_b128 a[192:195], v214 offset:0
  ds_read_b128 a[196:199], v215 offset:0
  ds_read_b128 a[200:203], v216 offset:0
  ds_read_b128 a[204:207], v217 offset:0
  ds_read_b128 a[208:211], v214 offset:4096
  ds_read_b128 a[212:215], v215 offset:4096
  ds_read_b128 a[216:219], v216 offset:4096
  ds_read_b128 a[220:223], v217 offset:4096
  s_waitcnt lgkmcnt(0)
  s_add_u32 m0, s38, 0
  s_add_u32 s39, s88, 0
  buffer_load_dwordx4 v232, s[16:19], s39 offen offset:0 lds
  buffer_load_dwordx4 v233, s[16:19], s39 offen offset:1024 lds
  buffer_load_dwordx4 v232, s[16:19], s39 offen offset:2048 lds
  buffer_load_dwordx4 v233, s[16:19], s39 offen offset:3072 lds
  s_add_u32 m0, s38, 4096
  s_add_u32 s39, s88, 4096
  buffer_load_dwordx4 v232, s[16:19], s39 offen offset:0 lds
  buffer_load_dwordx4 v233, s[16:19], s39 offen offset:1024 lds
  buffer_load_dwordx4 v232, s[16:19], s39 offen offset:2048 lds
  buffer_load_dwordx4 v233, s[16:19], s39 offen offset:3072 lds
  s_waitcnt vmcnt(0)
  ds_read_b64_tr_b16 a[224:225], v176 offset:0
  ds_read_b64_tr_b16 a[226:227], v176 offset:4096
  ds_read_b64_tr_b16 a[228:229], v177 offset:0
  ds_read_b64_tr_b16 a[230:231], v177 offset:4096
  ds_read_b64_tr_b16 a[232:233], v178 offset:0
  ds_read_b64_tr_b16 a[234:235], v178 offset:4096
  ds_read_b64_tr_b16 a[236:237], v179 offset:0
  ds_read_b64_tr_b16 a[238:239], v179 offset:4096
  ds_read_b64_tr_b16 a[240:241], v180 offset:0
  ds_read_b64_tr_b16 a[242:243], v180 offset:4096
  ds_read_b64_tr_b16 a[244:245], v181 offset:0
  ds_read_b64_tr_b16 a[246:247], v181 offset:4096
  ds_read_b64_tr_b16 a[248:249], v182 offset:0
  ds_read_b64_tr_b16 a[250:251], v182 offset:4096
  ds_read_b64_tr_b16 a[252:253], v183 offset:0
  ds_read_b64_tr_b16 a[254:255], v183 offset:4096
  v_mfma_f32_16x16x32_bf16 v[128:131], a[192:195], a[128:131], 0
  v_mfma_f32_16x16x32_bf16 v[136:139], a[192:195], a[144:147], 0
  v_mfma_f32_16x16x32_bf16 v[128:131], a[196:199], a[132:135], v[128:131]
  v_mfma_f32_16x16x32_bf16 v[136:139], a[196:199], a[148:151], v[136:139]
  v_mfma_f32_16x16x32_bf16 v[128:131], a[200:203], a[136:139], v[128:131]
  v_mfma_f32_16x16x32_bf16 v[136:139], a[200:203], a[152:155], v[136:139]
  v_mfma_f32_16x16x32_bf16 v[128:131], a[204:207], a[140:143], v[128:131]
  v_mfma_f32_16x16x32_bf16 v[136:139], a[204:207], a[156:159], v[136:139]
  v_mfma_f32_16x16x32_bf16 v[132:135], a[208:211], a[128:131], 0
  v_mfma_f32_16x16x32_bf16 v[140:143], a[208:211], a[144:147], 0
  v_mfma_f32_16x16x32_bf16 v[132:135], a[212:215], a[132:135], v[132:135]
  v_mfma_f32_16x16x32_bf16 v[140:143], a[212:215], a[148:151], v[140:143]
  v_mfma_f32_16x16x32_bf16 v[132:135], a[216:219], a[136:139], v[132:135]
  v_mfma_f32_16x16x32_bf16 v[140:143], a[216:219], a[152:155], v[140:143]
  v_mfma_f32_16x16x32_bf16 v[132:135], a[220:223], a[140:143], v[132:135]
  v_mfma_f32_16x16x32_bf16 v[140:143], a[220:223], a[156:159], v[140:143]
  s_nop 15
  v_max3_f32 v188, v128, v129, v130
  v_max3_f32 v188, v188, v131, v132
  v_max3_f32 v188, v188, v133, v134
  v_max_f32 v188, v188, v135
  v_mov_b32 v189, v188
  s_nop 1
  v_permlane16_swap_b32 v188, v189
  v_max_f32 v188, v188, v189
  v_mov_b32 v189, v188
  s_nop 1
  v_permlane32_swap_b32 v188, v189
  v_max_f32 v188, v188, v189
  v_max_f32 v188, v188, v184
  v_sub_f32 v189, v184, v188
  v_exp_f32 v189, v189
  v_mov_b32 v184, v188
  v_sub_f32 v128, v128, v188
  v_sub_f32 v129, v129, v188
  v_sub_f32 v130, v130, v188
  v_sub_f32 v131, v131, v188
  v_sub_f32 v132, v132, v188
  v_sub_f32 v133, v133, v188
  v_sub_f32 v134, v134, v188
  v_sub_f32 v135, v135, v188
  v_exp_f32 v128, v128
  v_exp_f32 v129, v129
  v_exp_f32 v130, v130
  v_exp_f32 v131, v131
  v_exp_f32 v132, v132
  v_exp_f32 v133, v133
  v_exp_f32 v134, v134
  v_exp_f32 v135, v135
  v_mul_f32 v238, v238, v189
  v_add_f32 v238, v238, v128
  v_add_f32 v238, v238, v129
  v_add_f32 v238, v238, v130
  v_add_f32 v238, v238, v131
  v_add_f32 v238, v238, v132
  v_add_f32 v238, v238, v133
  v_add_f32 v238, v238, v134
  v_add_f32 v238, v238, v135
  v_cvt_pk_bf16_f32 v160, v128, v129
  v_cvt_pk_bf16_f32 v161, v130, v131
  v_cvt_pk_bf16_f32 v162, v132, v133
  v_cvt_pk_bf16_f32 v163, v134, v135
  v_mul_f32 v0, v0, v189
  v_mul_f32 v1, v1, v189
  v_mul_f32 v2, v2, v189
  v_mul_f32 v3, v3, v189
  v_mul_f32 v4, v4, v189
  v_mul_f32 v5, v5, v189
  v_mul_f32 v6, v6, v189
  v_mul_f32 v7, v7, v189
  v_mul_f32 v8, v8, v189
  v_mul_f32 v9, v9, v189
  v_mul_f32 v10, v10, v189
  v_mul_f32 v11, v11, v189
  v_mul_f32 v12, v12, v189
  v_mul_f32 v13, v13, v189
  v_mul_f32 v14, v14, v189
  v_mul_f32 v15, v15, v189
  v_mul_f32 v16, v16, v189
  v_mul_f32 v17, v17, v189
  v_mul_f32 v18, v18, v189
  v_mul_f32 v19, v19, v189
  v_mul_f32 v20, v20, v189
  v_mul_f32 v21, v21, v189
  v_mul_f32 v22, v22, v189
  v_mul_f32 v23, v23, v189
  v_mul_f32 v24, v24, v189
  v_mul_f32 v25, v25, v189
  v_mul_f32 v26, v26, v189
  v_mul_f32 v27, v27, v189
  v_mul_f32 v28, v28, v189
  v_mul_f32 v29, v29, v189
  v_mul_f32 v30, v30, v189
  v_mul_f32 v31, v31, v189
  v_max3_f32 v188, v136, v137, v138
  v_max3_f32 v188, v188, v139, v140
  v_max3_f32 v188, v188, v141, v142
  v_max_f32 v188, v188, v143
  v_mov_b32 v189, v188
  s_nop 1
  v_permlane16_swap_b32 v188, v189
  v_max_f32 v188, v188, v189
  v_mov_b32 v189, v188
  s_nop 1
  v_permlane32_swap_b32 v188, v189
  v_max_f32 v188, v188, v189
  v_max_f32 v188, v188, v185
  v_sub_f32 v189, v185, v188
  v_exp_f32 v189, v189
  v_mov_b32 v185, v188
  v_sub_f32 v136, v136, v188
  v_sub_f32 v137, v137, v188
  v_sub_f32 v138, v138, v188
  v_sub_f32 v139, v139, v188
  v_sub_f32 v140, v140, v188
  v_sub_f32 v141, v141, v188
  v_sub_f32 v142, v142, v188
  v_sub_f32 v143, v143, v188
  v_exp_f32 v136, v136
  v_exp_f32 v137, v137
  v_exp_f32 v138, v138
  v_exp_f32 v139, v139
  v_exp_f32 v140, v140
  v_exp_f32 v141, v141
  v_exp_f32 v142, v142
  v_exp_f32 v143, v143
  v_mul_f32 v239, v239, v189
  v_add_f32 v239, v239, v136
  v_add_f32 v239, v239, v137
  v_add_f32 v239, v239, v138
  v_add_f32 v239, v239, v139
  v_add_f32 v239, v239, v140
  v_add_f32 v239, v239, v141
  v_add_f32 v239, v239, v142
  v_add_f32 v239, v239, v143
  v_cvt_pk_bf16_f32 v164, v136, v137
  v_cvt_pk_bf16_f32 v165, v138, v139
  v_cvt_pk_bf16_f32 v166, v140, v141
  v_cvt_pk_bf16_f32 v167, v142, v143
  v_mul_f32 v32, v32, v189
  v_mul_f32 v33, v33, v189
  v_mul_f32 v34, v34, v189
  v_mul_f32 v35, v35, v189
  v_mul_f32 v36, v36, v189
  v_mul_f32 v37, v37, v189
  v_mul_f32 v38, v38, v189
  v_mul_f32 v39, v39, v189
  v_mul_f32 v40, v40, v189
  v_mul_f32 v41, v41, v189
  v_mul_f32 v42, v42, v189
  v_mul_f32 v43, v43, v189
  v_mul_f32 v44, v44, v189
  v_mul_f32 v45, v45, v189
  v_mul_f32 v46, v46, v189
  v_mul_f32 v47, v47, v189
  v_mul_f32 v48, v48, v189
  v_mul_f32 v49, v49, v189
  v_mul_f32 v50, v50, v189
  v_mul_f32 v51, v51, v189
  v_mul_f32 v52, v52, v189
  v_mul_f32 v53, v53, v189
  v_mul_f32 v54, v54, v189
  v_mul_f32 v55, v55, v189
  v_mul_f32 v56, v56, v189
  v_mul_f32 v57, v57, v189
  v_mul_f32 v58, v58, v189
  v_mul_f32 v59, v59, v189
  v_mul_f32 v60, v60, v189
  v_mul_f32 v61, v61, v189
  v_mul_f32 v62, v62, v189
  v_mul_f32 v63, v63, v189
  s_waitcnt lgkmcnt(0)
  v_mfma_f32_16x16x32_bf16 v[0:3], a[224:227], v[160:163], v[0:3]
  v_mfma_f32_16x16x32_bf16 v[32:35], a[224:227], v[164:167], v[32:35]
  v_mfma_f32_16x16x32_bf16 v[4:7], a[228:231], v[160:163], v[4:7]
  v_mfma_f32_16x16x32_bf16 v[36:39], a[228:231], v[164:167], v[36:39]
  v_mfma_f32_16x16x32_bf16 v[8:11], a[232:235], v[160:163], v[8:11]
  v_mfma_f32_16x16x32_bf16 v[40:43], a[232:235], v[164:167], v[40:43]
  v_mfma_f32_16x16x32_bf16 v[12:15], a[236:239], v[160:163], v[12:15]
  v_mfma_f32_16x16x32_bf16 v[44:47], a[236:239], v[164:167], v[44:47]
  v_mfma_f32_16x16x32_bf16 v[16:19], a[240:243], v[160:163], v[16:19]
  v_mfma_f32_16x16x32_bf16 v[48:51], a[240:243], v[164:167], v[48:51]
  v_mfma_f32_16x16x32_bf16 v[20:23], a[244:247], v[160:163], v[20:23]
  v_mfma_f32_16x16x32_bf16 v[52:55], a[244:247], v[164:167], v[52:55]
  v_mfma_f32_16x16x32_bf16 v[24:27], a[248:251], v[160:163], v[24:27]
  v_mfma_f32_16x16x32_bf16 v[56:59], a[248:251], v[164:167], v[56:59]
  v_mfma_f32_16x16x32_bf16 v[28:31], a[252:255], v[160:163], v[28:31]
  v_mfma_f32_16x16x32_bf16 v[60:63], a[252:255], v[164:167], v[60:63]
  s_nop 15
  s_add_u32 s88, s88, 8192
  s_cmp_lt_u32 s88, 0x40000
  s_cbranch_scc1 L_slowl_LW
  v_mov_b32 v252, v238
  v_mov_b32 v254, v239
  s_nop 1
  v_permlane16_swap_b32 v238, v252
  v_permlane16_swap_b32 v239, v254
  v_add_f32 v238, v238, v252
  v_add_f32 v239, v239, v254
  v_mov_b32 v252, v238
  v_mov_b32 v254, v239
  s_nop 1
  v_permlane32_swap_b32 v238, v252
  v_permlane32_swap_b32 v239, v254
  v_add_f32 v238, v238, v252
  v_add_f32 v239, v239, v254
  v_rcp_f32 v252, v238
  v_rcp_f32 v254, v239
  s_nop 0
  s_branch L_resume_LW
L_end:
  s_endpgm
.section .rodata,"a"
.p2align 6
.amdhsa_kernel standalone__gqa_block_cached__near_ridge_kernel
  .amdhsa_next_free_vgpr 512
  .amdhsa_next_free_sgpr 102
  .amdhsa_accum_offset 256
  .amdhsa_group_segment_fixed_size 0
  .amdhsa_kernarg_size 64
  .amdhsa_user_sgpr_count 2
  .amdhsa_user_sgpr_kernarg_segment_ptr 1
  .amdhsa_system_sgpr_workgroup_id_x 1
.end_amdhsa_kernel
```
